```python
import torch

def _softmax(x, axis=-1):
    return torch.softmax(x, dim=axis)
def _gelu(x):
    return torch.nn.functional.gelu(x, approximate="tanh")
def _silu(x):
    return torch.nn.functional.silu(x)
def _sigmoid(x):
    return torch.sigmoid(x)
def _layernorm(x, axis=-1, eps=1e-5):
    m = x.mean(dim=axis, keepdim=True)
    v = x.var(dim=axis, keepdim=True, unbiased=False)
    return (x - m) / torch.sqrt(v + eps)
def _scatter_add(tgt, idx, src, axis=0):
    return tgt.clone().index_add_(axis, idx, src)
def _segment_sum(src, seg, n):
    out = torch.zeros((n,) + src.shape[1:], dtype=src.dtype)
    return out.index_add_(0, seg, src)
def _pad(x, pw):
    flat = tuple(v for pair in reversed(pw) for v in pair)
    return torch.nn.functional.pad(x, flat)

kernel_name = 'interleave_layers__sliding_block__sliding_local_dilated__prompt'

def setup_inputs():

    _w = (lambda a: (lambda t: t.to(torch.bfloat16) if t.is_floating_point() else t)(torch.as_tensor(a)))
    def _A_setup():
        B, S, D = 1, 2048, 512
        return {
            "x": _w((lambda *s: torch.randn(*s, dtype=torch.bfloat16) * 0.05)(B, S, D)),
            "wqkv": _w((lambda *s: torch.randn(*s, dtype=torch.bfloat16) * 0.05)(D, 3 * D)),
            "wo": _w((lambda *s: torch.randn(*s, dtype=torch.bfloat16) * 0.05)(D, D)),
        }
    _A_in = _A_setup()

    def _B_setup():
        B, S, D = 1, 2048, 512
        return {
            "x": _w((lambda *s: torch.randn(*s, dtype=torch.bfloat16) * 0.05)(B, S, D)),
            "wqkv": _w((lambda *s: torch.randn(*s, dtype=torch.bfloat16) * 0.05)(D, 3 * D)),
            "wo": _w((lambda *s: torch.randn(*s, dtype=torch.bfloat16) * 0.05)(D, D)),
        }
    _B_in = _B_setup()

    return {
        "A_x": _A_in["x"],
        "A_wqkv": _A_in["wqkv"],
        "A_wo": _A_in["wo"],
        "B_x": _B_in["x"],
        "B_wqkv": _B_in["wqkv"],
        "B_wo": _B_in["wo"],
    }

def reference(A_x, A_wqkv, A_wo, B_x, B_wqkv, B_wo):
    def _A_ref(x, wqkv, wo):
        B, S, D = x.shape
        H = 32; Dh = D // H; W = 256
        qkv = (lambda x, *d: x.permute(*d))((x @ wqkv).reshape(B, S, 3, H, Dh), 2, 0, 3, 1, 4)
        q, k, v = qkv[0], qkv[1], qkv[2]
        scores = torch.einsum("bhqd,bhkd->bhqk", q, k) * (Dh ** -0.5)
        idx = torch.arange(S)
        mask = (idx[:, None] - idx[None, :] >= 0) & (idx[:, None] - idx[None, :] < W)
        scores = torch.where(mask[None, None], scores, -1e9)
        p = _softmax(scores, axis=-1)
        o = torch.einsum("bhqk,bhkd->bhqd", p, v)
        return (lambda x, *d: x.permute(*d))(o, 0, 2, 1, 3).reshape(B, S, D) @ wo

    def _B_ref(x, wqkv, wo):
        B, S, D = x.shape
        H = 32; Dh = D // H
        W, dil = 8, 2
        qkv = (lambda x, *d: x.permute(*d))((x @ wqkv).reshape(B, S, 3, H, Dh), 2, 0, 3, 1, 4)
        q, k, v = qkv[0], qkv[1], qkv[2]
        scale = Dh ** -0.5
        pos = torch.arange(S)
        off = torch.arange(W) * dil
        idx = pos[:, None] - off[None, :]
        mask = idx >= 0
        idx_c = torch.where(mask, idx, 0).reshape(-1)
        kg = k[:, :, idx_c, :].reshape(B, H, S, W, Dh)
        vg = v[:, :, idx_c, :].reshape(B, H, S, W, Dh)
        logits = torch.einsum("bhsd,bhswd->bhsw", q, kg) * scale
        logits = torch.where(mask[None, None, :, :], logits, -1e9)
        attn = _softmax(logits, axis=-1)
        o = torch.einsum("bhsw,bhswd->bhsd", attn, vg)
        return (lambda x, *d: x.permute(*d))(o, 0, 2, 1, 3).reshape(B, S, D) @ wo

    x = A_x
    x = x + _A_ref(_layernorm(x, axis=-1), A_wqkv, A_wo)
    x = x + _B_ref(_layernorm(x, axis=-1), B_wqkv, B_wo)
    x = x + _A_ref(_layernorm(x, axis=-1), A_wqkv, A_wo)
    x = x + _B_ref(_layernorm(x, axis=-1), B_wqkv, B_wo)
    return x
```

```asm
; @launch grid=(256,1,1) block=(256,1,1) lds=163840
.amdgcn_target "amdgcn-amd-amdhsa--gfx950"
.text
.globl interleave_layers__sliding_block__sliding_local_dilated__prompt_kernel
.p2align 8
.type interleave_layers__sliding_block__sliding_local_dilated__prompt_kernel,@function
interleave_layers__sliding_block__sliding_local_dilated__prompt_kernel:
    s_cmpk_ge_u32 s2, 256
    s_cbranch_scc1 L_end
    s_load_dwordx2 s[8:9], s[0:1], 0
    s_load_dwordx2 s[12:13], s[0:1], 8
    s_getpc_b64 s[40:41]
L_pc:
    s_lshl_b32 s42, 12, 12
    s_lshl_b32 s43, 1, 17
    v_lshlrev_b32 v15, 3, v0
    s_lshr_b32 s47, s2, 3
    s_lshl_b32 s46, s47, 11
    buffer_load_dword v24, v15, s[40:43], s46 offen
    s_mov_b32 s11, s43
    s_lshl_b32 s10, 1, 21
    s_mov_b64 s[14:15], s[10:11]
    v_lshrrev_b32 v14, 5, v0
    v_lshlrev_b32 v14, 10, v14
    s_and_b32 s48, s2, 7
    s_lshl_b32 s48, s48, 5
    s_add_u32 s48, s48, s47
    s_lshl_b32 s48, s48, 13
    v_add_u32 v15, s46, v15
    v_mul_u32_u24 v15, 24, v15
    v_and_b32 v15, 0xfffffc00, v15
    s_waitcnt lgkmcnt(0)
    buffer_load_dword v235, v14, s[8:11], s48 offen offset:384
    buffer_load_dword v235, v15, s[12:15], 0 offen offset:384
    s_lshl_b32 s14, 3, 19
    s_load_dwordx16 s[72:87], s[0:1], 0
    s_load_dwordx2 s[88:89], s[0:1], 64
    v_and_b32 v1, 63, v0
    v_lshrrev_b32 v18, 6, v0
    s_lshr_b32 s4, s48, 17
    v_readfirstlane_b32 s3, v18
    s_lshr_b32 s46, s47, 1
    s_lshr_b32 s64, s47, 3
    s_add_u32 s64, s64, s46
    s_lshl2_add_u32 s64, s47, s64
    s_and_b32 s5, s47, 15
    s_lshl2_add_u32 s54, s4, s3
    s_lshl_b32 s92, s54, 15
    s_lshl_b32 s94, s3, 14
    v_lshrrev_b32 v18, 3, v1
    v_lshlrev_b32 v16, 10, v18
    v_and_b32 v18, 7, v1
    v_lshrrev_b32 v17, 4, v1
    v_xor_b32 v18, v18, v17
    v_lshl_add_u32 v16, v18, 4, v16
    v_xor_b32 v17, 64, v16
    v_lshrrev_b32 v18, 2, v1
    v_mul_u32_u24 v11, 3072, v18
    v_and_b32 v18, 3, v1
    v_lshl_add_u32 v11, v18, 4, v11
    s_mul_i32 s65, s3, 768
    s_add_u32 s65, s65, s5
    s_lshl_b32 s65, s65, 6
    s_lshl_b32 s98, s3, 10
    s_add_u32 s50, s64, 0
    s_and_b32 s50, s50, 7
    s_lshl_b32 s50, s50, 7
    s_add_u32 m0, s94, 0
    s_add_u32 s50, s50, s92
    buffer_load_dwordx4 v16, s[8:11], s50 offen offset:0 lds
    s_addk_i32 s50, 7168
    buffer_load_dwordx4 v17, s[8:11], s50 offen offset:1024 lds
    s_addk_i32 s50, 7168
    buffer_load_dwordx4 v16, s[8:11], s50 offen offset:2048 lds
    s_addk_i32 s50, 7168
    buffer_load_dwordx4 v17, s[8:11], s50 offen offset:3072 lds
    s_add_u32 s50, s64, 0
    s_and_b32 s50, s50, 7
    s_mul_i32 s50, s50, 196608
    s_add_u32 m0, s98, 97280
    s_add_u32 s50, s50, s65
    buffer_load_dwordx4 v11, s[12:15], s50 offen offset:1024 lds
    s_addk_i32 m0, 31744
    s_nop 0
    buffer_load_dwordx4 v11, s[12:15], s50 offen offset:2048 lds
    v_and_b32 v2, 31, v1
    v_lshrrev_b32 v3, 5, v1
    v_lshlrev_b32 v4, 4, v1
    s_getreg_b32 s53, hwreg(HW_REG_XCC_ID, 0, 4)
    s_mov_b64 s[6:7], 0
    s_mov_b32 s71, 0
    s_mov_b64 s[44:45], 0
    s_mov_b32 s66, -1
    s_mov_b32 s67, 0
    s_lshr_b32 s46, s5, 2
    s_lshl2_add_u32 s55, s4, s46
    s_and_b32 s56, s5, 3
    s_lshl2_add_u32 s56, s56, s3
    s_waitcnt lgkmcnt(0)
    s_mov_b64 s[20:21], s[76:77]
    s_lshl_b32 s22, 1, 19
    s_mov_b32 s23, s11
    s_mov_b64 s[24:25], s[82:83]
    s_lshl_b32 s26, 1, 19
    s_mov_b32 s27, s11
    s_mov_b64 s[16:17], s[80:81]
    s_lshl_b32 s18, 3, 19
    s_mov_b32 s19, s11
    s_mov_b64 s[36:37], s[88:89]
    s_lshl_b32 s38, 35, 20
    s_mov_b32 s39, s11
    s_lshl_b32 s46, s54, 15
    s_lshl_b32 s47, s5, 11
    s_add_u32 s58, s46, s47
    s_add_u32 s58, s58, 6291456
    s_lshl_b32 s46, s54, 14
    s_lshl_b32 s47, s5, 20
    s_add_u32 s59, s46, s47
    s_add_u32 s59, s59, 14680064
    s_mov_b64 s[28:29], s[84:85]
    s_lshl_b32 s30, 1, 21
    s_mov_b32 s31, s11
    s_mov_b64 s[32:33], s[86:87]
    s_lshl_b32 s34, 1, 8
    s_mov_b32 s35, s11
    s_lshl_b32 s46, s55, 10
    s_and_b32 s47, s5, 2
    s_lshl_b32 s47, s47, 8
    s_add_u32 s62, s46, s47
    s_and_b32 s47, s5, 1
    s_lshl_b32 s47, s47, 3
    s_add_u32 s62, s62, s47
    s_add_u32 s62, s62, 31457280
    s_lshl_b32 s46, s54, 10
    s_add_u32 s60, s46, 31457280
    s_lshl_b32 s46, s54, 15
    s_add_u32 s57, s46, 0
    s_lshl_b32 s46, s55, 15
    s_lshl_b32 s47, s56, 11
    s_add_u32 s61, s46, s47
    s_add_u32 s61, s61, 0
    s_lshl_b32 s47, s3, 13
    s_add_u32 s63, s46, s47
    s_add_u32 s63, s63, 6291456
    s_mov_b32 s70, 57856
    s_mov_b32 s88, s64
    s_mov_b32 s89, 0
    s_lshl_b32 s91, s56, 15
    s_add_u32 s91, s91, 32505856
    s_add_u32 s49, s3, 0
    s_and_b32 s49, s49, 3
    s_lshl_b32 s49, s49, 13
    s_add_u32 s40, s49, s91
    s_add_u32 s49, s3, 1
    s_and_b32 s49, s49, 3
    s_lshl_b32 s49, s49, 13
    s_add_u32 s41, s49, s91
    s_add_u32 s49, s3, 2
    s_and_b32 s49, s49, 3
    s_lshl_b32 s49, s49, 13
    s_add_u32 s42, s49, s91
    s_add_u32 s49, s3, 3
    s_and_b32 s49, s49, 3
    s_lshl_b32 s49, s49, 13
    s_add_u32 s43, s49, s91
    s_mul_i32 s90, s3, 49152
    s_lshl_b32 s46, s5, 6
    s_add_u32 s90, s90, s46
    s_lshl_b32 s46, s4, 4
    s_add_u32 s46, s46, s5
    s_and_b32 s47, s46, 3
    s_lshl_b32 s47, s47, 3
    s_or_b32 s48, s53, 0x80
    s_lshl_b32 s93, s48, s47
    s_lshl_b32 s99, s46, 7
    s_add_u32 s99, s99, 31588352
    s_and_b32 s95, s46, 0xfc
    v_bfe_u32 v14, v2, 1, 3
    v_xor_b32 v14, v14, v3
    v_lshlrev_b32 v14, 4, v14
    v_lshl_add_u32 v14, v2, 7, v14
    v_add_u32 v56, s94, v14
    v_xor_b32 v57, 32, v56
    v_xor_b32 v58, 64, v56
    v_xor_b32 v59, 0x60, v56
    v_cmp_gt_u32 s[72:73], 16, v2
    s_mov_b64 s[84:85], 0
    s_mov_b64 s[86:87], 0
    v_bfe_u32 v14, v1, 2, 2
    v_lshlrev_b32 v14, 6, v14
    v_bfe_u32 v15, v1, 4, 1
    v_lshl_add_u32 v14, v15, 5, v14
    v_and_b32 v15, 3, v1
    v_lshl_add_u32 v14, v15, 3, v14
    v_lshl_add_u32 v14, v3, 9, v14
    v_add_u32 v5, 65536, v14
    v_add_u32 v6, 65792, v14
    v_add_u32 v7, 98304, v14
    v_add_u32 v8, 98560, v14
    v_add_u32 v9, 131072, v14
    v_add_u32 v10, 131328, v14
    v_add_u32 v114, s98, v7
    v_add_u32 v115, s98, v8
    v_add_u32 v116, s98, v9
    v_add_u32 v117, s98, v10
    s_add_u32 s46, s98, 98304
    v_add_u32 v112, s46, v4
    v_lshrrev_b32 v14, 2, v1
    v_xor_b32 v14, v14, v1
    v_and_b32 v14, 4, v14
    v_and_or_b32 v14, v1, 3, v14
    v_mov_b32 v60, 0x3f803f80
    v_cmp_eq_u32 vcc, 0, v14
    s_nop 1
    v_cndmask_b32 v61, 0, v60, vcc
    v_cmp_eq_u32 vcc, 1, v14
    v_accvgpr_write_b32 a128, v61
    v_accvgpr_write_b32 a129, v61
    v_accvgpr_write_b32 a130, v61
    v_accvgpr_write_b32 a131, v61
    v_cndmask_b32 v61, 0, v60, vcc
    v_cmp_eq_u32 vcc, 2, v14
    v_accvgpr_write_b32 a132, v61
    v_accvgpr_write_b32 a133, v61
    v_accvgpr_write_b32 a134, v61
    v_accvgpr_write_b32 a135, v61
    v_cndmask_b32 v61, 0, v60, vcc
    v_cmp_eq_u32 vcc, 3, v14
    v_accvgpr_write_b32 a136, v61
    v_accvgpr_write_b32 a137, v61
    v_accvgpr_write_b32 a138, v61
    v_accvgpr_write_b32 a139, v61
    v_cndmask_b32 v61, 0, v60, vcc
    s_nop 0
    v_accvgpr_write_b32 a140, v61
    v_accvgpr_write_b32 a141, v61
    v_accvgpr_write_b32 a142, v61
    v_accvgpr_write_b32 a143, v61
    v_lshlrev_b32 v15, 3, v2
    v_add_u32 v15, s70, v15
    s_add_u32 s50, s64, 1
    s_and_b32 s50, s50, 7
    s_lshl_b32 s50, s50, 7
    s_add_u32 m0, s94, 4096
    s_add_u32 s50, s50, s92
    buffer_load_dwordx4 v16, s[8:11], s50 offen offset:0 lds
    s_addk_i32 s50, 7168
    buffer_load_dwordx4 v17, s[8:11], s50 offen offset:1024 lds
    s_addk_i32 s50, 7168
    buffer_load_dwordx4 v16, s[8:11], s50 offen offset:2048 lds
    s_addk_i32 s50, 7168
    buffer_load_dwordx4 v17, s[8:11], s50 offen offset:3072 lds
    s_add_u32 s50, s64, 1
    s_and_b32 s50, s50, 7
    s_mul_i32 s50, s50, 196608
    s_add_u32 m0, s98, 101376
    s_add_u32 s50, s50, s65
    buffer_load_dwordx4 v11, s[12:15], s50 offen offset:1024 lds
    s_addk_i32 m0, 31744
    s_nop 0
    buffer_load_dwordx4 v11, s[12:15], s50 offen offset:2048 lds
    s_waitcnt vmcnt(8)
    ds_read_b128 v[128:131], v56 offset:0
    ds_read_b128 v[132:135], v57 offset:0
    ds_read_b128 v[136:139], v58 offset:0
    ds_read_b128 v[140:143], v59 offset:0
    s_waitcnt vmcnt(6)
    ds_read_b64_tr_b16 v[120:121], v114 offset:0
    ds_read_b64_tr_b16 v[122:123], v115 offset:0
    ds_read_b64_tr_b16 v[124:125], v116 offset:0
    ds_read_b64_tr_b16 v[126:127], v117 offset:0
    s_barrier
    ds_read_b64_tr_b16 v[24:25], v7 offset:0
    ds_read_b64_tr_b16 v[26:27], v8 offset:0
    ds_read_b64_tr_b16 v[28:29], v9 offset:0
    ds_read_b64_tr_b16 v[30:31], v10 offset:0
    ds_read_b64_tr_b16 v[32:33], v7 offset:1024
    ds_read_b64_tr_b16 v[34:35], v8 offset:1024
    ds_read_b64_tr_b16 v[36:37], v9 offset:1024
    ds_read_b64_tr_b16 v[38:39], v10 offset:1024
    s_add_u32 s50, s64, 2
    s_and_b32 s50, s50, 7
    s_mul_i32 s50, s50, 196608
    s_add_u32 m0, s98, 105472
    s_add_u32 s50, s50, s65
    buffer_load_dwordx4 v11, s[12:15], s50 offen offset:1024 lds
    s_addk_i32 m0, 31744
    s_nop 0
    buffer_load_dwordx4 v11, s[12:15], s50 offen offset:2048 lds
    s_add_u32 s50, s64, 2
    s_and_b32 s50, s50, 7
    s_lshl_b32 s50, s50, 7
    s_add_u32 m0, s94, 8192
    s_add_u32 s50, s50, s92
    buffer_load_dwordx4 v16, s[8:11], s50 offen offset:0 lds
    s_addk_i32 s50, 7168
    buffer_load_dwordx4 v17, s[8:11], s50 offen offset:1024 lds
    s_waitcnt lgkmcnt(15)
    v_mfma_f32_32x32x16_bf16 v[96:111], v[128:131], v[128:131], 0
    s_addk_i32 s50, 7168
    buffer_load_dwordx4 v16, s[8:11], s50 offen offset:2048 lds
    v_mfma_f32_16x16x32_bf16 v[60:63], a[128:131], v[128:131], 0
    s_waitcnt lgkmcnt(14)
    v_mfma_f32_32x32x16_bf16 v[96:111], v[132:135], v[132:135], v[96:111]
    ds_read_b64_tr_b16 v[40:41], v7 offset:2048
    ds_read_b64_tr_b16 v[42:43], v8 offset:2048
    ds_read_b64_tr_b16 v[44:45], v9 offset:2048
    ds_read_b64_tr_b16 v[46:47], v10 offset:2048
    v_mfma_f32_16x16x32_bf16 v[60:63], a[128:131], v[132:135], v[60:63]
    s_waitcnt lgkmcnt(15)
    v_mfma_f32_32x32x16_bf16 v[96:111], v[136:139], v[136:139], v[96:111]
    s_addk_i32 s50, 7168
    buffer_load_dwordx4 v17, s[8:11], s50 offen offset:3072 lds
    ds_read_b64_tr_b16 v[48:49], v7 offset:3072
    ds_read_b64_tr_b16 v[50:51], v8 offset:3072
    ds_read_b64_tr_b16 v[52:53], v9 offset:3072
    ds_read_b64_tr_b16 v[54:55], v10 offset:3072
    v_mfma_f32_16x16x32_bf16 v[60:63], a[128:131], v[136:139], v[60:63]
    s_waitcnt lgkmcnt(15)
    v_mfma_f32_32x32x16_bf16 v[96:111], v[140:143], v[140:143], v[96:111]
    s_add_u32 s50, s64, 3
    s_and_b32 s50, s50, 7
    s_mul_i32 s50, s50, 196608
    s_add_u32 m0, s98, 109568
    s_add_u32 s50, s50, s65
    buffer_load_dwordx4 v11, s[12:15], s50 offen offset:1024 lds
    v_mfma_f32_16x16x32_bf16 v[60:63], a[128:131], v[140:143], v[60:63]
    s_waitcnt lgkmcnt(15)
    v_mfma_f32_16x16x32_bf16 v[60:63], a[136:139], v[120:123], v[60:63]
    v_mfma_f32_16x16x32_bf16 v[60:63], a[140:143], v[124:127], v[60:63]
    s_waitcnt lgkmcnt(12)
    v_mfma_f32_32x32x16_bf16 v[64:79], v[24:27], v[128:131], 0
    s_addk_i32 m0, 31744
    v_mfma_f32_32x32x16_bf16 v[80:95], v[128:131], v[28:31], 0
    buffer_load_dwordx4 v11, s[12:15], s50 offen offset:2048 lds
    s_waitcnt lgkmcnt(8)
    v_mfma_f32_32x32x16_bf16 v[64:79], v[32:35], v[132:135], v[64:79]
    s_lshl_b32 s46, s2, 2
    s_add_u32 s46, s46, s3
    s_bfe_u32 s47, s46, 0x50004
    s_and_b32 s48, s46, 15
    s_lshl_b32 s49, s47, 14
    s_lshl_b32 s50, s48, 6
    s_add_u32 s49, s49, s50
    v_lshrrev_b32 v231, 2, v1
    v_lshlrev_b32 v231, 10, v231
    v_and_b32 v234, 3, v1
    v_lshl_add_u32 v231, v234, 4, v231
    s_add_u32 m0, s98, 94208
    s_cmp_ge_u32 s46, 512
    s_cbranch_scc1 L_wob_1
    buffer_load_dwordx4 v231, s[20:23], s49 offen lds
    s_branch L_wod_2
L_wob_1:
    buffer_load_dwordx4 v231, s[24:27], s49 offen lds
L_wod_2:
    s_and_b32 s100, s46, 512
    s_lshl_b32 s48, s48, 5
    s_add_u32 s100, s100, s48
    s_add_u32 s100, s100, s47
    s_lshl_b32 s100, s100, 10
    s_add_u32 s100, s100, 32505856
    v_bfe_u32 v231, v1, 2, 2
    v_lshlrev_b32 v231, 6, v231
    v_lshl_add_u32 v231, v234, 3, v231
    v_bfe_u32 v234, v1, 4, 1
    v_lshl_add_u32 v231, v234, 5, v231
    v_lshl_add_u32 v231, v3, 8, v231
    s_add_u32 s46, s98, 94208
    v_add_u32 v231, s46, v231
    v_mov_b32 v14, s58
    s_add_u32 s46, s59, 4096
    v_writelane_b32 v14, s59, 1
    v_writelane_b32 v14, s46, 2
    v_writelane_b32 v14, s100, 3
    s_mov_b64 exec, 15
    buffer_load_dword v235, v14, s[36:39], 0 offen sc1
    s_mov_b64 exec, -1
    v_mfma_f32_32x32x16_bf16 v[80:95], v[132:135], v[36:39], v[80:95]
    s_waitcnt vmcnt(12)
    ds_read_b128 v[144:147], v56 offset:4096
    ds_read_b128 v[148:151], v57 offset:4096
    ds_read_b128 v[152:155], v58 offset:4096
    ds_read_b128 v[156:159], v59 offset:4096
    s_waitcnt vmcnt(10)
    ds_read_b64_tr_b16 v[120:121], v114 offset:4096
    ds_read_b64_tr_b16 v[122:123], v115 offset:4096
    ds_read_b64_tr_b16 v[124:125], v116 offset:4096
    ds_read_b64_tr_b16 v[126:127], v117 offset:4096
    s_barrier
    ds_read_b64_tr_b16 v[24:25], v7 offset:4096
    ds_read_b64_tr_b16 v[26:27], v8 offset:4096
    ds_read_b64_tr_b16 v[28:29], v9 offset:4096
    ds_read_b64_tr_b16 v[30:31], v10 offset:4096
    ds_read_b64_tr_b16 v[32:33], v7 offset:5120
    ds_read_b64_tr_b16 v[34:35], v8 offset:5120
    ds_read_b64_tr_b16 v[36:37], v9 offset:5120
    ds_read_b64_tr_b16 v[38:39], v10 offset:5120
    s_add_u32 s50, s64, 3
    s_and_b32 s50, s50, 7
    s_lshl_b32 s50, s50, 7
    s_add_u32 m0, s94, 12288
    s_add_u32 s50, s50, s92
    buffer_load_dwordx4 v16, s[8:11], s50 offen offset:0 lds
    s_waitcnt lgkmcnt(15)
    v_mfma_f32_32x32x16_bf16 v[64:79], v[40:43], v[136:139], v[64:79]
    s_addk_i32 s50, 7168
    buffer_load_dwordx4 v17, s[8:11], s50 offen offset:1024 lds
    v_mfma_f32_32x32x16_bf16 v[80:95], v[136:139], v[44:47], v[80:95]
    s_addk_i32 s50, 7168
    buffer_load_dwordx4 v16, s[8:11], s50 offen offset:2048 lds
    s_waitcnt lgkmcnt(15)
    v_mfma_f32_32x32x16_bf16 v[64:79], v[48:51], v[140:143], v[64:79]
    v_mfma_f32_32x32x16_bf16 v[80:95], v[140:143], v[52:55], v[80:95]
    s_addk_i32 s50, 7168
    buffer_load_dwordx4 v17, s[8:11], s50 offen offset:3072 lds
    s_waitcnt lgkmcnt(15)
    v_mfma_f32_32x32x16_bf16 v[96:111], v[144:147], v[144:147], v[96:111]
    s_add_u32 s50, s64, 4
    s_and_b32 s50, s50, 7
    s_mul_i32 s50, s50, 196608
    s_add_u32 m0, s98, 113664
    s_add_u32 s50, s50, s65
    buffer_load_dwordx4 v11, s[12:15], s50 offen offset:1024 lds
    v_mfma_f32_16x16x32_bf16 v[60:63], a[128:131], v[144:147], v[60:63]
    s_waitcnt lgkmcnt(14)
    v_mfma_f32_32x32x16_bf16 v[96:111], v[148:151], v[148:151], v[96:111]
    ds_read_b64_tr_b16 v[40:41], v7 offset:6144
    ds_read_b64_tr_b16 v[42:43], v8 offset:6144
    ds_read_b64_tr_b16 v[44:45], v9 offset:6144
    ds_read_b64_tr_b16 v[46:47], v10 offset:6144
    v_mfma_f32_16x16x32_bf16 v[60:63], a[128:131], v[148:151], v[60:63]
    s_waitcnt lgkmcnt(15)
    s_addk_i32 m0, 31744
    v_mfma_f32_32x32x16_bf16 v[96:111], v[152:155], v[152:155], v[96:111]
    buffer_load_dwordx4 v11, s[12:15], s50 offen offset:2048 lds
    ds_read_b64_tr_b16 v[48:49], v7 offset:7168
    ds_read_b64_tr_b16 v[50:51], v8 offset:7168
    ds_read_b64_tr_b16 v[52:53], v9 offset:7168
    ds_read_b64_tr_b16 v[54:55], v10 offset:7168
    v_mfma_f32_16x16x32_bf16 v[60:63], a[128:131], v[152:155], v[60:63]
    s_waitcnt lgkmcnt(15)
    v_mfma_f32_32x32x16_bf16 v[96:111], v[156:159], v[156:159], v[96:111]
    v_mov_b32 v20, -1
    v_mov_b32 v21, -1
    v_mov_b32 v22, -1
    v_mov_b32 v23, -1
    s_sub_u32 s46, 3, s3
    s_lshl_b32 s46, s46, 14
    s_add_u32 s46, s46, s59
    s_add_u32 s46, s46, s98
    s_add_u32 s46, s46, 4096
    s_cmp_eq_u32 s3, 2
    s_cselect_b32 s46, s99, s46
    s_cselect_b64 exec, 7, -1
    buffer_store_dwordx4 v[20:23], v4, s[36:39], s46 offen sc1
    s_mov_b64 exec, -1
    v_mfma_f32_16x16x32_bf16 v[60:63], a[128:131], v[156:159], v[60:63]
    s_waitcnt lgkmcnt(15)
    v_mfma_f32_16x16x32_bf16 v[60:63], a[136:139], v[120:123], v[60:63]
    v_mfma_f32_16x16x32_bf16 v[60:63], a[140:143], v[124:127], v[60:63]
    s_waitcnt lgkmcnt(12)
    v_mfma_f32_32x32x16_bf16 v[64:79], v[24:27], v[144:147], v[64:79]
    v_mfma_f32_32x32x16_bf16 v[80:95], v[144:147], v[28:31], v[80:95]
    s_waitcnt vmcnt(8)
    ds_read_b64_tr_b16 v[236:237], v231
    ds_read_b64_tr_b16 v[238:239], v231 offset:512
    s_waitcnt lgkmcnt(10)
    v_mfma_f32_32x32x16_bf16 v[64:79], v[32:35], v[148:151], v[64:79]
    s_waitcnt lgkmcnt(0)
    buffer_store_dwordx4 v[236:239], v4, s[36:39], s100 offen sc1
    v_mfma_f32_32x32x16_bf16 v[80:95], v[148:151], v[36:39], v[80:95]
    s_waitcnt vmcnt(12)
    ds_read_b128 v[160:163], v56 offset:8192
    ds_read_b128 v[164:167], v57 offset:8192
    ds_read_b128 v[168:171], v58 offset:8192
    ds_read_b128 v[172:175], v59 offset:8192
    ds_read_b64_tr_b16 v[120:121], v114 offset:8192
    ds_read_b64_tr_b16 v[122:123], v115 offset:8192
    ds_read_b64_tr_b16 v[124:125], v116 offset:8192
    ds_read_b64_tr_b16 v[126:127], v117 offset:8192
    s_barrier
    ds_read_b64_tr_b16 v[24:25], v7 offset:8192
    ds_read_b64_tr_b16 v[26:27], v8 offset:8192
    ds_read_b64_tr_b16 v[28:29], v9 offset:8192
    ds_read_b64_tr_b16 v[30:31], v10 offset:8192
    ds_read_b64_tr_b16 v[32:33], v7 offset:9216
    ds_read_b64_tr_b16 v[34:35], v8 offset:9216
    ds_read_b64_tr_b16 v[36:37], v9 offset:9216
    ds_read_b64_tr_b16 v[38:39], v10 offset:9216
    s_add_u32 s50, s64, 4
    s_and_b32 s50, s50, 7
    s_lshl_b32 s50, s50, 7
    s_add_u32 m0, s94, 0
    s_add_u32 s50, s50, s92
    buffer_load_dwordx4 v16, s[8:11], s50 offen offset:0 lds
    s_waitcnt lgkmcnt(15)
    v_mfma_f32_32x32x16_bf16 v[64:79], v[40:43], v[152:155], v[64:79]
    s_addk_i32 s50, 7168
    buffer_load_dwordx4 v17, s[8:11], s50 offen offset:1024 lds
    v_mfma_f32_32x32x16_bf16 v[80:95], v[152:155], v[44:47], v[80:95]
    s_addk_i32 s50, 7168
    buffer_load_dwordx4 v16, s[8:11], s50 offen offset:2048 lds
    s_waitcnt lgkmcnt(15)
    v_mfma_f32_32x32x16_bf16 v[64:79], v[48:51], v[156:159], v[64:79]
    s_addk_i32 s50, 7168
    buffer_load_dwordx4 v17, s[8:11], s50 offen offset:3072 lds
    v_mfma_f32_32x32x16_bf16 v[80:95], v[156:159], v[52:55], v[80:95]
    s_add_u32 s50, s64, 5
    s_and_b32 s50, s50, 7
    s_mul_i32 s50, s50, 196608
    s_add_u32 m0, s98, 117760
    s_add_u32 s50, s50, s65
    buffer_load_dwordx4 v11, s[12:15], s50 offen offset:1024 lds
    s_waitcnt lgkmcnt(15)
    s_addk_i32 m0, 31744
    v_mfma_f32_32x32x16_bf16 v[96:111], v[160:163], v[160:163], v[96:111]
    buffer_load_dwordx4 v11, s[12:15], s50 offen offset:2048 lds
    v_mfma_f32_16x16x32_bf16 v[60:63], a[128:131], v[160:163], v[60:63]
    s_waitcnt lgkmcnt(14)
    v_mfma_f32_32x32x16_bf16 v[96:111], v[164:167], v[164:167], v[96:111]
    ds_read_b64_tr_b16 v[40:41], v7 offset:10240
    ds_read_b64_tr_b16 v[42:43], v8 offset:10240
    ds_read_b64_tr_b16 v[44:45], v9 offset:10240
    ds_read_b64_tr_b16 v[46:47], v10 offset:10240
    v_mfma_f32_16x16x32_bf16 v[60:63], a[128:131], v[164:167], v[60:63]
    s_waitcnt lgkmcnt(15)
    v_mfma_f32_32x32x16_bf16 v[96:111], v[168:171], v[168:171], v[96:111]
    s_add_u32 s50, s64, 5
    s_and_b32 s50, s50, 7
    s_lshl_b32 s50, s50, 7
    s_add_u32 m0, s94, 4096
    s_add_u32 s50, s50, s92
    buffer_load_dwordx4 v16, s[8:11], s50 offen offset:0 lds
    ds_read_b64_tr_b16 v[48:49], v7 offset:11264
    ds_read_b64_tr_b16 v[50:51], v8 offset:11264
    ds_read_b64_tr_b16 v[52:53], v9 offset:11264
    ds_read_b64_tr_b16 v[54:55], v10 offset:11264
    v_mfma_f32_16x16x32_bf16 v[60:63], a[128:131], v[168:171], v[60:63]
    s_waitcnt lgkmcnt(15)
    v_mfma_f32_32x32x16_bf16 v[96:111], v[172:175], v[172:175], v[96:111]
    s_addk_i32 s50, 7168
    buffer_load_dwordx4 v17, s[8:11], s50 offen offset:1024 lds
    v_mfma_f32_16x16x32_bf16 v[60:63], a[128:131], v[172:175], v[60:63]
    s_waitcnt lgkmcnt(15)
    v_mfma_f32_16x16x32_bf16 v[60:63], a[136:139], v[120:123], v[60:63]
    v_mfma_f32_16x16x32_bf16 v[60:63], a[140:143], v[124:127], v[60:63]
    s_waitcnt lgkmcnt(12)
    v_mfma_f32_32x32x16_bf16 v[64:79], v[24:27], v[160:163], v[64:79]
    s_addk_i32 s50, 7168
    buffer_load_dwordx4 v16, s[8:11], s50 offen offset:2048 lds
    v_mfma_f32_32x32x16_bf16 v[80:95], v[160:163], v[28:31], v[80:95]
    s_addk_i32 s50, 7168
    buffer_load_dwordx4 v17, s[8:11], s50 offen offset:3072 lds
    s_waitcnt lgkmcnt(8)
    v_mfma_f32_32x32x16_bf16 v[64:79], v[32:35], v[164:167], v[64:79]
    s_waitcnt vmcnt(10)
    v_mfma_f32_32x32x16_bf16 v[80:95], v[164:167], v[36:39], v[80:95]
    s_waitcnt vmcnt(14)
    ds_read_b128 v[176:179], v56 offset:12288
    ds_read_b128 v[180:183], v57 offset:12288
    ds_read_b128 v[184:187], v58 offset:12288
    ds_read_b128 v[188:191], v59 offset:12288
    ds_read_b64_tr_b16 v[120:121], v114 offset:12288
    ds_read_b64_tr_b16 v[122:123], v115 offset:12288
    ds_read_b64_tr_b16 v[124:125], v116 offset:12288
    ds_read_b64_tr_b16 v[126:127], v117 offset:12288
    s_barrier
    ds_read_b64_tr_b16 v[24:25], v7 offset:12288
    ds_read_b64_tr_b16 v[26:27], v8 offset:12288
    ds_read_b64_tr_b16 v[28:29], v9 offset:12288
    ds_read_b64_tr_b16 v[30:31], v10 offset:12288
    ds_read_b64_tr_b16 v[32:33], v7 offset:13312
    ds_read_b64_tr_b16 v[34:35], v8 offset:13312
    ds_read_b64_tr_b16 v[36:37], v9 offset:13312
    ds_read_b64_tr_b16 v[38:39], v10 offset:13312
    s_cmp_lg_u32 s3, 0
    s_cbranch_scc1 L_hs_3
    v_mov_b32 v14, s93
    v_mov_b32 v20, 0
    s_mov_b64 exec, 1
    buffer_atomic_or v14, v20, s[32:35], s95 offen sc1
    s_mov_b64 exec, -1
L_hs_3:
    s_waitcnt lgkmcnt(15)
    v_mfma_f32_32x32x16_bf16 v[64:79], v[40:43], v[168:171], v[64:79]
    s_add_u32 s50, s64, 6
    s_and_b32 s50, s50, 7
    s_mul_i32 s50, s50, 196608
    s_add_u32 m0, s98, 121856
    s_add_u32 s50, s50, s65
    buffer_load_dwordx4 v11, s[12:15], s50 offen offset:1024 lds
    s_addk_i32 m0, 31744
    v_mfma_f32_32x32x16_bf16 v[80:95], v[168:171], v[44:47], v[80:95]
    buffer_load_dwordx4 v11, s[12:15], s50 offen offset:2048 lds
    s_waitcnt lgkmcnt(15)
    v_mfma_f32_32x32x16_bf16 v[64:79], v[48:51], v[172:175], v[64:79]
    v_mfma_f32_32x32x16_bf16 v[80:95], v[172:175], v[52:55], v[80:95]
    s_add_u32 s50, s64, 7
    s_and_b32 s50, s50, 7
    s_mul_i32 s50, s50, 196608
    s_add_u32 m0, s98, 125952
    s_add_u32 s50, s50, s65
    buffer_load_dwordx4 v11, s[12:15], s50 offen offset:1024 lds
    s_waitcnt lgkmcnt(15)
    s_addk_i32 m0, 31744
    v_mfma_f32_32x32x16_bf16 v[96:111], v[176:179], v[176:179], v[96:111]
    buffer_load_dwordx4 v11, s[12:15], s50 offen offset:2048 lds
    v_mfma_f32_16x16x32_bf16 v[60:63], a[128:131], v[176:179], v[60:63]
    s_waitcnt lgkmcnt(14)
    v_mfma_f32_32x32x16_bf16 v[96:111], v[180:183], v[180:183], v[96:111]
    ds_read_b64_tr_b16 v[40:41], v7 offset:14336
    ds_read_b64_tr_b16 v[42:43], v8 offset:14336
    ds_read_b64_tr_b16 v[44:45], v9 offset:14336
    ds_read_b64_tr_b16 v[46:47], v10 offset:14336
    v_mfma_f32_16x16x32_bf16 v[60:63], a[128:131], v[180:183], v[60:63]
    s_waitcnt lgkmcnt(15)
    v_mfma_f32_32x32x16_bf16 v[96:111], v[184:187], v[184:187], v[96:111]
    s_add_u32 s50, s64, 6
    s_and_b32 s50, s50, 7
    s_lshl_b32 s50, s50, 7
    s_add_u32 m0, s94, 8192
    s_add_u32 s50, s50, s92
    buffer_load_dwordx4 v16, s[8:11], s50 offen offset:0 lds
    ds_read_b64_tr_b16 v[48:49], v7 offset:15360
    ds_read_b64_tr_b16 v[50:51], v8 offset:15360
    ds_read_b64_tr_b16 v[52:53], v9 offset:15360
    ds_read_b64_tr_b16 v[54:55], v10 offset:15360
    v_mfma_f32_16x16x32_bf16 v[60:63], a[128:131], v[184:187], v[60:63]
    s_waitcnt lgkmcnt(15)
    v_mfma_f32_32x32x16_bf16 v[96:111], v[188:191], v[188:191], v[96:111]
    s_addk_i32 s50, 7168
    buffer_load_dwordx4 v17, s[8:11], s50 offen offset:1024 lds
    v_mfma_f32_16x16x32_bf16 v[60:63], a[128:131], v[188:191], v[60:63]
    s_waitcnt lgkmcnt(15)
    v_mfma_f32_16x16x32_bf16 v[60:63], a[136:139], v[120:123], v[60:63]
    v_mfma_f32_16x16x32_bf16 v[60:63], a[140:143], v[124:127], v[60:63]
    s_waitcnt lgkmcnt(12)
    v_mfma_f32_32x32x16_bf16 v[64:79], v[24:27], v[176:179], v[64:79]
    v_mfma_f32_32x32x16_bf16 v[80:95], v[176:179], v[28:31], v[80:95]
    s_addk_i32 s50, 7168
    buffer_load_dwordx4 v16, s[8:11], s50 offen offset:2048 lds
    s_waitcnt lgkmcnt(8)
    v_mfma_f32_32x32x16_bf16 v[64:79], v[32:35], v[180:183], v[64:79]
    s_addk_i32 s50, 7168
    buffer_load_dwordx4 v17, s[8:11], s50 offen offset:3072 lds
    v_mfma_f32_32x32x16_bf16 v[80:95], v[180:183], v[36:39], v[80:95]
    s_waitcnt vmcnt(14)
    ds_read_b128 v[192:195], v56 offset:0
    ds_read_b128 v[196:199], v57 offset:0
    ds_read_b128 v[200:203], v58 offset:0
    ds_read_b128 v[204:207], v59 offset:0
    ds_read_b64_tr_b16 v[120:121], v114 offset:16384
    ds_read_b64_tr_b16 v[122:123], v115 offset:16384
    ds_read_b64_tr_b16 v[124:125], v116 offset:16384
    ds_read_b64_tr_b16 v[126:127], v117 offset:16384
    s_barrier
    ds_read_b64_tr_b16 v[24:25], v7 offset:16384
    ds_read_b64_tr_b16 v[26:27], v8 offset:16384
    ds_read_b64_tr_b16 v[28:29], v9 offset:16384
    ds_read_b64_tr_b16 v[30:31], v10 offset:16384
    ds_read_b64_tr_b16 v[32:33], v7 offset:17408
    ds_read_b64_tr_b16 v[34:35], v8 offset:17408
    ds_read_b64_tr_b16 v[36:37], v9 offset:17408
    ds_read_b64_tr_b16 v[38:39], v10 offset:17408
    s_add_u32 s50, s64, 7
    s_and_b32 s50, s50, 7
    s_lshl_b32 s50, s50, 7
    s_add_u32 m0, s94, 12288
    s_add_u32 s50, s50, s92
    buffer_load_dwordx4 v16, s[8:11], s50 offen offset:0 lds
    s_waitcnt lgkmcnt(15)
    v_mfma_f32_32x32x16_bf16 v[64:79], v[40:43], v[184:187], v[64:79]
    s_addk_i32 s50, 7168
    buffer_load_dwordx4 v17, s[8:11], s50 offen offset:1024 lds
    v_mfma_f32_32x32x16_bf16 v[80:95], v[184:187], v[44:47], v[80:95]
    s_waitcnt lgkmcnt(15)
    v_mfma_f32_32x32x16_bf16 v[64:79], v[48:51], v[188:191], v[64:79]
    s_addk_i32 s50, 7168
    buffer_load_dwordx4 v16, s[8:11], s50 offen offset:2048 lds
    v_mfma_f32_32x32x16_bf16 v[80:95], v[188:191], v[52:55], v[80:95]
    s_addk_i32 s50, 7168
    buffer_load_dwordx4 v17, s[8:11], s50 offen offset:3072 lds
    s_waitcnt lgkmcnt(15)
    v_mfma_f32_32x32x16_bf16 v[96:111], v[192:195], v[192:195], v[96:111]
    v_mfma_f32_16x16x32_bf16 v[60:63], a[128:131], v[192:195], v[60:63]
    s_waitcnt lgkmcnt(14)
    v_mfma_f32_32x32x16_bf16 v[96:111], v[196:199], v[196:199], v[96:111]
    s_add_u32 s50, s64, 0
    s_and_b32 s50, s50, 7
    s_mul_i32 s50, s50, 196608
    s_add_u32 m0, s98, 65536
    s_add_u32 s50, s50, s65
    buffer_load_dwordx4 v11, s[12:15], s50 offen offset:0 lds
    ds_read_b64_tr_b16 v[40:41], v7 offset:18432
    ds_read_b64_tr_b16 v[42:43], v8 offset:18432
    ds_read_b64_tr_b16 v[44:45], v9 offset:18432
    ds_read_b64_tr_b16 v[46:47], v10 offset:18432
    v_mfma_f32_16x16x32_bf16 v[60:63], a[128:131], v[196:199], v[60:63]
    s_waitcnt lgkmcnt(15)
    v_mfma_f32_32x32x16_bf16 v[96:111], v[200:203], v[200:203], v[96:111]
    ds_read_b64_tr_b16 v[48:49], v7 offset:19456
    ds_read_b64_tr_b16 v[50:51], v8 offset:19456
    ds_read_b64_tr_b16 v[52:53], v9 offset:19456
    ds_read_b64_tr_b16 v[54:55], v10 offset:19456
    v_mfma_f32_16x16x32_bf16 v[60:63], a[128:131], v[200:203], v[60:63]
    s_waitcnt lgkmcnt(15)
    v_mfma_f32_32x32x16_bf16 v[96:111], v[204:207], v[204:207], v[96:111]
    s_add_u32 s50, s64, 1
    s_and_b32 s50, s50, 7
    s_mul_i32 s50, s50, 196608
    s_add_u32 m0, s98, 69632
    s_add_u32 s50, s50, s65
    buffer_load_dwordx4 v11, s[12:15], s50 offen offset:0 lds
    v_mfma_f32_16x16x32_bf16 v[60:63], a[128:131], v[204:207], v[60:63]
    s_waitcnt lgkmcnt(15)
    v_mfma_f32_16x16x32_bf16 v[60:63], a[136:139], v[120:123], v[60:63]
    v_mfma_f32_16x16x32_bf16 v[60:63], a[140:143], v[124:127], v[60:63]
    s_waitcnt lgkmcnt(12)
    v_mfma_f32_32x32x16_bf16 v[64:79], v[24:27], v[192:195], v[64:79]
    s_add_u32 s50, s64, 2
    s_and_b32 s50, s50, 7
    s_mul_i32 s50, s50, 196608
    s_add_u32 m0, s98, 73728
    s_add_u32 s50, s50, s65
    buffer_load_dwordx4 v11, s[12:15], s50 offen offset:0 lds
    v_mfma_f32_32x32x16_bf16 v[80:95], v[192:195], v[28:31], v[80:95]
    s_waitcnt lgkmcnt(8)
    v_mfma_f32_32x32x16_bf16 v[64:79], v[32:35], v[196:199], v[64:79]
    s_add_u32 s50, s64, 3
    s_and_b32 s50, s50, 7
    s_mul_i32 s50, s50, 196608
    s_add_u32 m0, s98, 77824
    s_add_u32 s50, s50, s65
    buffer_load_dwordx4 v11, s[12:15], s50 offen offset:0 lds
    v_mfma_f32_32x32x16_bf16 v[80:95], v[196:199], v[36:39], v[80:95]
    s_waitcnt vmcnt(16)
    ds_read_b128 v[208:211], v56 offset:4096
    ds_read_b128 v[212:215], v57 offset:4096
    ds_read_b128 v[216:219], v58 offset:4096
    ds_read_b128 v[220:223], v59 offset:4096
    ds_read_b64_tr_b16 v[120:121], v114 offset:20480
    ds_read_b64_tr_b16 v[122:123], v115 offset:20480
    ds_read_b64_tr_b16 v[124:125], v116 offset:20480
    ds_read_b64_tr_b16 v[126:127], v117 offset:20480
    s_barrier
    ds_read_b64_tr_b16 v[24:25], v7 offset:20480
    ds_read_b64_tr_b16 v[26:27], v8 offset:20480
    ds_read_b64_tr_b16 v[28:29], v9 offset:20480
    ds_read_b64_tr_b16 v[30:31], v10 offset:20480
    ds_read_b64_tr_b16 v[32:33], v7 offset:21504
    ds_read_b64_tr_b16 v[34:35], v8 offset:21504
    ds_read_b64_tr_b16 v[36:37], v9 offset:21504
    ds_read_b64_tr_b16 v[38:39], v10 offset:21504
    s_add_u32 s50, s64, 4
    s_and_b32 s50, s50, 7
    s_mul_i32 s50, s50, 196608
    s_add_u32 m0, s98, 81920
    s_add_u32 s50, s50, s65
    buffer_load_dwordx4 v11, s[12:15], s50 offen offset:0 lds
    s_waitcnt lgkmcnt(15)
    v_mfma_f32_32x32x16_bf16 v[64:79], v[40:43], v[200:203], v[64:79]
    v_mfma_f32_32x32x16_bf16 v[80:95], v[200:203], v[44:47], v[80:95]
    s_add_u32 s50, s64, 5
    s_and_b32 s50, s50, 7
    s_mul_i32 s50, s50, 196608
    s_add_u32 m0, s98, 86016
    s_add_u32 s50, s50, s65
    buffer_load_dwordx4 v11, s[12:15], s50 offen offset:0 lds
    s_waitcnt lgkmcnt(15)
    v_mfma_f32_32x32x16_bf16 v[64:79], v[48:51], v[204:207], v[64:79]
    v_mfma_f32_32x32x16_bf16 v[80:95], v[204:207], v[52:55], v[80:95]
    s_add_u32 s50, s64, 6
    s_and_b32 s50, s50, 7
    s_mul_i32 s50, s50, 196608
    s_add_u32 m0, s98, 90112
    s_add_u32 s50, s50, s65
    buffer_load_dwordx4 v11, s[12:15], s50 offen offset:0 lds
    s_waitcnt lgkmcnt(15)
    v_mfma_f32_32x32x16_bf16 v[96:111], v[208:211], v[208:211], v[96:111]
    v_mfma_f32_16x16x32_bf16 v[60:63], a[128:131], v[208:211], v[60:63]
    s_waitcnt lgkmcnt(14)
    v_mfma_f32_32x32x16_bf16 v[96:111], v[212:215], v[212:215], v[96:111]
    s_add_u32 s50, s64, 7
    s_and_b32 s50, s50, 7
    s_mul_i32 s50, s50, 196608
    s_add_u32 m0, s98, 94208
    s_add_u32 s50, s50, s65
    buffer_load_dwordx4 v11, s[12:15], s50 offen offset:0 lds
    ds_read_b64_tr_b16 v[40:41], v7 offset:22528
    ds_read_b64_tr_b16 v[42:43], v8 offset:22528
    ds_read_b64_tr_b16 v[44:45], v9 offset:22528
    ds_read_b64_tr_b16 v[46:47], v10 offset:22528
    v_mfma_f32_16x16x32_bf16 v[60:63], a[128:131], v[212:215], v[60:63]
    s_waitcnt lgkmcnt(15)
    v_mfma_f32_32x32x16_bf16 v[96:111], v[216:219], v[216:219], v[96:111]
    ds_read_b64_tr_b16 v[48:49], v7 offset:23552
    ds_read_b64_tr_b16 v[50:51], v8 offset:23552
    ds_read_b64_tr_b16 v[52:53], v9 offset:23552
    ds_read_b64_tr_b16 v[54:55], v10 offset:23552
    v_mfma_f32_16x16x32_bf16 v[60:63], a[128:131], v[216:219], v[60:63]
    s_waitcnt lgkmcnt(15)
    v_mfma_f32_32x32x16_bf16 v[96:111], v[220:223], v[220:223], v[96:111]
    s_lshr_b32 s101, s2, 3
    s_lshl_b32 s101, s101, 2
    s_add_u32 s101, s101, s3
    s_mul_i32 s101, s101, 12288
    v_min_u32 v19, 47, v1
    v_lshlrev_b32 v19, 7, v19
    buffer_load_dword a144, v19, s[16:19], s101 offen
    v_mfma_f32_16x16x32_bf16 v[60:63], a[128:131], v[220:223], v[60:63]
    s_waitcnt lgkmcnt(15)
    v_mfma_f32_16x16x32_bf16 v[60:63], a[136:139], v[120:123], v[60:63]
    v_mfma_f32_16x16x32_bf16 v[60:63], a[140:143], v[124:127], v[60:63]
    s_waitcnt lgkmcnt(12)
    v_mfma_f32_32x32x16_bf16 v[64:79], v[24:27], v[208:211], v[64:79]
    v_mfma_f32_32x32x16_bf16 v[80:95], v[208:211], v[28:31], v[80:95]
    s_add_u32 s101, s101, 6144
    buffer_load_dword a144, v19, s[16:19], s101 offen
    s_waitcnt lgkmcnt(8)
    v_mfma_f32_32x32x16_bf16 v[64:79], v[32:35], v[212:215], v[64:79]
    v_mfma_f32_32x32x16_bf16 v[80:95], v[212:215], v[36:39], v[80:95]
    s_waitcnt vmcnt(14)
    ds_read_b128 v[224:227], v56 offset:8192
    ds_read_b128 v[228:231], v57 offset:8192
    ds_read_b128 v[232:235], v58 offset:8192
    ds_read_b128 v[236:239], v59 offset:8192
    ds_read_b64_tr_b16 v[120:121], v114 offset:24576
    ds_read_b64_tr_b16 v[122:123], v115 offset:24576
    ds_read_b64_tr_b16 v[124:125], v116 offset:24576
    ds_read_b64_tr_b16 v[126:127], v117 offset:24576
    s_barrier
    ds_read_b64_tr_b16 v[24:25], v7 offset:24576
    ds_read_b64_tr_b16 v[26:27], v8 offset:24576
    ds_read_b64_tr_b16 v[28:29], v9 offset:24576
    ds_read_b64_tr_b16 v[30:31], v10 offset:24576
    ds_read_b64_tr_b16 v[32:33], v7 offset:25600
    ds_read_b64_tr_b16 v[34:35], v8 offset:25600
    ds_read_b64_tr_b16 v[36:37], v9 offset:25600
    ds_read_b64_tr_b16 v[38:39], v10 offset:25600
    s_waitcnt lgkmcnt(15)
    v_mfma_f32_32x32x16_bf16 v[64:79], v[40:43], v[216:219], v[64:79]
    v_mfma_f32_32x32x16_bf16 v[80:95], v[216:219], v[44:47], v[80:95]
    s_waitcnt lgkmcnt(15)
    v_mfma_f32_32x32x16_bf16 v[64:79], v[48:51], v[220:223], v[64:79]
    v_mfma_f32_32x32x16_bf16 v[80:95], v[220:223], v[52:55], v[80:95]
    s_waitcnt lgkmcnt(15)
    v_mfma_f32_32x32x16_bf16 v[96:111], v[224:227], v[224:227], v[96:111]
    v_mfma_f32_16x16x32_bf16 v[60:63], a[128:131], v[224:227], v[60:63]
    s_waitcnt lgkmcnt(14)
    v_mfma_f32_32x32x16_bf16 v[96:111], v[228:231], v[228:231], v[96:111]
    ds_read_b64_tr_b16 v[40:41], v7 offset:26624
    ds_read_b64_tr_b16 v[42:43], v8 offset:26624
    ds_read_b64_tr_b16 v[44:45], v9 offset:26624
    ds_read_b64_tr_b16 v[46:47], v10 offset:26624
    v_mfma_f32_16x16x32_bf16 v[60:63], a[128:131], v[228:231], v[60:63]
    s_waitcnt lgkmcnt(15)
    v_mfma_f32_32x32x16_bf16 v[96:111], v[232:235], v[232:235], v[96:111]
    ds_read_b64_tr_b16 v[48:49], v7 offset:27648
    ds_read_b64_tr_b16 v[50:51], v8 offset:27648
    ds_read_b64_tr_b16 v[52:53], v9 offset:27648
    ds_read_b64_tr_b16 v[54:55], v10 offset:27648
    v_mfma_f32_16x16x32_bf16 v[60:63], a[128:131], v[232:235], v[60:63]
    s_waitcnt lgkmcnt(15)
    v_mfma_f32_32x32x16_bf16 v[96:111], v[236:239], v[236:239], v[96:111]
    v_mfma_f32_16x16x32_bf16 v[60:63], a[128:131], v[236:239], v[60:63]
    s_waitcnt lgkmcnt(15)
    v_mfma_f32_16x16x32_bf16 v[60:63], a[136:139], v[120:123], v[60:63]
    v_mfma_f32_16x16x32_bf16 v[60:63], a[140:143], v[124:127], v[60:63]
    ds_read_b64_tr_b16 v[244:245], v114 offset:28672
    ds_read_b64_tr_b16 v[246:247], v115 offset:28672
    ds_read_b64_tr_b16 v[248:249], v116 offset:28672
    ds_read_b64_tr_b16 v[250:251], v117 offset:28672
    s_waitcnt lgkmcnt(15)
    v_mfma_f32_32x32x16_bf16 v[64:79], v[24:27], v[224:227], v[64:79]
    v_mfma_f32_32x32x16_bf16 v[80:95], v[224:227], v[28:31], v[80:95]
    s_waitcnt lgkmcnt(0)
    v_mfma_f32_16x16x32_bf16 v[60:63], a[136:139], v[244:247], v[60:63]
    v_mfma_f32_16x16x32_bf16 v[60:63], a[140:143], v[248:251], v[60:63]
    s_waitcnt lgkmcnt(12)
    v_mfma_f32_32x32x16_bf16 v[64:79], v[32:35], v[228:231], v[64:79]
    v_mfma_f32_32x32x16_bf16 v[80:95], v[228:231], v[36:39], v[80:95]
    v_lshlrev_b32 v14, 2, v1
    s_lshl_b32 s46, s3, 8
    v_add_u32 v14, s46, v14
    s_nop 2
    ds_write_b32 v14, v62 offset:1024
    ds_write_b32 v14, v63 offset:2048
    s_waitcnt lgkmcnt(0) vmcnt(10)
    ds_read_b128 v[240:243], v56 offset:12288
    ds_read_b128 v[244:247], v57 offset:12288
    ds_read_b128 v[248:251], v58 offset:12288
    ds_read_b128 v[252:255], v59 offset:12288
    ds_read_b64_tr_b16 v[24:25], v7 offset:28672
    ds_read_b64_tr_b16 v[26:27], v8 offset:28672
    ds_read_b64_tr_b16 v[28:29], v9 offset:28672
    ds_read_b64_tr_b16 v[30:31], v10 offset:28672
    ds_read_b64_tr_b16 v[32:33], v7 offset:29696
    ds_read_b64_tr_b16 v[34:35], v8 offset:29696
    ds_read_b64_tr_b16 v[36:37], v9 offset:29696
    ds_read_b64_tr_b16 v[38:39], v10 offset:29696
    s_barrier
    v_lshlrev_b32 v18, 2, v2
    ds_read_b32 v116, v18 offset:1024
    ds_read_b32 v117, v18 offset:1280
    ds_read_b32 v118, v18 offset:1536
    ds_read_b32 v119, v18 offset:1792
    ds_read_b32 v120, v18 offset:2048
    ds_read_b32 v121, v18 offset:2304
    ds_read_b32 v122, v18 offset:2560
    ds_read_b32 v123, v18 offset:2816
    s_waitcnt lgkmcnt(15)
    v_mfma_f32_32x32x16_bf16 v[96:111], v[240:243], v[240:243], v[96:111]
    v_mfma_f32_16x16x32_bf16 v[60:63], a[128:131], v[240:243], v[60:63]
    s_waitcnt lgkmcnt(15)
    v_mfma_f32_32x32x16_bf16 v[96:111], v[244:247], v[244:247], v[96:111]
    s_waitcnt lgkmcnt(0)
    v_add_f32 v116, v116, v117
    v_add_f32 v118, v118, v119
    v_add_f32 v116, v116, v118
    v_cvt_pk_bf16_f32 v117, v116, v116
    v_mfma_f32_16x16x32_bf16 v[60:63], a[128:131], v[244:247], v[60:63]
    v_and_b32 v118, 0xffff0000, v117
    v_sub_f32 v119, v116, v118
    s_waitcnt lgkmcnt(15)
    v_mfma_f32_32x32x16_bf16 v[96:111], v[248:251], v[248:251], v[96:111]
    v_cvt_pk_bf16_f32 v117, v119, v119
    v_and_b32 v117, 0xffff0000, v117
    v_sub_f32 v119, v119, v117
    v_cvt_pk_bf16_f32 v119, v119, v119
    v_lshrrev_b32 v56, 16, v118
    v_mfma_f32_16x16x32_bf16 v[60:63], a[128:131], v[248:251], v[60:63]
    v_or_b32 v56, v56, v117
    v_and_b32 v57, 0xffff, v119
    s_waitcnt lgkmcnt(15)
    v_mfma_f32_32x32x16_bf16 v[96:111], v[252:255], v[252:255], v[96:111]
    v_mov_b32 v58, 0
    v_mov_b32 v59, 0
    v_add_f32 v120, v120, v121
    v_add_f32 v122, v122, v123
    v_add_f32 v120, v120, v122
    v_mfma_f32_16x16x32_bf16 v[60:63], a[128:131], v[252:255], v[60:63]
    v_cvt_pk_bf16_f32 v121, v120, v120
    v_and_b32 v122, 0xffff0000, v121
    s_waitcnt lgkmcnt(15)
    v_mfma_f32_32x32x16_bf16 v[64:79], v[40:43], v[232:235], v[64:79]
    v_sub_f32 v123, v120, v122
    v_cvt_pk_bf16_f32 v121, v123, v123
    v_and_b32 v121, 0xffff0000, v121
    v_sub_f32 v123, v123, v121
    v_cvt_pk_bf16_f32 v123, v123, v123
    v_lshrrev_b32 v124, 16, v122
    v_or_b32 v124, v124, v121
    v_mfma_f32_32x32x16_bf16 v[80:95], v[232:235], v[44:47], v[80:95]
    v_and_b32 v125, 0xffff, v123
    ds_write_b64 v15, v[56:57] offset:256
    ds_write_b64 v15, v[124:125] offset:512
    s_mov_b32 vcc_lo, 0xaaaaaaaa
    s_mov_b32 vcc_hi, 0xaaaaaaaa
    v_cndmask_b32 v96, v96, v97, vcc
    v_cndmask_b32 v98, v98, v99, vcc
    ds_read_b64_tr_b16 v[40:41], v7 offset:30720
    ds_read_b64_tr_b16 v[42:43], v8 offset:30720
    ds_read_b64_tr_b16 v[44:45], v9 offset:30720
    ds_read_b64_tr_b16 v[46:47], v10 offset:30720
    s_waitcnt lgkmcnt(15)
    v_mfma_f32_32x32x16_bf16 v[64:79], v[48:51], v[236:239], v[64:79]
    v_cndmask_b32 v100, v100, v101, vcc
    v_cndmask_b32 v102, v102, v103, vcc
    v_cndmask_b32 v104, v104, v105, vcc
    v_cndmask_b32 v106, v106, v107, vcc
    v_cndmask_b32 v108, v108, v109, vcc
    v_cndmask_b32 v110, v110, v111, vcc
    s_mov_b32 vcc_lo, 0xcccccccc
    v_mfma_f32_32x32x16_bf16 v[80:95], v[236:239], v[52:55], v[80:95]
    s_mov_b32 vcc_hi, 0xcccccccc
    v_cndmask_b32 v96, v96, v98, vcc
    v_cndmask_b32 v100, v100, v102, vcc
    v_cndmask_b32 v104, v104, v106, vcc
    v_cndmask_b32 v108, v108, v110, vcc
    s_mov_b32 vcc_lo, 0xff00ff00
    s_mov_b32 vcc_hi, 0xff00ff00
    ds_read_b64_tr_b16 v[48:49], v7 offset:31744
    ds_read_b64_tr_b16 v[50:51], v8 offset:31744
    ds_read_b64_tr_b16 v[52:53], v9 offset:31744
    ds_read_b64_tr_b16 v[54:55], v10 offset:31744
    s_waitcnt lgkmcnt(15)
    v_mfma_f32_32x32x16_bf16 v[64:79], v[24:27], v[240:243], v[64:79]
    v_cndmask_b32 v96, v96, v100, vcc
    v_cndmask_b32 v104, v104, v108, vcc
    s_mov_b32 vcc_lo, 0xffff0000
    s_mov_b32 vcc_hi, 0xffff0000
    v_cndmask_b32 v96, v96, v104, vcc
    s_mov_b32 vcc_lo, 0x0f0f0f0f
    s_mov_b32 vcc_hi, 0xf0f0f0f0
    v_mfma_f32_32x32x16_bf16 v[80:95], v[240:243], v[28:31], v[80:95]
    v_cndmask_b32 v113, 0, v96, vcc
    v_mul_f32 v112, 0.5, v60
    v_mov_b32 v114, v112
    v_mov_b32 v115, v113
    v_mov_b32 v60, v124
    v_mov_b32 v61, v125
    v_permlane32_swap_b32 v112, v114
    s_waitcnt lgkmcnt(15)
    v_mfma_f32_32x32x16_bf16 v[64:79], v[32:35], v[244:247], v[64:79]
    v_permlane32_swap_b32 v113, v115
    s_lshl_b32 s46, s3, 7
    v_lshlrev_b32 v14, 2, v2
    v_add_f32 v112, v112, v114
    v_add_f32 v113, v113, v115
    v_mul_f32 v112, 0x3b000000, v112
    v_mul_f32 v113, 0x3b000000, v113
    v_mfma_f32_32x32x16_bf16 v[80:95], v[244:247], v[36:39], v[80:95]
    v_fma_f32 v113, -v112, v112, v113
    v_max_f32 v113, 0, v113
    v_cvt_pk_bf16_f32 v114, v112, v113
    v_and_b32 v115, 0xffff0000, v114
    v_add_f32 v115, 0x3727c5ac, v115
    v_cvt_pk_bf16_f32 v115, v115, v115
    v_and_b32 v115, 0xffff0000, v115
    s_waitcnt lgkmcnt(4)
    v_mfma_f32_32x32x16_bf16 v[64:79], v[40:43], v[248:251], v[64:79]
    v_sqrt_f32 v115, v115
    v_and_b32 v114, 0xffff, v114
    v_xor_b32 v114, 0x8000, v114
    v_cvt_pk_bf16_f32 v115, v115, v115
    v_and_b32 v115, 0xffff0000, v115
    v_rcp_f32 v12, v115
    v_cndmask_b32_e64 v17, 0, v114, s[66:67]
    v_mfma_f32_32x32x16_bf16 v[80:95], v[248:251], v[44:47], v[80:95]
    v_lshl_or_b32 v16, v17, 16, v17
    v_add_u32 v14, s46, v14
    v_mul_f32 v13, 0x3eb8aa3b, v12
    v_lshlrev_b32 v21, 4, v3
    v_add_u32 v21, s46, v21
    ds_write_b32 v14, v12 offset:59392
    ds_read_b128 v[112:115], v21 offset:59392
    s_waitcnt lgkmcnt(2)
    v_mfma_f32_32x32x16_bf16 v[64:79], v[48:51], v[252:255], v[64:79]
    ds_read_b128 v[116:119], v21 offset:59424
    ds_read_b128 v[120:123], v21 offset:59456
    ds_read_b128 v[124:127], v21 offset:59488
    v_mov_b32 v18, 0
    v_mov_b32 v19, 0
    v_mov_b32 v62, 0
    v_mov_b32 v63, 0
    v_mfma_f32_32x32x16_bf16 v[80:95], v[252:255], v[52:55], v[80:95]
    s_nop 0
    v_mfma_f32_32x32x16_bf16 v[64:79], v[56:59], v[16:19], v[64:79]
    v_mfma_f32_32x32x16_bf16 v[80:95], v[16:19], v[60:63], v[80:95]
    s_barrier
    s_lshl_b32 s46, s3, 8
    v_lshlrev_b32 v14, 2, v1
    buffer_load_dword v20, v14, s[32:35], s46 offen sc1
    s_nop 6
    v_mul_f32 v64, v12, v64
    v_mul_f32 v65, v12, v65
    v_mul_f32 v66, v12, v66
    v_mul_f32 v67, v12, v67
    v_mul_f32 v68, v12, v68
    v_mul_f32 v69, v12, v69
    v_mul_f32 v70, v12, v70
    v_mul_f32 v71, v12, v71
    v_add_u32 v65, 0x10000, v65
    v_and_b32 v65, 0xfffe0000, v65
    v_cvt_pk_bf16_f32 v64, v64, v65
    v_cvt_pk_bf16_f32 v65, v66, v67
    v_cvt_pk_bf16_f32 v66, v68, v69
    v_cvt_pk_bf16_f32 v67, v70, v71
    v_and_b32 v64, 0xfffeffff, v64
    buffer_store_dwordx4 v[64:67], v4, s[36:39], s59 offen offset:0 sc1
    v_mul_f32 v72, v12, v72
    v_mul_f32 v73, v12, v73
    v_mul_f32 v74, v12, v74
    v_mul_f32 v75, v12, v75
    v_mul_f32 v76, v12, v76
    v_mul_f32 v77, v12, v77
    v_mul_f32 v78, v12, v78
    v_mul_f32 v79, v12, v79
    v_add_u32 v73, 0x10000, v73
    v_and_b32 v73, 0xfffe0000, v73
    v_cvt_pk_bf16_f32 v68, v72, v73
    v_cvt_pk_bf16_f32 v69, v74, v75
    v_cvt_pk_bf16_f32 v70, v76, v77
    v_cvt_pk_bf16_f32 v71, v78, v79
    v_and_b32 v68, 0xfffeffff, v68
    buffer_store_dwordx4 v[68:71], v4, s[36:39], s59 offen offset:1024 sc1
    s_waitcnt lgkmcnt(0)
    v_mul_f32 v80, v112, v80
    v_mul_f32 v81, v113, v81
    v_mul_f32 v82, v114, v82
    v_mul_f32 v83, v115, v83
    v_mul_f32 v84, v116, v84
    v_mul_f32 v85, v117, v85
    v_mul_f32 v86, v118, v86
    v_mul_f32 v87, v119, v87
    v_add_u32 v81, 0x10000, v81
    v_and_b32 v81, 0xfffe0000, v81
    v_cvt_pk_bf16_f32 v80, v80, v81
    v_cvt_pk_bf16_f32 v81, v82, v83
    v_cvt_pk_bf16_f32 v82, v84, v85
    v_cvt_pk_bf16_f32 v83, v86, v87
    v_and_b32 v80, 0xfffeffff, v80
    buffer_store_dwordx4 v[80:83], v4, s[36:39], s59 offen offset:2048 sc1
    v_mul_f32 v88, v120, v88
    v_mul_f32 v89, v121, v89
    v_mul_f32 v90, v122, v90
    v_mul_f32 v91, v123, v91
    v_mul_f32 v92, v124, v92
    v_mul_f32 v93, v125, v93
    v_mul_f32 v94, v126, v94
    v_mul_f32 v95, v127, v95
    v_add_u32 v89, 0x10000, v89
    v_and_b32 v89, 0xfffe0000, v89
    v_cvt_pk_bf16_f32 v84, v88, v89
    v_cvt_pk_bf16_f32 v85, v90, v91
    v_cvt_pk_bf16_f32 v86, v92, v93
    v_cvt_pk_bf16_f32 v87, v94, v95
    v_and_b32 v84, 0xfffeffff, v84
    buffer_store_dwordx4 v[84:87], v4, s[36:39], s59 offen offset:3072 sc1
    v_cmp_ge_u32 vcc, 32, v1
    v_mov_b32 v103, 0xff800000
    v_lshlrev_b32 v14, 2, v1
    v_sub_u32 v15, 32, v1
    v_cndmask_b32_e64 v98, v103, 0, vcc
    v_cndmask_b32_e64 v99, 0, v103, vcc
    v_and_b32 v100, 0xfffffff1, v15
    v_cmp_eq_u32 vcc, 0, v100
    v_add_u32 v15, 32, v15
    v_and_b32 v101, 0xfffffff1, v15
    v_cndmask_b32_e64 v100, v103, 0, vcc
    v_cmp_eq_u32 vcc, 0, v101
    v_mov_b32 v102, 0
    s_nop 0
    v_cndmask_b32_e64 v101, v103, 0, vcc
    ds_write_b32 v14, v98 offset:59904
    ds_write_b32 v14, v99 offset:60160
    ds_write_b32 v14, v100 offset:60416
    ds_write_b32 v14, v101 offset:60672
    ds_write_b32 v14, v102 offset:60928
    ds_write_b32 v14, v103 offset:61184
    s_mov_b32 s74, 0
    s_mov_b32 s75, 0x10000
    s_mov_b32 s93, 0
    s_mov_b32 s27, 0
    s_mul_i32 s46, s3, 4128
    v_add_u32 v22, s46, v4
    ds_write_b128 v22, v[64:67] offset:33024
    ds_write_b128 v22, v[68:71] offset:34048
    ds_write_b128 v22, v[80:83] offset:35072
    ds_write_b128 v22, v[84:87] offset:36112
    s_lshl_b32 s46, s3, 10
    s_add_u32 s46, s46, 65536
    v_add_u32 v58, s46, v4
    v_add_u32 v59, 0x10000, v58
    ds_read_b128 a[160:163], v58 offset:32768
    s_lshl_b32 s64, s3, 10
    v_lshrrev_b32 v14, 1, v1
    v_mul_u32_u24 v14, 4128, v14
    v_and_b32 v15, 1, v1
    v_mul_u32_u24 v15, 1040, v15
    v_add_u32 v14, v14, v15
    s_lshl_b32 s46, s4, 3
    v_add_u32 v15, s46, v1
    v_cmp_le_u32 vcc, 16, v15
    v_mov_b32 v105, 0x3f803f80
    s_nop 0
    v_cndmask_b32 v104, 0, v105, vcc
    v_cndmask_b32 v106, 0, v105, vcc
    v_cndmask_b32 v107, 0, v105, vcc
    v_cndmask_b32 v105, 0, v105, vcc
    s_mov_b64 exec, 0xffffff
    ds_write_b128 v14, v[104:107] offset:3072
    s_mov_b64 exec, -1
    s_mov_b32 s100, 0x5d800000
    s_mov_b32 s101, 0x21800000
    s_sub_u32 s46, s3, 8
    s_lshl_b32 s47, s46, 14
    s_add_u32 s76, s59, s47
    s_add_u32 s77, s76, 16384
    s_add_i32 s46, s46, s54
    s_cmp_lt_i32 s46, 0
    s_cselect_b32 s76, 0x7f000000, s76
    s_cselect_b32 s77, 0x7f000000, s77
    s_cselect_b32 s27, 0, s93
    s_sub_u32 s46, 3, s3
    s_min_u32 s47, s46, s3
    s_max_u32 s48, s46, s3
    s_lshr_b32 s49, s3, 1
    s_lshl_b32 s49, s49, 8
    s_lshl_b32 s50, s49, 2
    s_mul_i32 s46, s47, 4128
    s_add_u32 s12, s46, s50
    s_add_u32 s14, s46, s49
    s_add_u32 s25, s46, 1024
    s_sub_u32 s46, s47, s3
    s_lshl_b32 s46, s46, 15
    s_add_u32 s92, s46, s50
    s_mul_i32 s46, s48, 4128
    s_add_u32 s13, s46, s50
    s_add_u32 s15, s46, s49
    s_add_u32 s26, s46, 1024
    s_sub_u32 s46, s48, s3
    s_lshl_b32 s46, s46, 15
    s_add_u32 s94, s46, s50
    s_lshl_b32 s46, s3, 10
    v_add_u32 v22, s46, v5
    v_lshlrev_b32 v23, 2, v1
    s_lshl_b32 s46, s3, 8
    v_add_u32 v23, s46, v23
    s_waitcnt vmcnt(11)
    ds_read_b64_tr_b16 v[24:25], v22 offset:0
    ds_read_b64_tr_b16 v[26:27], v22 offset:256
    ds_read_b64_tr_b16 v[28:29], v22 offset:4096
    ds_read_b64_tr_b16 v[30:31], v22 offset:4352
    ds_read_b64_tr_b16 v[32:33], v22 offset:8192
    ds_read_b64_tr_b16 v[34:35], v22 offset:8448
    ds_read_b64_tr_b16 v[36:37], v22 offset:12288
    ds_read_b64_tr_b16 v[38:39], v22 offset:12544
    s_waitcnt vmcnt(7)
    ds_read_b64_tr_b16 v[40:41], v22 offset:16384
    ds_read_b64_tr_b16 v[42:43], v22 offset:16640
    ds_read_b64_tr_b16 v[44:45], v22 offset:20480
    ds_read_b64_tr_b16 v[46:47], v22 offset:20736
    ds_read_b64_tr_b16 v[48:49], v22 offset:24576
    ds_read_b64_tr_b16 v[50:51], v22 offset:24832
    ds_read_b64_tr_b16 v[52:53], v22 offset:28672
    ds_read_b64_tr_b16 v[54:55], v22 offset:28928
    s_waitcnt lgkmcnt(14)
    v_mfma_f32_16x16x32_bf16 v[60:63], a[132:135], v[24:27], 0
    s_waitcnt lgkmcnt(12)
    v_mfma_f32_16x16x32_bf16 v[60:63], a[132:135], v[28:31], v[60:63]
    s_waitcnt lgkmcnt(10)
    v_mfma_f32_16x16x32_bf16 v[60:63], a[132:135], v[32:35], v[60:63]
    s_waitcnt lgkmcnt(8)
    v_mfma_f32_16x16x32_bf16 v[60:63], a[132:135], v[36:39], v[60:63]
    s_waitcnt lgkmcnt(6)
    v_mfma_f32_16x16x32_bf16 v[60:63], a[132:135], v[40:43], v[60:63]
    s_waitcnt lgkmcnt(4)
    v_mfma_f32_16x16x32_bf16 v[60:63], a[132:135], v[44:47], v[60:63]
    s_waitcnt lgkmcnt(2)
    v_mfma_f32_16x16x32_bf16 v[60:63], a[132:135], v[48:51], v[60:63]
    s_waitcnt lgkmcnt(0)
    v_mfma_f32_16x16x32_bf16 v[60:63], a[132:135], v[52:55], v[60:63]
    s_waitcnt lgkmcnt(15)
    s_add_u32 m0, s64, 97280
    s_add_u32 s82, s90, 0
    buffer_load_dwordx4 v11, s[16:19], s82 offen offset:1024 lds
    v_mov_b32 v56, 0
    v_mul_u32_u24 v57, 2032, v1
    v_sub_u32 v57, 4112, v57
    s_lshl_b32 s51, s3, 2
    s_add_u32 s51, s51, s99
    s_cmp_lg_u32 s3, 0
    s_cbranch_scc1 L_fnw_4
    s_waitcnt vmcnt(5)
    v_and_b32 v21, 0x80808080, v20
    v_cmp_ne_u32 vcc, 0x80808080, v21
    s_cbranch_vccnz L_fsl_5
L_fbk_6:
    s_mul_i32 s46, s53, 0x01010101
    v_and_b32 v21, 0x0f0f0f0f, v20
    v_cmp_eq_u32 vcc, s46, v21
    s_lshl_b32 s47, s4, 2
    s_lshr_b64 s[68:69], vcc, s47
    s_and_b32 s46, s68, 15
    s_cmp_eq_u32 s46, 15
    s_cselect_b32 s7, 1, 0
    s_lshl_b32 s46, s71, 8
    s_or_b32 s46, s46, s7
    v_mov_b32 v21, s46
    s_cmp_lg_u32 s5, 0
    s_cbranch_scc1 L_fbk_6m
    v_lshlrev_b32 v123, 7, v1
    s_mov_b64 exec, 0xffff
    buffer_store_dword v21, v123, s[36:39], s99 offen sc1
    s_mov_b64 exec, -1
L_fbk_6m:
    v_mov_b32 v123, 0
    ds_write_b32 v123, v21 offset:49536
L_fnw_4:
    s_nop 4
    ds_write_b32 v23, v61 offset:49664
    s_waitcnt lgkmcnt(0)
    s_mov_b64 exec, 3
    s_barrier
    s_waitcnt vmcnt(1)
    buffer_store_dword v56, v57, s[36:39], s51 offen sc1
    s_mov_b64 exec, -1
    ds_read_b64_tr_b16 v[32:33], v5 offset:31744
    ds_read_b64_tr_b16 v[34:35], v6 offset:31744
    ds_read_b64_tr_b16 v[36:37], v5 offset:30720
    ds_read_b64_tr_b16 v[38:39], v6 offset:30720
    ds_read_b64_tr_b16 v[40:41], v5 offset:29696
    ds_read_b64_tr_b16 v[42:43], v6 offset:29696
    ds_read_b64_tr_b16 v[44:45], v5 offset:28672
    ds_read_b64_tr_b16 v[46:47], v6 offset:28672
    ds_read_b64_tr_b16 v[24:25], v5 offset:27648
    ds_read_b64_tr_b16 v[26:27], v6 offset:27648
    v_lshlrev_b32 v121, 2, v2
    v_mov_b32 v122, 0
    ds_read_b32 v122, v122 offset:49536
    ds_read_b32 v116, v121 offset:49664
    ds_read_b32 v117, v121 offset:49920
    ds_read_b32 v118, v121 offset:50176
    ds_read_b32 v119, v121 offset:50432
    s_waitcnt lgkmcnt(13)
    v_mfma_f32_32x32x16_bf16 v[96:111], v[32:35], v[252:255], 0
    ds_read_b64_tr_b16 v[28:29], v5 offset:26624
    ds_read_b64_tr_b16 v[30:31], v6 offset:26624
    v_mov_b32 v50, 0
    ds_read_b128 a[192:195], v59 offset:0
    s_waitcnt lgkmcnt(3)
    v_add_f32 v116, v116, v117
    v_add_f32 v118, v118, v119
    s_waitcnt lgkmcnt(14)
    v_mfma_f32_32x32x16_bf16 v[96:111], v[36:39], v[248:251], v[96:111]
    ds_read_b64_tr_b16 v[32:33], v5 offset:25600
    ds_read_b64_tr_b16 v[34:35], v6 offset:25600
    v_mov_b32 v20, -1
    v_mov_b32 v21, -1
    v_mov_b32 v22, -1
    v_mov_b32 v23, -1
    ds_read_b128 a[164:167], v58 offset:36864
    v_add_f32 v116, v116, v118
    v_cvt_pk_bf16_f32 v117, v116, v116
    v_and_b32 v118, 0xffff0000, v117
    s_waitcnt lgkmcnt(15)
    v_mfma_f32_32x32x16_bf16 v[96:111], v[40:43], v[244:247], v[96:111]
    ds_read_b64_tr_b16 v[36:37], v5 offset:24576
    ds_read_b64_tr_b16 v[38:39], v6 offset:24576
    s_waitcnt lgkmcnt(12)
    v_readfirstlane_b32 s47, v122
    s_nop 0
    s_and_b32 s7, s47, 1
    s_lshr_b32 s71, s47, 8
    s_cmp_eq_u32 s71, 0
    s_cselect_b64 s[44:45], -1, 0
    ds_read_b128 a[196:199], v59 offset:4096
    v_sub_f32 v119, v116, v118
    v_cvt_pk_bf16_f32 v117, v119, v119
    v_and_b32 v117, 0xffff0000, v117
    s_waitcnt lgkmcnt(15)
    v_mfma_f32_32x32x16_bf16 v[96:111], v[44:47], v[240:243], v[96:111]
    ds_read_b64_tr_b16 v[40:41], v5 offset:23552
    ds_read_b64_tr_b16 v[42:43], v6 offset:23552
    s_cmp_eq_u32 s7, 0
    s_cbranch_scc1 L_stsl_7
    buffer_store_dwordx4 v[20:23], v4, s[28:31], s61 offen
    buffer_store_dwordx4 v[20:23], v4, s[28:31], s61 offen offset:1024
L_stdn_8:
    ds_read_b128 a[168:171], v58 offset:40960
    v_sub_f32 v119, v119, v117
    v_cvt_pk_bf16_f32 v119, v119, v119
    v_lshrrev_b32 v112, 16, v118
    s_waitcnt lgkmcnt(15)
    v_mfma_f32_32x32x16_bf16 v[96:111], v[24:27], v[236:239], v[96:111]
    ds_read_b64_tr_b16 v[44:45], v5 offset:22528
    ds_read_b64_tr_b16 v[46:47], v6 offset:22528
    s_cmp_eq_u32 s7, 0
    s_cbranch_scc1 L_stsl_9
    buffer_store_dwordx4 v[20:23], v4, s[36:39], s58 offen
    buffer_store_dwordx4 v[20:23], v4, s[36:39], s58 offen offset:1024
L_stdn_10:
    ds_read_b128 a[200:203], v59 offset:8192
    v_or_b32 v112, v112, v117
    v_and_b32 v113, 0xffff, v119
    v_mov_b32 v114, 0
    s_waitcnt lgkmcnt(13)
    v_mfma_f32_32x32x16_bf16 v[96:111], v[28:31], v[232:235], v[96:111]
    ds_read_b64_tr_b16 v[24:25], v5 offset:21504
    ds_read_b64_tr_b16 v[26:27], v6 offset:21504
    v_lshlrev_b32 v15, 4, v2
    s_cmp_eq_u32 s7, 0
    s_cbranch_scc1 L_stsl_11
    buffer_store_dwordx2 v[20:21], v15, s[36:39], s62 offen
L_stdn_12:
    ds_read_b128 a[172:175], v58 offset:45056
    s_add_u32 m0, s64, 129024
    s_waitcnt lgkmcnt(15)
    buffer_load_dwordx4 v11, s[16:19], s82 offen offset:2048 lds
    v_mov_b32 v115, 0
    v_lshlrev_b32 v121, 3, v2
    ds_write_b64 v121, v[112:113] offset:57856
    s_waitcnt lgkmcnt(14)
    v_mfma_f32_32x32x16_bf16 v[96:111], v[32:35], v[228:231], v[96:111]
    ds_read_b64_tr_b16 v[28:29], v5 offset:20480
    ds_read_b64_tr_b16 v[30:31], v6 offset:20480
    ds_read_b128 a[204:207], v59 offset:12288
    v_add_u32 v248, s12, v4
    v_add_u32 v249, s14, v4
    v_mov_b32 v14, s25
    s_waitcnt lgkmcnt(14)
    v_mfma_f32_32x32x16_bf16 v[96:111], v[36:39], v[224:227], v[96:111]
    ds_read_b64_tr_b16 v[32:33], v5 offset:19456
    ds_read_b64_tr_b16 v[34:35], v6 offset:19456
    ds_read_b128 a[176:179], v58 offset:49152
    s_waitcnt lgkmcnt(15)
    s_add_u32 m0, s64, 101376
    s_add_u32 s82, s90, 196608
    buffer_load_dwordx4 v11, s[16:19], s82 offen offset:1024 lds
    v_cndmask_b32_e64 v249, v14, v249, s[72:73]
    v_add_u32 v251, s13, v4
    v_add_u32 v250, s15, v4
    s_waitcnt lgkmcnt(14)
    v_mfma_f32_32x32x16_bf16 v[96:111], v[40:43], v[220:223], v[96:111]
    ds_read_b64_tr_b16 v[36:37], v5 offset:18432
    ds_read_b64_tr_b16 v[38:39], v6 offset:18432
    ds_read_b128 a[208:211], v59 offset:16384
    v_mov_b32 v14, s26
    v_cndmask_b32_e64 v250, v14, v250, s[72:73]
    v_lshlrev_b32 v14, 2, v3
    s_waitcnt lgkmcnt(14)
    v_mfma_f32_32x32x16_bf16 v[96:111], v[44:47], v[216:219], v[96:111]
    ds_read_b64_tr_b16 v[40:41], v5 offset:17408
    ds_read_b64_tr_b16 v[42:43], v6 offset:17408
    ds_read_b128 a[180:183], v58 offset:53248
    s_add_u32 m0, s64, 133120
    s_waitcnt lgkmcnt(15)
    buffer_load_dwordx4 v11, s[16:19], s82 offen offset:2048 lds
    v_sub_u32 v14, v14, v2
    v_lshlrev_b32 v14, 2, v14
    v_add_u32 v14, 60032, v14
    s_waitcnt lgkmcnt(14)
    v_mfma_f32_32x32x16_bf16 v[96:111], v[24:27], v[212:215], v[96:111]
    ds_read_b64_tr_b16 v[44:45], v5 offset:16384
    ds_read_b64_tr_b16 v[46:47], v6 offset:16384
    ds_read_b128 a[212:215], v59 offset:20480
    ds_read2_b32 v[232:233], v14 offset0:0 offset1:1
    ds_read2_b32 v[234:235], v14 offset0:2 offset1:3
    ds_read2_b32 v[236:237], v14 offset0:8 offset1:9
    s_waitcnt lgkmcnt(15)
    v_mfma_f32_32x32x16_bf16 v[96:111], v[28:31], v[208:211], v[96:111]
    ds_read_b64_tr_b16 v[24:25], v5 offset:15360
    ds_read_b64_tr_b16 v[26:27], v6 offset:15360
    ds_read_b128 a[184:187], v58 offset:57344
    s_waitcnt lgkmcnt(15)
    s_add_u32 m0, s64, 105472
    s_add_u32 s82, s90, 393216
    buffer_load_dwordx4 v11, s[16:19], s82 offen offset:1024 lds
    ds_read2_b32 v[238:239], v14 offset0:10 offset1:11
    ds_read2_b32 v[240:241], v14 offset0:16 offset1:17
    ds_read2_b32 v[242:243], v14 offset0:18 offset1:19
    s_waitcnt lgkmcnt(15)
    v_mfma_f32_32x32x16_bf16 v[96:111], v[32:35], v[204:207], v[96:111]
    ds_read_b64_tr_b16 v[28:29], v5 offset:14336
    ds_read_b64_tr_b16 v[30:31], v6 offset:14336
    s_lshl_b32 s80, s3, 3
    s_add_u32 s80, s80, s99
    s_max_u32 s80, s80, s76
    buffer_load_dwordx2 v[48:49], v50, s[36:39], s80 offen offset:16 sc1
    ds_read_b128 a[216:219], v59 offset:24576
    ds_read2_b32 v[244:245], v14 offset0:24 offset1:25
    ds_read2_b32 v[246:247], v14 offset0:26 offset1:27
    s_waitcnt lgkmcnt(15)
    v_mfma_f32_32x32x16_bf16 v[96:111], v[36:39], v[200:203], v[96:111]
    ds_read_b64_tr_b16 v[32:33], v5 offset:13312
    ds_read_b64_tr_b16 v[34:35], v6 offset:13312
    ds_read_b128 a[188:191], v58 offset:61440
    s_add_u32 m0, s64, 137216
    s_waitcnt lgkmcnt(15)
    buffer_load_dwordx4 v11, s[16:19], s82 offen offset:2048 lds
    s_waitcnt lgkmcnt(15)
    v_mfma_f32_32x32x16_bf16 v[96:111], v[40:43], v[196:199], v[96:111]
    ds_read_b64_tr_b16 v[36:37], v5 offset:12288
    ds_read_b64_tr_b16 v[38:39], v6 offset:12288
    ds_read_b128 a[220:223], v59 offset:28672
    s_waitcnt lgkmcnt(15)
    v_mfma_f32_32x32x16_bf16 v[96:111], v[44:47], v[192:195], v[96:111]
    s_waitcnt lgkmcnt(15)
    s_add_u32 m0, s64, 109568
    s_add_u32 s82, s90, 589824
    buffer_load_dwordx4 v11, s[16:19], s82 offen offset:1024 lds
    s_waitcnt lgkmcnt(15)
    v_mfma_f32_32x32x16_bf16 v[96:111], v[24:27], v[188:191], v[96:111]
    ds_read_b64_tr_b16 v[44:45], v5 offset:11264
    ds_read_b64_tr_b16 v[46:47], v6 offset:11264
    s_waitcnt lgkmcnt(11)
    v_mfma_f32_32x32x16_bf16 v[96:111], v[28:31], v[184:187], v[96:111]
    ds_read_b64_tr_b16 v[24:25], v5 offset:10240
    ds_read_b64_tr_b16 v[26:27], v6 offset:10240
    s_add_u32 m0, s64, 141312
    s_waitcnt lgkmcnt(15)
    buffer_load_dwordx4 v11, s[16:19], s82 offen offset:2048 lds
    s_waitcnt lgkmcnt(8)
    v_mfma_f32_32x32x16_bf16 v[96:111], v[32:35], v[180:183], v[96:111]
    ds_read_b64_tr_b16 v[28:29], v5 offset:9216
    ds_read_b64_tr_b16 v[30:31], v6 offset:9216
    s_waitcnt lgkmcnt(7)
    v_mfma_f32_32x32x16_bf16 v[96:111], v[36:39], v[176:179], v[96:111]
    ds_read_b64_tr_b16 v[32:33], v5 offset:8192
    ds_read_b64_tr_b16 v[34:35], v6 offset:8192
    s_waitcnt lgkmcnt(15)
    s_add_u32 m0, s64, 113664
    s_add_u32 s82, s90, 786432
    buffer_load_dwordx4 v11, s[16:19], s82 offen offset:1024 lds
    v_mfma_f32_32x32x16_bf16 v[96:111], v[112:115], v[16:19], v[96:111]
    ds_read_b64_tr_b16 v[36:37], v5 offset:7168
    ds_read_b64_tr_b16 v[38:39], v6 offset:7168
    s_waitcnt lgkmcnt(8)
    v_mfma_f32_32x32x16_bf16 v[96:111], v[44:47], v[172:175], v[96:111]
    ds_read_b64_tr_b16 v[40:41], v5 offset:6144
    ds_read_b64_tr_b16 v[42:43], v6 offset:6144
    s_add_u32 m0, s64, 145408
    s_waitcnt lgkmcnt(15)
    buffer_load_dwordx4 v11, s[16:19], s82 offen offset:2048 lds
    s_waitcnt lgkmcnt(8)
    v_mfma_f32_32x32x16_bf16 v[96:111], v[24:27], v[168:171], v[96:111]
    ds_read_b64_tr_b16 v[44:45], v5 offset:5120
    ds_read_b64_tr_b16 v[46:47], v6 offset:5120
    s_waitcnt lgkmcnt(8)
    v_mfma_f32_32x32x16_bf16 v[96:111], v[28:31], v[164:167], v[96:111]
    ds_read_b64_tr_b16 v[24:25], v5 offset:4096
    ds_read_b64_tr_b16 v[26:27], v6 offset:4096
    s_waitcnt lgkmcnt(8)
    v_mfma_f32_32x32x16_bf16 v[96:111], v[32:35], v[160:163], v[96:111]
    ds_read_b64_tr_b16 v[28:29], v5 offset:3072
    ds_read_b64_tr_b16 v[30:31], v6 offset:3072
    s_waitcnt vmcnt(5)
    v_or_b32 v48, v48, v49
    v_cmp_ne_u32 vcc, 0, v48
    s_and_b64 vcc, vcc, s[44:45]
    s_cbranch_vccnz L_kw_13
L_kb_14:
    s_mul_i32 s81, s3, 8256
    s_add_u32 m0, s81, 0
    s_nop 0
    buffer_load_dwordx4 v4, s[36:39], s76 offen offset:0 sc1 lds
    buffer_load_dwordx4 v4, s[36:39], s76 offen offset:1024 sc1 lds
    s_waitcnt lgkmcnt(8)
    v_mfma_f32_32x32x16_bf16 v[96:111], v[36:39], v[156:159], v[96:111]
    ds_read_b64_tr_b16 v[32:33], v5 offset:2048
    s_add_u32 m0, s81, 0
    ds_read_b64_tr_b16 v[34:35], v6 offset:2048
    buffer_load_dwordx4 v4, s[36:39], s76 offen offset:2048 sc1 lds
    s_add_u32 m0, s81, 16
    s_nop 0
    buffer_load_dwordx4 v4, s[36:39], s76 offen offset:3072 sc1 lds
    s_waitcnt lgkmcnt(8)
    v_mfma_f32_32x32x16_bf16 v[96:111], v[40:43], v[152:155], v[96:111]
    ds_read_b64_tr_b16 v[36:37], v5 offset:1024
    s_add_u32 m0, s81, 4128
    ds_read_b64_tr_b16 v[38:39], v6 offset:1024
    buffer_load_dwordx4 v4, s[36:39], s77 offen offset:0 sc1 lds
    buffer_load_dwordx4 v4, s[36:39], s77 offen offset:1024 sc1 lds
    ds_read_b128 v[160:163], v248 offset:33024
    ds_read_b128 v[164:167], v249 offset:35072
    ds_read_b128 v[168:171], v249 offset:36112
    ds_read_b128 v[172:175], v251 offset:33024
    ds_read_b128 v[176:179], v250 offset:35072
    ds_read_b128 v[180:183], v250 offset:36112
    s_waitcnt lgkmcnt(14)
    v_mfma_f32_32x32x16_bf16 v[96:111], v[44:47], v[148:151], v[96:111]
    ds_read_b64_tr_b16 v[40:41], v5 offset:0
    s_add_u32 m0, s81, 4128
    ds_read_b64_tr_b16 v[42:43], v6 offset:0
    buffer_load_dwordx4 v4, s[36:39], s77 offen offset:2048 sc1 lds
    s_add_u32 m0, s81, 4144
    s_nop 0
    buffer_load_dwordx4 v4, s[36:39], s77 offen offset:3072 sc1 lds
    s_waitcnt lgkmcnt(14)
    v_mfma_f32_32x32x16_bf16 v[96:111], v[24:27], v[144:147], v[96:111]
    s_waitcnt lgkmcnt(12)
    v_mfma_f32_32x32x16_bf16 v[96:111], v[28:31], v[140:143], v[96:111]
    s_waitcnt lgkmcnt(10)
    v_mfma_f32_32x32x16_bf16 v[96:111], v[32:35], v[136:139], v[96:111]
    s_waitcnt lgkmcnt(8)
    v_mfma_f32_32x32x16_bf16 v[96:111], v[36:39], v[132:135], v[96:111]
    s_waitcnt lgkmcnt(0)
    v_mfma_f32_32x32x16_bf16 v[96:111], v[40:43], v[128:131], v[96:111]
    s_lshl_b32 s46, s3, 10
    s_add_u32 s46, s46, 65536
    v_add_u32 v32, s46, v4
    v_add_u32 v33, 0x10000, v32
    s_lshl_b32 s46, s3, 10
    v_add_u32 v27, s46, v4
    v_xor_b32 v28, 0xc00, v27
    s_nop 3
    s_cmp_ge_u32 s3, 2
    s_cbranch_scc1 L_qxh_16
    v_mul_f32 v96, v13, v96
    v_mul_f32 v97, v13, v97
    v_mul_f32 v98, v13, v98
    v_mul_f32 v99, v13, v99
    v_mul_f32 v100, v13, v100
    v_mul_f32 v101, v13, v101
    v_mul_f32 v102, v13, v102
    v_mul_f32 v103, v13, v103
    v_cvt_pk_bf16_f32 v16, v96, v97
    v_cvt_pk_bf16_f32 v17, v98, v99
    v_cvt_pk_bf16_f32 v18, v100, v101
    v_cvt_pk_bf16_f32 v19, v102, v103
    s_waitcnt lgkmcnt(0)
    s_nop 0
    v_mfma_f32_32x32x16_bf16 v[128:143], v[160:163], v[16:19], v[232:247]
    v_mul_f32 v104, v13, v104
    v_mul_f32 v105, v13, v105
    v_mul_f32 v106, v13, v106
    v_mul_f32 v107, v13, v107
    v_mul_f32 v108, v13, v108
    v_mul_f32 v109, v13, v109
    v_mul_f32 v110, v13, v110
    v_mul_f32 v111, v13, v111
    v_cvt_pk_bf16_f32 v20, v104, v105
    v_cvt_pk_bf16_f32 v21, v106, v107
    v_cvt_pk_bf16_f32 v22, v108, v109
    v_cvt_pk_bf16_f32 v23, v110, v111
    ds_write_b128 v27, v[20:23] offset:61440
    v_exp_f32 v128, v128
    v_exp_f32 v129, v129
    v_exp_f32 v130, v130
    s_waitcnt lgkmcnt(0)
    s_barrier
    ds_read_b128 v[20:23], v28 offset:61440
    ds_read_b128 v[184:187], v251 offset:28896
    ds_read_b128 v[188:191], v250 offset:30944
    ds_read_b128 v[192:195], v250 offset:31984
    v_exp_f32 v131, v131
    v_exp_f32 v132, v132
    v_exp_f32 v133, v133
    ds_read_b128 a[224:227], v32 offset:0
    ds_read_b128 a[228:231], v32 offset:4096
    ds_read_b128 a[232:235], v32 offset:8192
    ds_read_b128 a[236:239], v32 offset:12288
    v_exp_f32 v134, v134
    v_exp_f32 v135, v135
    v_exp_f32 v136, v136
    v_exp_f32 v137, v137
    v_exp_f32 v138, v138
    s_waitcnt lgkmcnt(7)
    v_mfma_f32_32x32x16_bf16 v[144:159], v[172:175], v[20:23], v[232:247]
    v_exp_f32 v139, v139
    ds_read_b128 v[196:199], v251 offset:24768
    ds_read_b128 v[200:203], v250 offset:26816
    ds_read_b128 v[204:207], v250 offset:27856
    v_exp_f32 v140, v140
    v_exp_f32 v141, v141
    ds_read_b128 a[240:243], v32 offset:16384
    ds_read_b128 a[244:247], v32 offset:20480
    s_add_u32 m0, s64, 117760
    s_add_u32 s82, s90, 983040
    buffer_load_dwordx4 v11, s[16:19], s82 offen offset:1024 lds
    ds_read_b128 a[248:251], v32 offset:24576
    s_add_u32 m0, s64, 149504
    ds_read_b128 a[252:255], v32 offset:28672
    buffer_load_dwordx4 v11, s[16:19], s82 offen offset:2048 lds
    v_exp_f32 v142, v142
    v_exp_f32 v143, v143
    v_cvt_pk_bf16_f32 v128, v128, v129
    s_waitcnt lgkmcnt(13)
    v_mfma_f32_32x32x16_bf16 v[64:79], v[184:187], v[20:23], 0
    v_cvt_pk_bf16_f32 v129, v130, v131
    v_cvt_pk_bf16_f32 v130, v132, v133
    v_cvt_pk_bf16_f32 v131, v134, v135
    v_cvt_pk_bf16_f32 v132, v136, v137
    v_cvt_pk_bf16_f32 v133, v138, v139
    s_add_u32 m0, s64, 121856
    s_add_u32 s82, s90, 1179648
    buffer_load_dwordx4 v11, s[16:19], s82 offen offset:1024 lds
    s_add_u32 m0, s64, 153600
    s_nop 0
    buffer_load_dwordx4 v11, s[16:19], s82 offen offset:2048 lds
    v_cvt_pk_bf16_f32 v134, v140, v141
    v_cvt_pk_bf16_f32 v135, v142, v143
    v_exp_f32 v144, v144
    v_exp_f32 v145, v145
    v_mfma_f32_32x32x16_bf16 v[96:111], v[164:167], v[128:131], 0
    v_exp_f32 v146, v146
    v_exp_f32 v147, v147
    s_add_u32 m0, s64, 125952
    s_add_u32 s82, s90, 1376256
    buffer_load_dwordx4 v11, s[16:19], s82 offen offset:1024 lds
    v_exp_f32 v148, v148
    v_exp_f32 v149, v149
    v_exp_f32 v150, v150
    v_exp_f32 v151, v151
    v_mfma_f32_32x32x16_bf16 v[96:111], v[168:171], v[132:135], v[96:111]
    v_exp_f32 v152, v152
    v_exp_f32 v153, v153
    v_exp_f32 v154, v154
    v_exp_f32 v155, v155
    v_exp_f32 v156, v156
    v_exp_f32 v157, v157
    s_waitcnt lgkmcnt(6)
    v_mfma_f32_32x32x16_bf16 v[80:95], v[196:199], v[20:23], 0
    v_exp_f32 v158, v158
    s_add_u32 m0, s64, 157696
    v_exp_f32 v159, v159
    buffer_load_dwordx4 v11, s[16:19], s82 offen offset:2048 lds
    v_cvt_pk_bf16_f32 v144, v144, v145
    v_cvt_pk_bf16_f32 v145, v146, v147
    v_cvt_pk_bf16_f32 v146, v148, v149
    v_cvt_pk_bf16_f32 v147, v150, v151
    v_cvt_pk_bf16_f32 v148, v152, v153
    s_add_u32 s83, s40, 0
    buffer_load_dwordx4 a[0:3], v4, s[36:39], s83 offen offset:0
    v_cvt_pk_bf16_f32 v149, v154, v155
    v_cvt_pk_bf16_f32 v150, v156, v157
    v_cvt_pk_bf16_f32 v151, v158, v159
    v_exp_f32 v64, v64
    v_exp_f32 v65, v65
    v_mfma_f32_32x32x16_bf16 v[112:127], v[176:179], v[144:147], 0
    v_exp_f32 v66, v66
    v_exp_f32 v67, v67
    buffer_load_dwordx4 a[4:7], v4, s[36:39], s83 offen offset:1024
    v_exp_f32 v68, v68
    v_exp_f32 v69, v69
    v_exp_f32 v70, v70
    v_exp_f32 v71, v71
    v_mfma_f32_32x32x16_bf16 v[112:127], v[180:183], v[148:151], v[112:127]
    v_exp_f32 v72, v72
    v_exp_f32 v73, v73
    buffer_load_dwordx4 a[8:11], v4, s[36:39], s83 offen offset:2048
    v_exp_f32 v74, v74
    v_exp_f32 v75, v75
    v_exp_f32 v76, v76
    v_exp_f32 v77, v77
    v_exp_f32 v78, v78
    v_exp_f32 v79, v79
    buffer_load_dwordx4 a[12:15], v4, s[36:39], s83 offen offset:3072
    v_cvt_pk_bf16_f32 v64, v64, v65
    v_cvt_pk_bf16_f32 v65, v66, v67
    v_cvt_pk_bf16_f32 v66, v68, v69
    v_cvt_pk_bf16_f32 v67, v70, v71
    v_cvt_pk_bf16_f32 v68, v72, v73
    v_cvt_pk_bf16_f32 v69, v74, v75
    v_cvt_pk_bf16_f32 v70, v76, v77
    v_cvt_pk_bf16_f32 v71, v78, v79
    s_branch L_qxd_17
L_qxh_16:
    v_mul_f32 v104, v13, v104
    v_mul_f32 v105, v13, v105
    v_mul_f32 v106, v13, v106
    v_mul_f32 v107, v13, v107
    v_mul_f32 v108, v13, v108
    v_mul_f32 v109, v13, v109
    v_mul_f32 v110, v13, v110
    v_mul_f32 v111, v13, v111
    v_cvt_pk_bf16_f32 v20, v104, v105
    v_cvt_pk_bf16_f32 v21, v106, v107
    v_cvt_pk_bf16_f32 v22, v108, v109
    v_cvt_pk_bf16_f32 v23, v110, v111
    s_waitcnt lgkmcnt(0)
    s_nop 0
    v_mfma_f32_32x32x16_bf16 v[144:159], v[172:175], v[20:23], v[232:247]
    v_mul_f32 v96, v13, v96
    v_mul_f32 v97, v13, v97
    v_mul_f32 v98, v13, v98
    v_mul_f32 v99, v13, v99
    v_mul_f32 v100, v13, v100
    v_mul_f32 v101, v13, v101
    v_mul_f32 v102, v13, v102
    v_mul_f32 v103, v13, v103
    v_cvt_pk_bf16_f32 v16, v96, v97
    v_cvt_pk_bf16_f32 v17, v98, v99
    v_cvt_pk_bf16_f32 v18, v100, v101
    v_cvt_pk_bf16_f32 v19, v102, v103
    ds_write_b128 v27, v[16:19] offset:61440
    v_exp_f32 v144, v144
    v_exp_f32 v145, v145
    v_exp_f32 v146, v146
    s_waitcnt lgkmcnt(0)
    s_barrier
    ds_read_b128 v[16:19], v28 offset:61440
    ds_read_b128 v[184:187], v251 offset:28896
    ds_read_b128 v[188:191], v250 offset:30944
    ds_read_b128 v[192:195], v250 offset:31984
    v_exp_f32 v147, v147
    v_exp_f32 v148, v148
    v_exp_f32 v149, v149
    ds_read_b128 a[224:227], v32 offset:0
    ds_read_b128 a[228:231], v32 offset:4096
    ds_read_b128 a[232:235], v32 offset:8192
    ds_read_b128 a[236:239], v32 offset:12288
    v_exp_f32 v150, v150
    v_exp_f32 v151, v151
    v_exp_f32 v152, v152
    v_exp_f32 v153, v153
    v_exp_f32 v154, v154
    s_waitcnt lgkmcnt(7)
    v_mfma_f32_32x32x16_bf16 v[128:143], v[160:163], v[16:19], v[232:247]
    v_exp_f32 v155, v155
    ds_read_b128 v[196:199], v251 offset:24768
    ds_read_b128 v[200:203], v250 offset:26816
    ds_read_b128 v[204:207], v250 offset:27856
    v_exp_f32 v156, v156
    v_exp_f32 v157, v157
    ds_read_b128 a[240:243], v32 offset:16384
    ds_read_b128 a[244:247], v32 offset:20480
    s_add_u32 m0, s64, 117760
    s_add_u32 s82, s90, 983040
    buffer_load_dwordx4 v11, s[16:19], s82 offen offset:1024 lds
    ds_read_b128 a[248:251], v32 offset:24576
    s_add_u32 m0, s64, 149504
    ds_read_b128 a[252:255], v32 offset:28672
    buffer_load_dwordx4 v11, s[16:19], s82 offen offset:2048 lds
    v_exp_f32 v158, v158
    v_exp_f32 v159, v159
    v_cvt_pk_bf16_f32 v144, v144, v145
    s_waitcnt lgkmcnt(13)
    v_mfma_f32_32x32x16_bf16 v[64:79], v[184:187], v[20:23], 0
    v_cvt_pk_bf16_f32 v145, v146, v147
    v_cvt_pk_bf16_f32 v146, v148, v149
    v_cvt_pk_bf16_f32 v147, v150, v151
    v_cvt_pk_bf16_f32 v148, v152, v153
    v_cvt_pk_bf16_f32 v149, v154, v155
    s_add_u32 m0, s64, 121856
    s_add_u32 s82, s90, 1179648
    buffer_load_dwordx4 v11, s[16:19], s82 offen offset:1024 lds
    s_add_u32 m0, s64, 153600
    s_nop 0
    buffer_load_dwordx4 v11, s[16:19], s82 offen offset:2048 lds
    v_cvt_pk_bf16_f32 v150, v156, v157
    v_cvt_pk_bf16_f32 v151, v158, v159
    v_exp_f32 v128, v128
    v_exp_f32 v129, v129
    v_mfma_f32_32x32x16_bf16 v[112:127], v[176:179], v[144:147], 0
    v_exp_f32 v130, v130
    v_exp_f32 v131, v131
    s_add_u32 m0, s64, 125952
    s_add_u32 s82, s90, 1376256
    buffer_load_dwordx4 v11, s[16:19], s82 offen offset:1024 lds
    v_exp_f32 v132, v132
    v_exp_f32 v133, v133
    v_exp_f32 v134, v134
    v_exp_f32 v135, v135
    v_mfma_f32_32x32x16_bf16 v[112:127], v[180:183], v[148:151], v[112:127]
    v_exp_f32 v136, v136
    v_exp_f32 v137, v137
    v_exp_f32 v138, v138
    v_exp_f32 v139, v139
    v_exp_f32 v140, v140
    v_exp_f32 v141, v141
    s_waitcnt lgkmcnt(6)
    v_mfma_f32_32x32x16_bf16 v[80:95], v[196:199], v[20:23], 0
    v_exp_f32 v142, v142
    s_add_u32 m0, s64, 157696
    v_exp_f32 v143, v143
    buffer_load_dwordx4 v11, s[16:19], s82 offen offset:2048 lds
    v_cvt_pk_bf16_f32 v128, v128, v129
    v_cvt_pk_bf16_f32 v129, v130, v131
    v_cvt_pk_bf16_f32 v130, v132, v133
    v_cvt_pk_bf16_f32 v131, v134, v135
    v_cvt_pk_bf16_f32 v132, v136, v137
    s_add_u32 s83, s40, 0
    buffer_load_dwordx4 a[0:3], v4, s[36:39], s83 offen offset:0
    v_cvt_pk_bf16_f32 v133, v138, v139
    v_cvt_pk_bf16_f32 v134, v140, v141
    v_cvt_pk_bf16_f32 v135, v142, v143
    v_exp_f32 v64, v64
    v_exp_f32 v65, v65
    v_mfma_f32_32x32x16_bf16 v[96:111], v[164:167], v[128:131], 0
    v_exp_f32 v66, v66
    v_exp_f32 v67, v67
    buffer_load_dwordx4 a[4:7], v4, s[36:39], s83 offen offset:1024
    v_exp_f32 v68, v68
    v_exp_f32 v69, v69
    v_exp_f32 v70, v70
    v_exp_f32 v71, v71
    v_mfma_f32_32x32x16_bf16 v[96:111], v[168:171], v[132:135], v[96:111]
    v_exp_f32 v72, v72
    v_exp_f32 v73, v73
    buffer_load_dwordx4 a[8:11], v4, s[36:39], s83 offen offset:2048
    v_exp_f32 v74, v74
    v_exp_f32 v75, v75
    v_exp_f32 v76, v76
    v_exp_f32 v77, v77
    v_exp_f32 v78, v78
    v_exp_f32 v79, v79
    buffer_load_dwordx4 a[12:15], v4, s[36:39], s83 offen offset:3072
    v_cvt_pk_bf16_f32 v64, v64, v65
    v_cvt_pk_bf16_f32 v65, v66, v67
    v_cvt_pk_bf16_f32 v66, v68, v69
    v_cvt_pk_bf16_f32 v67, v70, v71
    v_cvt_pk_bf16_f32 v68, v72, v73
    v_cvt_pk_bf16_f32 v69, v74, v75
    v_cvt_pk_bf16_f32 v70, v76, v77
    v_cvt_pk_bf16_f32 v71, v78, v79
L_qxd_17:
    v_add_u32 v27, s81, v4
    s_waitcnt vmcnt(10)
    ds_read_b32 v40, v27 offset:0
    ds_read_b32 v41, v27 offset:1024
    ds_read_b32 v42, v27 offset:2048
    ds_read_b32 v43, v27 offset:3088
    ds_read_b32 v44, v27 offset:4128
    ds_read_b32 v45, v27 offset:5152
    ds_read_b32 v46, v27 offset:6176
    ds_read_b32 v47, v27 offset:7216
L_nbw_18:
    v_exp_f32 v80, v80
    v_mfma_f32_32x32x16_bf16 v[112:127], v[188:191], v[64:67], v[112:127]
    v_exp_f32 v81, v81
    v_exp_f32 v82, v82
    v_exp_f32 v83, v83
    s_waitcnt lgkmcnt(0)
    v_xor_b32 v14, s27, v40
    v_bitop3_b32 v14, v14, v41, s27 bitop3:0xf6
    v_bitop3_b32 v14, v14, v42, s27 bitop3:0xf6
    v_bitop3_b32 v14, v14, v43, s27 bitop3:0xf6
    v_bitop3_b32 v14, v14, v44, s27 bitop3:0xf6
    v_bitop3_b32 v14, v14, v45, s27 bitop3:0xf6
    v_bitop3_b32 v14, v14, v46, s27 bitop3:0xf6
    v_bitop3_b32 v14, v14, v47, s27 bitop3:0xf6
    v_and_b32 v14, 0x10000, v14
    v_cmp_ne_u32 vcc, 0, v14
    s_and_b64 vcc, vcc, s[44:45]
    s_cbranch_vccnz L_slow_20
L_back_21:
L_nbw_19:
    s_barrier
    ds_read_b128 v[208:211], v248 offset:28896
    ds_read_b128 v[212:215], v249 offset:30944
    ds_read_b128 v[216:219], v249 offset:31984
    ds_read_b128 v[220:223], v251 offset:20640
    ds_read_b128 v[224:227], v250 offset:22688
    ds_read_b128 v[228:231], v250 offset:23728
    s_cmp_lg_u32 s3, 3
    s_cbranch_scc1 L_oc_23
    v_mov_b32 v36, 0
    s_mov_b64 exec, 1
    buffer_store_dword v36, v36, s[36:39], s99 offen offset:12 sc1
    s_mov_b64 exec, -1
L_oc_23:
    v_lshrrev_b32 v14, 2, v1
    v_lshlrev_b32 v14, 10, v14
    v_and_b32 v15, 3, v1
    v_lshl_add_u32 v14, v15, 4, v14
    s_lshl_b32 s46, s55, 15
    s_lshl_b32 s47, s56, 6
    s_add_u32 s46, s46, s47
    s_lshl_b32 s47, s3, 11
    s_add_u32 m0, s47, 49664
    s_nop 0
    buffer_load_dwordx4 v14, s[8:11], s46 offen lds
    s_add_u32 m0, s47, 50688
    s_add_u32 s46, s46, 16384
    buffer_load_dwordx4 v14, s[8:11], s46 offen lds
    v_exp_f32 v84, v84
    v_exp_f32 v85, v85
    s_add_u32 m0, s64, 65536
    s_add_u32 s82, s90, 0
    buffer_load_dwordx4 v11, s[16:19], s82 offen offset:0 lds
    s_add_u32 s83, s40, 4096
    buffer_load_dwordx4 a[16:19], v4, s[36:39], s83 offen offset:0
    v_exp_f32 v86, v86
    v_exp_f32 v87, v87
    v_mfma_f32_32x32x16_bf16 v[112:127], v[192:195], v[68:71], v[112:127]
    v_exp_f32 v88, v88
    v_exp_f32 v89, v89
    v_exp_f32 v90, v90
    buffer_load_dwordx4 a[20:23], v4, s[36:39], s83 offen offset:1024
    v_exp_f32 v91, v91
    v_exp_f32 v92, v92
    v_exp_f32 v93, v93
    s_waitcnt lgkmcnt(5)
    v_mfma_f32_32x32x16_bf16 v[128:143], v[208:211], v[16:19], 0
    v_exp_f32 v94, v94
    ds_read_b128 v[160:163], v248 offset:24768
    ds_read_b128 v[164:167], v249 offset:26816
    ds_read_b128 v[168:171], v249 offset:27856
    v_exp_f32 v95, v95
    v_cvt_pk_bf16_f32 v80, v80, v81
    v_cvt_pk_bf16_f32 v81, v82, v83
    v_cvt_pk_bf16_f32 v82, v84, v85
    v_cvt_pk_bf16_f32 v83, v86, v87
    s_waitcnt lgkmcnt(5)
    v_mfma_f32_32x32x16_bf16 v[144:159], v[220:223], v[20:23], 0
    v_cvt_pk_bf16_f32 v84, v88, v89
    v_cvt_pk_bf16_f32 v85, v90, v91
    buffer_load_dwordx4 a[24:27], v4, s[36:39], s83 offen offset:2048
    v_cvt_pk_bf16_f32 v86, v92, v93
    v_cvt_pk_bf16_f32 v87, v94, v95
    ds_read_b128 v[172:175], v251 offset:16512
    ds_read_b128 v[176:179], v250 offset:18560
    ds_read_b128 v[180:183], v250 offset:19600
    v_exp_f32 v128, v128
    v_exp_f32 v129, v129
    v_mfma_f32_32x32x16_bf16 v[112:127], v[200:203], v[80:83], v[112:127]
    v_exp_f32 v130, v130
    v_exp_f32 v131, v131
    v_exp_f32 v132, v132
    v_exp_f32 v133, v133
    v_exp_f32 v134, v134
    v_exp_f32 v135, v135
    v_mfma_f32_32x32x16_bf16 v[112:127], v[204:207], v[84:87], v[112:127]
    v_exp_f32 v136, v136
    v_exp_f32 v137, v137
    s_add_u32 m0, s64, 69632
    s_add_u32 s82, s90, 196608
    buffer_load_dwordx4 v11, s[16:19], s82 offen offset:0 lds
    buffer_load_dwordx4 a[28:31], v4, s[36:39], s83 offen offset:3072
    v_exp_f32 v138, v138
    v_exp_f32 v139, v139
    v_exp_f32 v140, v140
    v_exp_f32 v141, v141
    s_waitcnt lgkmcnt(5)
    v_mfma_f32_32x32x16_bf16 v[64:79], v[160:163], v[16:19], 0
    v_exp_f32 v142, v142
    v_exp_f32 v143, v143
    v_cvt_pk_bf16_f32 v128, v128, v129
    v_cvt_pk_bf16_f32 v129, v130, v131
    v_cvt_pk_bf16_f32 v130, v132, v133
    v_cvt_pk_bf16_f32 v131, v134, v135
    v_cvt_pk_bf16_f32 v132, v136, v137
    s_add_u32 s83, s41, 0
    buffer_load_dwordx4 a[32:35], v4, s[36:39], s83 offen offset:0
    v_cvt_pk_bf16_f32 v133, v138, v139
    v_cvt_pk_bf16_f32 v134, v140, v141
    v_cvt_pk_bf16_f32 v135, v142, v143
    ds_read_b128 v[184:187], v248 offset:20640
    ds_read_b128 v[188:191], v249 offset:22688
    ds_read_b128 v[192:195], v249 offset:23728
    v_exp_f32 v144, v144
    v_exp_f32 v145, v145
    v_mfma_f32_32x32x16_bf16 v[96:111], v[212:215], v[128:131], v[96:111]
    v_exp_f32 v146, v146
    v_exp_f32 v147, v147
    buffer_load_dwordx4 a[36:39], v4, s[36:39], s83 offen offset:1024
    v_exp_f32 v148, v148
    v_exp_f32 v149, v149
    v_exp_f32 v150, v150
    v_exp_f32 v151, v151
    v_mfma_f32_32x32x16_bf16 v[96:111], v[216:219], v[132:135], v[96:111]
    v_exp_f32 v152, v152
    v_exp_f32 v153, v153
    v_exp_f32 v154, v154
    v_exp_f32 v155, v155
    v_exp_f32 v156, v156
    v_exp_f32 v157, v157
    s_waitcnt lgkmcnt(5)
    v_mfma_f32_32x32x16_bf16 v[80:95], v[172:175], v[20:23], 0
    v_exp_f32 v158, v158
    v_exp_f32 v159, v159
    s_add_u32 m0, s64, 73728
    s_add_u32 s82, s90, 393216
    buffer_load_dwordx4 v11, s[16:19], s82 offen offset:0 lds
    buffer_load_dwordx4 a[40:43], v4, s[36:39], s83 offen offset:2048
    v_cvt_pk_bf16_f32 v144, v144, v145
    v_cvt_pk_bf16_f32 v145, v146, v147
    v_cvt_pk_bf16_f32 v146, v148, v149
    v_cvt_pk_bf16_f32 v147, v150, v151
    v_cvt_pk_bf16_f32 v148, v152, v153
    v_cvt_pk_bf16_f32 v149, v154, v155
    v_cvt_pk_bf16_f32 v150, v156, v157
    v_cvt_pk_bf16_f32 v151, v158, v159
    v_lshlrev_b32 v14, 2, v3
    v_sub_u32 v14, v14, v2
    v_lshlrev_b32 v14, 2, v14
    v_add_u32 v14, 60288, v14
    ds_read2_b32 v[232:233], v14 offset0:0 offset1:1
    ds_read2_b32 v[234:235], v14 offset0:2 offset1:3
    ds_read2_b32 v[236:237], v14 offset0:8 offset1:9
    ds_read2_b32 v[238:239], v14 offset0:10 offset1:11
    ds_read2_b32 v[240:241], v14 offset0:16 offset1:17
    ds_read2_b32 v[242:243], v14 offset0:18 offset1:19
    ds_read2_b32 v[244:245], v14 offset0:24 offset1:25
    ds_read2_b32 v[246:247], v14 offset0:26 offset1:27
    ds_read_b128 v[196:199], v251 offset:12384
    ds_read_b128 v[200:203], v250 offset:14432
    ds_read_b128 v[204:207], v250 offset:15472
    v_exp_f32 v64, v64
    v_exp_f32 v65, v65
    v_mfma_f32_32x32x16_bf16 v[112:127], v[224:227], v[144:147], v[112:127]
    v_exp_f32 v66, v66
    v_exp_f32 v67, v67
    buffer_load_dwordx4 a[44:47], v4, s[36:39], s83 offen offset:3072
    v_exp_f32 v68, v68
    v_exp_f32 v69, v69
    v_exp_f32 v70, v70
    v_exp_f32 v71, v71
    v_mfma_f32_32x32x16_bf16 v[112:127], v[228:231], v[148:151], v[112:127]
    v_exp_f32 v72, v72
    v_exp_f32 v73, v73
    v_exp_f32 v74, v74
    v_exp_f32 v75, v75
    v_exp_f32 v76, v76
    v_exp_f32 v77, v77
    s_waitcnt lgkmcnt(13)
    v_mfma_f32_32x32x16_bf16 v[128:143], v[184:187], v[16:19], 0
    v_exp_f32 v78, v78
    v_exp_f32 v79, v79
    s_add_u32 s83, s41, 4096
    buffer_load_dwordx4 a[48:51], v4, s[36:39], s83 offen offset:0
    v_cvt_pk_bf16_f32 v64, v64, v65
    v_cvt_pk_bf16_f32 v65, v66, v67
    v_cvt_pk_bf16_f32 v66, v68, v69
    v_cvt_pk_bf16_f32 v67, v70, v71
    v_cvt_pk_bf16_f32 v68, v72, v73
    s_add_u32 m0, s64, 77824
    s_add_u32 s82, s90, 589824
    buffer_load_dwordx4 v11, s[16:19], s82 offen offset:0 lds
    v_cvt_pk_bf16_f32 v69, v74, v75
    v_cvt_pk_bf16_f32 v70, v76, v77
    v_cvt_pk_bf16_f32 v71, v78, v79
    ds_read_b128 v[208:211], v248 offset:16512
    ds_read_b128 v[212:215], v249 offset:18560
    ds_read_b128 v[216:219], v249 offset:19600
    v_exp_f32 v80, v80
    v_exp_f32 v81, v81
    v_mfma_f32_32x32x16_bf16 v[96:111], v[164:167], v[64:67], v[96:111]
    v_exp_f32 v82, v82
    v_exp_f32 v83, v83
    buffer_load_dwordx4 a[52:55], v4, s[36:39], s83 offen offset:1024
    v_exp_f32 v84, v84
    v_exp_f32 v85, v85
    v_exp_f32 v86, v86
    v_exp_f32 v87, v87
    v_mfma_f32_32x32x16_bf16 v[96:111], v[168:171], v[68:71], v[96:111]
    v_exp_f32 v88, v88
    v_exp_f32 v89, v89
    buffer_load_dwordx4 a[56:59], v4, s[36:39], s83 offen offset:2048
    v_exp_f32 v90, v90
    v_exp_f32 v91, v91
    v_exp_f32 v92, v92
    v_exp_f32 v93, v93
    s_waitcnt lgkmcnt(5)
    v_mfma_f32_32x32x16_bf16 v[144:159], v[196:199], v[20:23], 0
    v_exp_f32 v94, v94
    v_exp_f32 v95, v95
    v_cvt_pk_bf16_f32 v80, v80, v81
    v_cvt_pk_bf16_f32 v81, v82, v83
    v_cvt_pk_bf16_f32 v82, v84, v85
    v_cvt_pk_bf16_f32 v83, v86, v87
    v_cvt_pk_bf16_f32 v84, v88, v89
    buffer_load_dwordx4 a[60:63], v4, s[36:39], s83 offen offset:3072
    v_cvt_pk_bf16_f32 v85, v90, v91
    v_cvt_pk_bf16_f32 v86, v92, v93
    v_cvt_pk_bf16_f32 v87, v94, v95
    ds_read_b128 v[220:223], v251 offset:8256
    ds_read_b128 v[224:227], v250 offset:10304
    ds_read_b128 v[228:231], v250 offset:11344
    v_exp_f32 v128, v128
    v_exp_f32 v129, v129
    v_mfma_f32_32x32x16_bf16 v[112:127], v[176:179], v[80:83], v[112:127]
    v_exp_f32 v130, v130
    v_exp_f32 v131, v131
    s_add_u32 m0, s64, 81920
    s_add_u32 s82, s90, 786432
    buffer_load_dwordx4 v11, s[16:19], s82 offen offset:0 lds
    v_exp_f32 v132, v132
    v_exp_f32 v133, v133
    v_exp_f32 v134, v134
    v_exp_f32 v135, v135
    v_mfma_f32_32x32x16_bf16 v[112:127], v[180:183], v[84:87], v[112:127]
    v_exp_f32 v136, v136
    v_exp_f32 v137, v137
    s_add_u32 s83, s42, 0
    buffer_load_dwordx4 a[64:67], v4, s[36:39], s83 offen offset:0
    v_exp_f32 v138, v138
    v_exp_f32 v139, v139
    v_exp_f32 v140, v140
    v_exp_f32 v141, v141
    s_waitcnt lgkmcnt(5)
    v_mfma_f32_32x32x16_bf16 v[64:79], v[208:211], v[16:19], 0
    v_exp_f32 v142, v142
    v_exp_f32 v143, v143
    v_cvt_pk_bf16_f32 v128, v128, v129
    v_cvt_pk_bf16_f32 v129, v130, v131
    v_cvt_pk_bf16_f32 v130, v132, v133
    v_cvt_pk_bf16_f32 v131, v134, v135
    v_cvt_pk_bf16_f32 v132, v136, v137
    buffer_load_dwordx4 a[68:71], v4, s[36:39], s83 offen offset:1024
    v_cvt_pk_bf16_f32 v133, v138, v139
    v_cvt_pk_bf16_f32 v134, v140, v141
    v_cvt_pk_bf16_f32 v135, v142, v143
    ds_read_b128 v[160:163], v248 offset:12384
    ds_read_b128 v[164:167], v249 offset:14432
    ds_read_b128 v[168:171], v249 offset:15472
    v_exp_f32 v144, v144
    v_exp_f32 v145, v145
    v_mfma_f32_32x32x16_bf16 v[96:111], v[188:191], v[128:131], v[96:111]
    v_exp_f32 v146, v146
    v_exp_f32 v147, v147
    v_exp_f32 v148, v148
    v_exp_f32 v149, v149
    v_exp_f32 v150, v150
    v_exp_f32 v151, v151
    v_mfma_f32_32x32x16_bf16 v[96:111], v[192:195], v[132:135], v[96:111]
    v_exp_f32 v152, v152
    v_exp_f32 v153, v153
    s_add_u32 m0, s64, 86016
    s_add_u32 s82, s90, 983040
    buffer_load_dwordx4 v11, s[16:19], s82 offen offset:0 lds
    buffer_load_dwordx4 a[72:75], v4, s[36:39], s83 offen offset:2048
    v_exp_f32 v154, v154
    v_exp_f32 v155, v155
    v_exp_f32 v156, v156
    v_exp_f32 v157, v157
    s_waitcnt lgkmcnt(5)
    v_mfma_f32_32x32x16_bf16 v[80:95], v[220:223], v[20:23], 0
    v_exp_f32 v158, v158
    v_exp_f32 v159, v159
    buffer_load_dwordx4 a[76:79], v4, s[36:39], s83 offen offset:3072
    v_cvt_pk_bf16_f32 v144, v144, v145
    v_cvt_pk_bf16_f32 v145, v146, v147
    v_cvt_pk_bf16_f32 v146, v148, v149
    v_cvt_pk_bf16_f32 v147, v150, v151
    v_cvt_pk_bf16_f32 v148, v152, v153
    v_cvt_pk_bf16_f32 v149, v154, v155
    v_cvt_pk_bf16_f32 v150, v156, v157
    v_cvt_pk_bf16_f32 v151, v158, v159
    ds_read_b128 v[172:175], v251 offset:4128
    ds_read_b128 v[176:179], v250 offset:6176
    ds_read_b128 v[180:183], v250 offset:7216
    v_exp_f32 v64, v64
    v_exp_f32 v65, v65
    v_mfma_f32_32x32x16_bf16 v[112:127], v[200:203], v[144:147], v[112:127]
    v_exp_f32 v66, v66
    v_exp_f32 v67, v67
    s_add_u32 s83, s42, 4096
    buffer_load_dwordx4 a[80:83], v4, s[36:39], s83 offen offset:0
    v_exp_f32 v68, v68
    v_exp_f32 v69, v69
    v_exp_f32 v70, v70
    v_exp_f32 v71, v71
    v_mfma_f32_32x32x16_bf16 v[112:127], v[204:207], v[148:151], v[112:127]
    v_exp_f32 v72, v72
    v_exp_f32 v73, v73
    v_exp_f32 v74, v74
    v_exp_f32 v75, v75
    v_exp_f32 v76, v76
    v_exp_f32 v77, v77
    s_waitcnt lgkmcnt(5)
    v_mfma_f32_32x32x16_bf16 v[128:143], v[160:163], v[16:19], 0
    v_exp_f32 v78, v78
    v_exp_f32 v79, v79
    s_add_u32 m0, s64, 90112
    s_add_u32 s82, s90, 1179648
    buffer_load_dwordx4 v11, s[16:19], s82 offen offset:0 lds
    buffer_load_dwordx4 a[84:87], v4, s[36:39], s83 offen offset:1024
    s_getpc_b64 s[20:21]
L_pc_15:
    s_sub_u32 s20, s20, L_pc_15-L_pc
    s_subb_u32 s21, s21, 0
    s_and_b32 s21, s21, 0xffff
    s_mov_b32 s22, 49152
    s_mov_b32 s23, 0x20000
    s_lshr_b32 s24, s2, 3
    s_lshl_b32 s24, s24, 2
    s_add_u32 s24, s24, s3
    s_lshl_b32 s24, s24, 9
    v_lshrrev_b32 v39, 4, v1
    v_lshlrev_b32 v39, 7, v39
    buffer_load_dword a144, v39, s[20:23], s24 offen
    v_cvt_pk_bf16_f32 v64, v64, v65
    v_cvt_pk_bf16_f32 v65, v66, v67
    v_cvt_pk_bf16_f32 v66, v68, v69
    v_cvt_pk_bf16_f32 v67, v70, v71
    v_cvt_pk_bf16_f32 v68, v72, v73
    v_cvt_pk_bf16_f32 v69, v74, v75
    v_cvt_pk_bf16_f32 v70, v76, v77
    v_cvt_pk_bf16_f32 v71, v78, v79
    ds_read_b128 v[184:187], v248 offset:8256
    ds_read_b128 v[188:191], v249 offset:10304
    ds_read_b128 v[192:195], v249 offset:11344
    v_exp_f32 v80, v80
    v_exp_f32 v81, v81
    v_mfma_f32_32x32x16_bf16 v[96:111], v[212:215], v[64:67], v[96:111]
    v_exp_f32 v82, v82
    v_exp_f32 v83, v83
    buffer_load_dwordx4 a[88:91], v4, s[36:39], s83 offen offset:2048
    v_exp_f32 v84, v84
    v_exp_f32 v85, v85
    v_exp_f32 v86, v86
    v_exp_f32 v87, v87
    v_mfma_f32_32x32x16_bf16 v[96:111], v[216:219], v[68:71], v[96:111]
    v_exp_f32 v88, v88
    v_exp_f32 v89, v89
    buffer_load_dwordx4 a[92:95], v4, s[36:39], s83 offen offset:3072
    v_exp_f32 v90, v90
    v_exp_f32 v91, v91
    v_exp_f32 v92, v92
    v_exp_f32 v93, v93
    s_waitcnt lgkmcnt(5)
    v_mfma_f32_32x32x16_bf16 v[144:159], v[172:175], v[20:23], 0
    v_exp_f32 v94, v94
    v_exp_f32 v95, v95
    v_cvt_pk_bf16_f32 v80, v80, v81
    v_cvt_pk_bf16_f32 v81, v82, v83
    v_cvt_pk_bf16_f32 v82, v84, v85
    v_cvt_pk_bf16_f32 v83, v86, v87
    v_cvt_pk_bf16_f32 v84, v88, v89
    s_add_u32 m0, s64, 94208
    s_add_u32 s82, s90, 1376256
    buffer_load_dwordx4 v11, s[16:19], s82 offen offset:0 lds
    s_add_u32 s83, s43, 0
    buffer_load_dwordx4 a[96:99], v4, s[36:39], s83 offen offset:0
    v_cvt_pk_bf16_f32 v85, v90, v91
    v_cvt_pk_bf16_f32 v86, v92, v93
    v_cvt_pk_bf16_f32 v87, v94, v95
    ds_read_b128 v[196:199], v248 offset:4128
    ds_read_b128 v[200:203], v249 offset:6176
    ds_read_b128 v[204:207], v249 offset:7216
    v_exp_f32 v128, v128
    v_exp_f32 v129, v129
    v_mfma_f32_32x32x16_bf16 v[112:127], v[224:227], v[80:83], v[112:127]
    v_exp_f32 v130, v130
    v_exp_f32 v131, v131
    v_exp_f32 v132, v132
    v_exp_f32 v133, v133
    v_exp_f32 v134, v134
    v_exp_f32 v135, v135
    v_mfma_f32_32x32x16_bf16 v[112:127], v[228:231], v[84:87], v[112:127]
    v_exp_f32 v136, v136
    v_exp_f32 v137, v137
    buffer_load_dwordx4 a[100:103], v4, s[36:39], s83 offen offset:1024
    v_exp_f32 v138, v138
    v_exp_f32 v139, v139
    v_exp_f32 v140, v140
    v_exp_f32 v141, v141
    s_waitcnt lgkmcnt(5)
    v_mfma_f32_32x32x16_bf16 v[64:79], v[184:187], v[16:19], 0
    v_exp_f32 v142, v142
    v_exp_f32 v143, v143
    v_cvt_pk_bf16_f32 v128, v128, v129
    v_cvt_pk_bf16_f32 v129, v130, v131
    v_cvt_pk_bf16_f32 v130, v132, v133
    v_cvt_pk_bf16_f32 v131, v134, v135
    v_cvt_pk_bf16_f32 v132, v136, v137
    buffer_load_dwordx4 a[104:107], v4, s[36:39], s83 offen offset:2048
    v_cvt_pk_bf16_f32 v133, v138, v139
    v_cvt_pk_bf16_f32 v134, v140, v141
    v_cvt_pk_bf16_f32 v135, v142, v143
    ds_read_b128 v[208:211], v251 offset:0
    ds_read_b128 v[212:215], v250 offset:2048
    ds_read_b128 v[216:219], v250 offset:3088
    v_exp_f32 v144, v144
    v_exp_f32 v145, v145
    v_mfma_f32_32x32x16_bf16 v[96:111], v[164:167], v[128:131], v[96:111]
    v_exp_f32 v146, v146
    v_exp_f32 v147, v147
    v_exp_f32 v148, v148
    v_exp_f32 v149, v149
    v_exp_f32 v150, v150
    v_exp_f32 v151, v151
    v_mfma_f32_32x32x16_bf16 v[96:111], v[168:171], v[132:135], v[96:111]
    v_exp_f32 v152, v152
    v_exp_f32 v153, v153
    buffer_load_dwordx4 a[108:111], v4, s[36:39], s83 offen offset:3072
    v_exp_f32 v154, v154
    v_exp_f32 v155, v155
    v_exp_f32 v156, v156
    v_exp_f32 v157, v157
    s_waitcnt lgkmcnt(5)
    v_mfma_f32_32x32x16_bf16 v[80:95], v[196:199], v[16:19], 0
    v_exp_f32 v158, v158
    v_exp_f32 v159, v159
    s_add_u32 s83, s43, 4096
    buffer_load_dwordx4 a[112:115], v4, s[36:39], s83 offen offset:0
    v_cvt_pk_bf16_f32 v144, v144, v145
    v_cvt_pk_bf16_f32 v145, v146, v147
    v_cvt_pk_bf16_f32 v146, v148, v149
    v_cvt_pk_bf16_f32 v147, v150, v151
    v_cvt_pk_bf16_f32 v148, v152, v153
    v_cvt_pk_bf16_f32 v149, v154, v155
    v_cvt_pk_bf16_f32 v150, v156, v157
    v_cvt_pk_bf16_f32 v151, v158, v159
    ds_read_b128 v[220:223], v248 offset:0
    ds_read_b128 v[224:227], v249 offset:2048
    ds_read_b128 v[228:231], v249 offset:3088
    v_exp_f32 v64, v64
    v_exp_f32 v65, v65
    v_mfma_f32_32x32x16_bf16 v[112:127], v[176:179], v[144:147], v[112:127]
    v_exp_f32 v66, v66
    v_exp_f32 v67, v67
    buffer_load_dwordx4 a[116:119], v4, s[36:39], s83 offen offset:1024
    s_lshl_b32 s80, s54, 9
    s_add_u32 s80, s80, 31588352
    v_lshrrev_b32 v37, 4, v1
    v_lshlrev_b32 v37, 7, v37
    buffer_load_dword v36, v37, s[36:39], s80 offen offset:12 sc1
    v_exp_f32 v68, v68
    v_exp_f32 v69, v69
    v_exp_f32 v70, v70
    v_exp_f32 v71, v71
    v_mfma_f32_32x32x16_bf16 v[112:127], v[180:183], v[148:151], v[112:127]
    v_exp_f32 v72, v72
    v_exp_f32 v73, v73
    v_exp_f32 v74, v74
    v_exp_f32 v75, v75
    v_exp_f32 v76, v76
    v_exp_f32 v77, v77
    s_waitcnt lgkmcnt(5)
    v_mfma_f32_32x32x16_bf16 v[128:143], v[208:211], v[20:23], v[232:247]
    v_exp_f32 v78, v78
    v_exp_f32 v79, v79
    buffer_load_dwordx4 a[120:123], v4, s[36:39], s83 offen offset:2048
    v_cvt_pk_bf16_f32 v64, v64, v65
    v_cvt_pk_bf16_f32 v65, v66, v67
    v_cvt_pk_bf16_f32 v66, v68, v69
    v_cvt_pk_bf16_f32 v67, v70, v71
    v_cvt_pk_bf16_f32 v68, v72, v73
    v_cvt_pk_bf16_f32 v69, v74, v75
    v_cvt_pk_bf16_f32 v70, v76, v77
    v_cvt_pk_bf16_f32 v71, v78, v79
    v_exp_f32 v80, v80
    v_exp_f32 v81, v81
    v_mfma_f32_32x32x16_bf16 v[96:111], v[188:191], v[64:67], v[96:111]
    v_exp_f32 v82, v82
    v_exp_f32 v83, v83
    buffer_load_dwordx4 a[124:127], v4, s[36:39], s83 offen offset:3072
    v_exp_f32 v84, v84
    v_exp_f32 v85, v85
    v_exp_f32 v86, v86
    v_exp_f32 v87, v87
    v_mfma_f32_32x32x16_bf16 v[96:111], v[192:195], v[68:71], v[96:111]
    v_exp_f32 v88, v88
    v_exp_f32 v89, v89
    v_exp_f32 v90, v90
    v_exp_f32 v91, v91
    v_exp_f32 v92, v92
    v_exp_f32 v93, v93
    s_waitcnt lgkmcnt(2)
    v_mfma_f32_32x32x16_bf16 v[144:159], v[220:223], v[16:19], v[232:247]
    v_exp_f32 v94, v94
    v_exp_f32 v95, v95
    v_cvt_pk_bf16_f32 v80, v80, v81
    v_cvt_pk_bf16_f32 v81, v82, v83
    v_cvt_pk_bf16_f32 v82, v84, v85
    v_cvt_pk_bf16_f32 v83, v86, v87
    v_cvt_pk_bf16_f32 v84, v88, v89
    v_cvt_pk_bf16_f32 v85, v90, v91
    v_cvt_pk_bf16_f32 v86, v92, v93
    v_cvt_pk_bf16_f32 v87, v94, v95
    v_exp_f32 v128, v128
    v_exp_f32 v129, v129
    v_mfma_f32_32x32x16_bf16 v[96:111], v[200:203], v[80:83], v[96:111]
    v_exp_f32 v130, v130
    v_exp_f32 v131, v131
    v_exp_f32 v132, v132
    v_exp_f32 v133, v133
    v_exp_f32 v134, v134
    v_exp_f32 v135, v135
    v_mfma_f32_32x32x16_bf16 v[96:111], v[204:207], v[84:87], v[96:111]
    v_exp_f32 v136, v136
    v_exp_f32 v137, v137
    v_exp_f32 v138, v138
    v_exp_f32 v139, v139
    v_exp_f32 v140, v140
    v_exp_f32 v141, v141
    v_exp_f32 v142, v142
    v_exp_f32 v143, v143
    v_cvt_pk_bf16_f32 v128, v128, v129
    v_cvt_pk_bf16_f32 v129, v130, v131
    v_cvt_pk_bf16_f32 v130, v132, v133
    v_cvt_pk_bf16_f32 v131, v134, v135
    v_cvt_pk_bf16_f32 v132, v136, v137
    v_cvt_pk_bf16_f32 v133, v138, v139
    v_cvt_pk_bf16_f32 v134, v140, v141
    v_cvt_pk_bf16_f32 v135, v142, v143
    v_exp_f32 v144, v144
    v_exp_f32 v145, v145
    v_mfma_f32_32x32x16_bf16 v[112:127], v[212:215], v[128:131], v[112:127]
    v_exp_f32 v146, v146
    v_exp_f32 v147, v147
    v_exp_f32 v148, v148
    v_exp_f32 v149, v149
    v_exp_f32 v150, v150
    v_exp_f32 v151, v151
    v_mfma_f32_32x32x16_bf16 v[112:127], v[216:219], v[132:135], v[112:127]
    v_exp_f32 v152, v152
    v_exp_f32 v153, v153
    v_exp_f32 v154, v154
    v_exp_f32 v155, v155
    v_exp_f32 v156, v156
    v_exp_f32 v157, v157
    v_exp_f32 v158, v158
    v_exp_f32 v159, v159
    v_cvt_pk_bf16_f32 v144, v144, v145
    v_cvt_pk_bf16_f32 v145, v146, v147
    v_cvt_pk_bf16_f32 v146, v148, v149
    v_cvt_pk_bf16_f32 v147, v150, v151
    v_cvt_pk_bf16_f32 v148, v152, v153
    v_cvt_pk_bf16_f32 v149, v154, v155
    v_cvt_pk_bf16_f32 v150, v156, v157
    v_cvt_pk_bf16_f32 v151, v158, v159
    s_nop 1
    s_waitcnt lgkmcnt(0)
    v_mfma_f32_32x32x16_bf16 v[96:111], v[224:227], v[144:147], v[96:111]
    v_mfma_f32_32x32x16_bf16 v[96:111], v[228:231], v[148:151], v[96:111]
    s_add_u32 s82, s58, s92
    s_add_u32 s83, s58, s94
    v_rcp_f32 v28, v120
    v_mov_b32 v29, 0x10000
    v_mul_f32 v112, v28, v112
    v_mul_f32 v113, v28, v113
    v_mul_f32 v114, v28, v114
    v_mul_f32 v115, v28, v115
    v_mul_f32 v116, v28, v116
    v_mul_f32 v117, v28, v117
    v_mul_f32 v118, v28, v118
    v_mul_f32 v119, v28, v119
    v_add_u32 v113, s75, v113
    v_and_b32 v113, 0xfffe0000, v113
    v_cvt_pk_bf16_f32 v68, v112, v113
    v_cvt_pk_bf16_f32 v69, v114, v115
    v_cvt_pk_bf16_f32 v70, v116, v117
    v_cvt_pk_bf16_f32 v71, v118, v119
    v_bfi_b32 v68, v29, s74, v68
    v_max_f32 v25, v104, v120
    v_min_f32 v26, v104, v120
    v_add_f32 v27, v104, v120
    v_cmp_nle_f32 vcc, v25, s100
    v_cmp_nge_f32 s[68:69], v26, s101
    s_or_b64 vcc, vcc, s[68:69]
    v_cmp_u_f32 s[68:69], v27, v27
    s_or_b64 vcc, vcc, s[68:69]
    s_cbranch_vccnz L_fb_24
L_fbk_25:
    s_cmp_eq_u32 s7, 0
    s_cbranch_scc1 L_stsl_33
    buffer_store_dwordx4 v[68:71], v4, s[36:39], s83 offen
L_stdn_34:
    v_rcp_f32 v28, v104
    v_mov_b32 v29, 0x10000
    v_mul_f32 v96, v28, v96
    v_mul_f32 v97, v28, v97
    v_mul_f32 v98, v28, v98
    v_mul_f32 v99, v28, v99
    v_mul_f32 v100, v28, v100
    v_mul_f32 v101, v28, v101
    v_mul_f32 v102, v28, v102
    v_mul_f32 v103, v28, v103
    v_add_u32 v97, s75, v97
    v_and_b32 v97, 0xfffe0000, v97
    v_cvt_pk_bf16_f32 v64, v96, v97
    v_cvt_pk_bf16_f32 v65, v98, v99
    v_cvt_pk_bf16_f32 v66, v100, v101
    v_cvt_pk_bf16_f32 v67, v102, v103
    v_bfi_b32 v64, v29, s74, v64
    s_cmp_eq_u32 s7, 0
    s_cbranch_scc1 L_stsl_35
    buffer_store_dwordx4 v[64:67], v4, s[36:39], s82 offen
L_stdn_36:
    s_mul_i32 s81, s3, 8256
    s_mov_b32 s76, s63
    s_add_u32 s77, s63, 4096
    s_barrier
L_trp_37:
    s_waitcnt vmcnt(2)
    v_cmp_eq_u32 vcc, -1, v36
    s_and_b64 vcc, vcc, s[44:45]
    s_cbranch_vccnz L_ocl_39
L_ock_40:
    v_lshlrev_b32 v14, 6, v2
    v_lshl_add_u32 v14, v3, 3, v14
    s_lshl_b32 s46, s3, 11
    v_add_u32 v14, s46, v14
    ds_read_b64 v[96:97], v14 offset:49664
    ds_read_b64 v[98:99], v14 offset:49680
    ds_read_b64 v[100:101], v14 offset:49696
    ds_read_b64 v[102:103], v14 offset:49712
    v_bfe_u32 v14, v1, 2, 2
    v_lshlrev_b32 v14, 6, v14
    v_bfe_u32 v15, v1, 4, 1
    v_lshl_add_u32 v14, v15, 5, v14
    v_and_b32 v15, 3, v1
    v_lshl_add_u32 v14, v15, 3, v14
    v_lshl_add_u32 v14, v3, 8, v14
    v_add_u32 v5, 65536, v14
    v_add_u32 v6, 66048, v14
    v_add_u32 v7, 98304, v14
    v_add_u32 v8, 98816, v14
    v_add_u32 v9, 131072, v14
    v_add_u32 v10, 131584, v14
    s_lshl_b32 s48, s3, 10
    v_add_u32 v14, s48, v5
    s_add_u32 m0, s81, 0
    v_add_u32 v15, s48, v9
    buffer_load_dwordx4 v4, s[36:39], s76 offen offset:0 sc1 lds
    ds_read_b64_tr_b16 v[160:161], v14 offset:0
    ds_read_b64_tr_b16 v[162:163], v14 offset:512
    ds_read_b64_tr_b16 v[164:165], v14 offset:4096
    ds_read_b64_tr_b16 v[166:167], v14 offset:4608
    ds_read_b64_tr_b16 v[168:169], v14 offset:8192
    ds_read_b64_tr_b16 v[170:171], v14 offset:8704
    buffer_load_dwordx4 v4, s[36:39], s76 offen offset:1024 sc1 lds
    ds_read_b64_tr_b16 v[172:173], v14 offset:12288
    ds_read_b64_tr_b16 v[174:175], v14 offset:12800
    ds_read_b64_tr_b16 v[176:177], v14 offset:16384
    ds_read_b64_tr_b16 v[178:179], v14 offset:16896
    ds_read_b64_tr_b16 v[180:181], v14 offset:20480
    ds_read_b64_tr_b16 v[182:183], v14 offset:20992
    buffer_load_dwordx4 v4, s[36:39], s76 offen offset:2048 sc1 lds
    ds_read_b64_tr_b16 v[184:185], v14 offset:24576
    ds_read_b64_tr_b16 v[186:187], v14 offset:25088
    s_waitcnt lgkmcnt(12)
    v_mfma_f32_16x16x32_bf16 v[20:23], a[132:135], v[160:163], 0
    ds_read_b64_tr_b16 v[188:189], v14 offset:28672
    s_add_u32 m0, s81, 16
    ds_read_b64_tr_b16 v[190:191], v14 offset:29184
    buffer_load_dwordx4 v4, s[36:39], s76 offen offset:3072 sc1 lds
    s_waitcnt lgkmcnt(12)
    v_mfma_f32_16x16x32_bf16 v[20:23], a[132:135], v[164:167], v[20:23]
    ds_read_b64_tr_b16 v[160:161], v14 offset:32768
    ds_read_b64_tr_b16 v[162:163], v14 offset:33280
    s_waitcnt lgkmcnt(12)
    v_mfma_f32_16x16x32_bf16 v[20:23], a[132:135], v[168:171], v[20:23]
    ds_read_b64_tr_b16 v[164:165], v14 offset:36864
    ds_read_b64_tr_b16 v[166:167], v14 offset:37376
    s_waitcnt lgkmcnt(12)
    v_mfma_f32_16x16x32_bf16 v[20:23], a[132:135], v[172:175], v[20:23]
    ds_read_b64_tr_b16 v[168:169], v14 offset:40960
    s_add_u32 m0, s81, 4128
    ds_read_b64_tr_b16 v[170:171], v14 offset:41472
    buffer_load_dwordx4 v4, s[36:39], s77 offen offset:0 sc1 lds
    s_waitcnt lgkmcnt(12)
    v_mfma_f32_16x16x32_bf16 v[20:23], a[132:135], v[176:179], v[20:23]
    ds_read_b64_tr_b16 v[172:173], v14 offset:45056
    ds_read_b64_tr_b16 v[174:175], v14 offset:45568
    s_waitcnt lgkmcnt(12)
    v_mfma_f32_16x16x32_bf16 v[20:23], a[132:135], v[180:183], v[20:23]
    ds_read_b64_tr_b16 v[176:177], v14 offset:49152
    ds_read_b64_tr_b16 v[178:179], v14 offset:49664
    s_waitcnt lgkmcnt(12)
    v_mfma_f32_16x16x32_bf16 v[20:23], a[132:135], v[184:187], v[20:23]
    ds_read_b64_tr_b16 v[180:181], v14 offset:53248
    ds_read_b64_tr_b16 v[182:183], v14 offset:53760
    buffer_load_dwordx4 v4, s[36:39], s77 offen offset:1024 sc1 lds
    s_waitcnt lgkmcnt(12)
    v_mfma_f32_16x16x32_bf16 v[20:23], a[132:135], v[188:191], v[20:23]
    ds_read_b64_tr_b16 v[184:185], v14 offset:57344
    ds_read_b64_tr_b16 v[186:187], v14 offset:57856
    s_waitcnt lgkmcnt(12)
    v_mfma_f32_16x16x32_bf16 v[20:23], a[136:139], v[160:163], v[20:23]
    ds_read_b64_tr_b16 v[188:189], v14 offset:61440
    ds_read_b64_tr_b16 v[190:191], v14 offset:61952
    s_waitcnt lgkmcnt(12)
    v_mfma_f32_16x16x32_bf16 v[20:23], a[136:139], v[164:167], v[20:23]
    ds_read_b64_tr_b16 v[160:161], v15 offset:0
    ds_read_b64_tr_b16 v[162:163], v15 offset:512
    buffer_load_dwordx4 v4, s[36:39], s77 offen offset:2048 sc1 lds
    s_waitcnt lgkmcnt(12)
    v_mfma_f32_16x16x32_bf16 v[20:23], a[136:139], v[168:171], v[20:23]
    ds_read_b64_tr_b16 v[164:165], v15 offset:4096
    ds_read_b64_tr_b16 v[166:167], v15 offset:4608
    s_waitcnt lgkmcnt(12)
    v_mfma_f32_16x16x32_bf16 v[20:23], a[136:139], v[172:175], v[20:23]
    ds_read_b64_tr_b16 v[168:169], v15 offset:8192
    ds_read_b64_tr_b16 v[170:171], v15 offset:8704
    s_waitcnt lgkmcnt(12)
    v_mfma_f32_16x16x32_bf16 v[20:23], a[136:139], v[176:179], v[20:23]
    ds_read_b64_tr_b16 v[172:173], v15 offset:12288
    s_add_u32 m0, s81, 4144
    ds_read_b64_tr_b16 v[174:175], v15 offset:12800
    buffer_load_dwordx4 v4, s[36:39], s77 offen offset:3072 sc1 lds
    s_waitcnt lgkmcnt(12)
    v_mfma_f32_16x16x32_bf16 v[20:23], a[136:139], v[180:183], v[20:23]
    ds_read_b64_tr_b16 v[176:177], v15 offset:16384
    ds_read_b64_tr_b16 v[178:179], v15 offset:16896
    s_waitcnt lgkmcnt(12)
    v_mfma_f32_16x16x32_bf16 v[20:23], a[136:139], v[184:187], v[20:23]
    ds_read_b64_tr_b16 v[180:181], v15 offset:20480
    ds_read_b64_tr_b16 v[182:183], v15 offset:20992
    s_waitcnt lgkmcnt(12)
    v_mfma_f32_16x16x32_bf16 v[20:23], a[136:139], v[188:191], v[20:23]
    ds_read_b64_tr_b16 v[184:185], v15 offset:24576
    ds_read_b64_tr_b16 v[186:187], v15 offset:25088
    s_waitcnt lgkmcnt(12)
    v_mfma_f32_16x16x32_bf16 v[20:23], a[140:143], v[160:163], v[20:23]
    ds_read_b64_tr_b16 v[188:189], v15 offset:28672
    ds_read_b64_tr_b16 v[190:191], v15 offset:29184
    s_waitcnt lgkmcnt(12)
    v_mfma_f32_16x16x32_bf16 v[20:23], a[140:143], v[164:167], v[20:23]
    s_waitcnt lgkmcnt(10)
    v_mfma_f32_16x16x32_bf16 v[20:23], a[140:143], v[168:171], v[20:23]
    s_waitcnt lgkmcnt(8)
    v_mfma_f32_16x16x32_bf16 v[20:23], a[140:143], v[172:175], v[20:23]
    s_waitcnt lgkmcnt(6)
    v_mfma_f32_16x16x32_bf16 v[20:23], a[140:143], v[176:179], v[20:23]
    s_waitcnt lgkmcnt(4)
    v_mfma_f32_16x16x32_bf16 v[20:23], a[140:143], v[180:183], v[20:23]
    s_waitcnt lgkmcnt(2)
    v_mfma_f32_16x16x32_bf16 v[20:23], a[140:143], v[184:187], v[20:23]
    s_waitcnt lgkmcnt(0)
    v_mfma_f32_16x16x32_bf16 v[20:23], a[140:143], v[188:191], v[20:23]
    v_lshlrev_b32 v14, 2, v1
    s_lshl_b32 s46, s3, 8
    v_add_u32 v14, s46, v14
    v_lshlrev_b32 v64, 16, v96
    v_and_b32 v65, 0xffff0000, v96
    v_lshlrev_b32 v66, 16, v97
    v_and_b32 v67, 0xffff0000, v97
    v_lshlrev_b32 v68, 16, v98
    v_and_b32 v69, 0xffff0000, v98
    v_lshlrev_b32 v70, 16, v99
    v_and_b32 v71, 0xffff0000, v99
    v_lshlrev_b32 v72, 16, v100
    v_and_b32 v73, 0xffff0000, v100
    v_lshlrev_b32 v74, 16, v101
    v_and_b32 v75, 0xffff0000, v101
    v_lshlrev_b32 v76, 16, v102
    v_and_b32 v77, 0xffff0000, v102
    v_lshlrev_b32 v78, 16, v103
    v_and_b32 v79, 0xffff0000, v103
    s_mul_i32 s46, s3, 8256
    v_add_u32 v104, s46, v4
    s_add_u32 s46, s3, 1
    s_and_b32 s46, s46, 3
    s_mul_i32 s46, s46, 8256
    v_add_u32 v105, s46, v4
    s_add_u32 s46, s3, 2
    s_and_b32 s46, s46, 3
    s_mul_i32 s46, s46, 8256
    v_add_u32 v106, s46, v4
    s_add_u32 s46, s3, 3
    s_and_b32 s46, s46, 3
    s_mul_i32 s46, s46, 8256
    v_add_u32 v107, s46, v4
    ds_write_b32 v14, v21 offset:61440
    ds_write_b32 v14, v22 offset:62464
    ds_write_b32 v14, v23 offset:63488
    s_waitcnt lgkmcnt(0)
L_trr_38:
L_swr_42:
    s_mov_b32 s52, 0
L_opv_44:
L_ort_48:
    s_waitcnt vmcnt(7)
    ds_read_b128 v[128:131], v104 offset:0
    s_waitcnt vmcnt(6)
    ds_read_b128 v[132:135], v104 offset:1024
    s_waitcnt vmcnt(5)
    ds_read_b128 v[136:139], v104 offset:2048
    s_waitcnt lgkmcnt(2)
    v_mfma_f32_32x32x16_bf16 v[64:79], a[0:3], v[128:131], v[64:79]
    v_xor_b32 v14, s74, v128
    s_waitcnt vmcnt(4)
    ds_read_b128 v[140:143], v104 offset:3088
    s_waitcnt lgkmcnt(2)
    v_mfma_f32_32x32x16_bf16 v[64:79], a[4:7], v[132:135], v[64:79]
    v_bitop3_b32 v14, v14, v132, s74 bitop3:0xf6
    s_waitcnt vmcnt(3)
    ds_read_b128 v[144:147], v104 offset:4128
    s_waitcnt lgkmcnt(2)
    v_mfma_f32_32x32x16_bf16 v[64:79], a[8:11], v[136:139], v[64:79]
    v_bitop3_b32 v14, v14, v136, s74 bitop3:0xf6
    s_waitcnt vmcnt(2)
    ds_read_b128 v[148:151], v104 offset:5152
    s_waitcnt lgkmcnt(2)
    v_mfma_f32_32x32x16_bf16 v[64:79], a[12:15], v[140:143], v[64:79]
    v_bitop3_b32 v14, v14, v140, s74 bitop3:0xf6
    s_waitcnt vmcnt(1)
    ds_read_b128 v[152:155], v104 offset:6176
    s_waitcnt lgkmcnt(2)
    v_mfma_f32_32x32x16_bf16 v[64:79], a[16:19], v[144:147], v[64:79]
    v_bitop3_b32 v14, v14, v144, s74 bitop3:0xf6
    s_waitcnt vmcnt(0)
    ds_read_b128 v[156:159], v104 offset:7216
    s_waitcnt lgkmcnt(2)
    v_bitop3_b32 v14, v14, v148, s74 bitop3:0xf6
    s_waitcnt lgkmcnt(1)
    v_bitop3_b32 v14, v14, v152, s74 bitop3:0xf6
    s_waitcnt lgkmcnt(0)
    v_bitop3_b32 v14, v14, v156, s74 bitop3:0xf6
    v_and_b32 v14, 0x10000, v14
    v_cmp_ne_u32 vcc, 0, v14
    s_and_b64 vcc, vcc, s[44:45]
    s_cbranch_vccnz L_osl_49
    s_barrier
    s_min_u32 s46, s3, 2
    s_lshl_b32 s47, s46, 10
    v_lshlrev_b32 v42, 2, v2
    v_add_u32 v42, s47, v42
    ds_read_b32 v32, v42 offset:61440
    ds_read_b32 v33, v42 offset:61696
    ds_read_b32 v34, v42 offset:61952
    ds_read_b32 v35, v42 offset:62208
    ds_read_b128 v[160:163], v105 offset:0
    ds_read_b128 v[164:167], v105 offset:1024
    ds_read_b128 v[168:171], v105 offset:2048
    ds_read_b128 v[172:175], v105 offset:3088
    v_mfma_f32_32x32x16_bf16 v[64:79], a[20:23], v[148:151], v[64:79]
    ds_read_b128 v[176:179], v105 offset:4128
    ds_read_b128 v[180:183], v105 offset:5152
    s_add_u32 s51, s40, 524288
    buffer_load_dwordx4 a[0:3], v4, s[36:39], s51 offen offset:0
    v_mfma_f32_32x32x16_bf16 v[64:79], a[24:27], v[152:155], v[64:79]
    ds_read_b128 v[184:187], v105 offset:6176
    ds_read_b128 v[188:191], v105 offset:7216
    s_waitcnt lgkmcnt(8)
    v_mfma_f32_32x32x16_bf16 v[64:79], a[28:31], v[156:159], v[64:79]
    ds_read_b128 v[192:195], v106 offset:0
    ds_read_b128 v[196:199], v106 offset:1024
    buffer_load_dwordx4 a[4:7], v4, s[36:39], s51 offen offset:1024
    v_add_f32 v32, v32, v33
    v_add_f32 v32, v32, v34
    s_waitcnt lgkmcnt(9)
    v_mfma_f32_32x32x16_bf16 v[64:79], a[32:35], v[160:163], v[64:79]
    ds_read_b128 v[200:203], v106 offset:2048
    ds_read_b128 v[204:207], v106 offset:3088
    v_add_f32 v32, v32, v35
    v_cvt_pk_bf16_f32 v33, v32, v32
    s_waitcnt lgkmcnt(10)
    v_mfma_f32_32x32x16_bf16 v[64:79], a[36:39], v[164:167], v[64:79]
    ds_read_b128 v[208:211], v106 offset:4128
    ds_read_b128 v[212:215], v106 offset:5152
    buffer_load_dwordx4 a[8:11], v4, s[36:39], s51 offen offset:2048
    v_and_b32 v34, 0xffff0000, v33
    v_sub_f32 v35, v32, v34
    s_waitcnt lgkmcnt(11)
    v_mfma_f32_32x32x16_bf16 v[64:79], a[40:43], v[168:171], v[64:79]
    ds_read_b128 v[216:219], v106 offset:6176
    ds_read_b128 v[220:223], v106 offset:7216
    v_cvt_pk_bf16_f32 v36, v35, v35
    v_and_b32 v37, 0xffff0000, v36
    s_waitcnt lgkmcnt(12)
    v_mfma_f32_32x32x16_bf16 v[64:79], a[44:47], v[172:175], v[64:79]
    ds_read_b128 v[224:227], v107 offset:0
    buffer_load_dwordx4 a[12:15], v4, s[36:39], s51 offen offset:3072
    v_sub_f32 v38, v35, v37
    v_cvt_pk_bf16_f32 v39, v38, v38
    s_waitcnt lgkmcnt(12)
    v_mfma_f32_32x32x16_bf16 v[64:79], a[48:51], v[176:179], v[64:79]
    ds_read_b128 v[228:231], v107 offset:1024
    v_lshrrev_b32 v40, 16, v34
    v_or_b32 v40, v40, v37
    s_waitcnt lgkmcnt(12)
    v_mfma_f32_32x32x16_bf16 v[64:79], a[52:55], v[180:183], v[64:79]
    ds_read_b128 v[232:235], v107 offset:2048
    v_and_b32 v41, 0xffff, v39
    s_lshl_b32 s46, s46, 8
    s_waitcnt lgkmcnt(12)
    v_mfma_f32_32x32x16_bf16 v[64:79], a[56:59], v[184:187], v[64:79]
    ds_read_b128 v[236:239], v107 offset:3088
    s_add_u32 s51, s40, 528384
    buffer_load_dwordx4 a[16:19], v4, s[36:39], s51 offen offset:0
    v_lshlrev_b32 v42, 3, v2
    v_add_u32 v42, s46, v42
    s_waitcnt lgkmcnt(12)
    v_mfma_f32_32x32x16_bf16 v[64:79], a[60:63], v[188:191], v[64:79]
    ds_read_b128 v[240:243], v107 offset:4128
    s_add_u32 s78, s57, 0
    s_add_u32 s79, s57, 4096
    s_waitcnt lgkmcnt(12)
    v_mfma_f32_32x32x16_bf16 v[64:79], a[64:67], v[192:195], v[64:79]
    ds_read_b128 v[244:247], v107 offset:5152
    buffer_load_dwordx4 a[20:23], v4, s[36:39], s51 offen offset:1024
    s_add_u32 s80, s57, 8192
    s_add_u32 s81, s57, 12288
    s_waitcnt lgkmcnt(12)
    v_mfma_f32_32x32x16_bf16 v[64:79], a[68:71], v[196:199], v[64:79]
    ds_read_b128 v[248:251], v107 offset:6176
    s_add_u32 s82, s57, 16384
    s_add_u32 s83, s57, 20480
    s_waitcnt lgkmcnt(12)
    v_mfma_f32_32x32x16_bf16 v[64:79], a[72:75], v[200:203], v[64:79]
    ds_read_b128 v[252:255], v107 offset:7216
    buffer_load_dwordx4 a[24:27], v4, s[36:39], s51 offen offset:2048
    s_add_u32 s64, s57, 24576
    s_add_u32 s65, s57, 28672
    s_waitcnt lgkmcnt(12)
    v_mfma_f32_32x32x16_bf16 v[64:79], a[76:79], v[204:207], v[64:79]
    v_lshrrev_b32 v108, 2, v1
    v_lshlrev_b32 v108, 11, v108
    s_waitcnt lgkmcnt(11)
    v_mfma_f32_32x32x16_bf16 v[64:79], a[80:83], v[208:211], v[64:79]
    buffer_load_dwordx4 a[28:31], v4, s[36:39], s51 offen offset:3072
    v_add_u32 v108, 2032, v108
    s_waitcnt lgkmcnt(10)
    v_mfma_f32_32x32x16_bf16 v[64:79], a[84:87], v[212:215], v[64:79]
    s_waitcnt lgkmcnt(9)
    v_mfma_f32_32x32x16_bf16 v[64:79], a[88:91], v[216:219], v[64:79]
    s_waitcnt lgkmcnt(8)
    v_mfma_f32_32x32x16_bf16 v[64:79], a[92:95], v[220:223], v[64:79]
    s_add_u32 s51, s41, 524288
    buffer_load_dwordx4 a[32:35], v4, s[36:39], s51 offen offset:0
    s_waitcnt lgkmcnt(7)
    v_mfma_f32_32x32x16_bf16 v[64:79], a[96:99], v[224:227], v[64:79]
    s_waitcnt lgkmcnt(6)
    v_mfma_f32_32x32x16_bf16 v[64:79], a[100:103], v[228:231], v[64:79]
    buffer_load_dwordx4 a[36:39], v4, s[36:39], s51 offen offset:1024
    s_waitcnt lgkmcnt(5)
    v_mfma_f32_32x32x16_bf16 v[64:79], a[104:107], v[232:235], v[64:79]
    s_waitcnt lgkmcnt(4)
    v_mfma_f32_32x32x16_bf16 v[64:79], a[108:111], v[236:239], v[64:79]
    buffer_load_dwordx4 a[40:43], v4, s[36:39], s51 offen offset:2048
    s_waitcnt lgkmcnt(3)
    v_mfma_f32_32x32x16_bf16 v[64:79], a[112:115], v[240:243], v[64:79]
    s_waitcnt lgkmcnt(2)
    v_mfma_f32_32x32x16_bf16 v[64:79], a[116:119], v[244:247], v[64:79]
    buffer_load_dwordx4 a[44:47], v4, s[36:39], s51 offen offset:3072
    s_waitcnt lgkmcnt(1)
    v_mfma_f32_32x32x16_bf16 v[64:79], a[120:123], v[248:251], v[64:79]
    s_waitcnt lgkmcnt(0)
    v_mfma_f32_32x32x16_bf16 v[64:79], a[124:127], v[252:255], v[64:79]
    ds_write_b64 v42, v[40:41] offset:58624
L_opD_43:
    s_nop 2
    v_mov_b32 v22, 0x10000
    s_nop 7
    v_add_u32 v104, s75, v65
    v_and_b32 v104, 0xfffe0000, v104
    v_add_u32 v105, s75, v73
    v_and_b32 v105, 0xfffe0000, v105
    v_cvt_pk_bf16_f32 v96, v64, v104
    v_cvt_pk_bf16_f32 v97, v66, v67
    v_cvt_pk_bf16_f32 v98, v68, v69
    v_cvt_pk_bf16_f32 v99, v70, v71
    v_cvt_pk_bf16_f32 v100, v72, v105
    v_cvt_pk_bf16_f32 v101, v74, v75
    v_cvt_pk_bf16_f32 v102, v76, v77
    v_cvt_pk_bf16_f32 v103, v78, v79
    v_bfi_b32 v96, v22, s74, v96
    v_bfi_b32 v100, v22, s74, v100
    s_cmp_eq_u32 s7, 0
    s_cbranch_scc1 L_stsl_51
    buffer_store_dwordx4 v[96:99], v4, s[28:31], s61 offen
    buffer_store_dwordx4 v[100:103], v4, s[28:31], s61 offen offset:1024
L_stdn_52:
    s_add_u32 s51, s41, 528384
    buffer_load_dwordx4 a[48:51], v4, s[36:39], s51 offen offset:0
    v_cvt_pk_bf16_f32 v104, v64, v65
    v_cvt_pk_bf16_f32 v105, v72, v73
    v_lshlrev_b32 v64, 16, v104
    v_and_b32 v65, 0xffff0000, v104
    v_lshlrev_b32 v66, 16, v97
    v_and_b32 v67, 0xffff0000, v97
    v_lshlrev_b32 v68, 16, v98
    buffer_load_dwordx4 a[52:55], v4, s[36:39], s51 offen offset:1024
    v_and_b32 v69, 0xffff0000, v98
    v_lshlrev_b32 v70, 16, v99
    v_and_b32 v71, 0xffff0000, v99
    v_lshlrev_b32 v72, 16, v105
    v_and_b32 v73, 0xffff0000, v105
    v_lshlrev_b32 v74, 16, v101
    v_and_b32 v75, 0xffff0000, v101
    buffer_load_dwordx4 a[56:59], v4, s[36:39], s51 offen offset:2048
    v_lshlrev_b32 v76, 16, v102
    v_and_b32 v77, 0xffff0000, v102
    v_lshlrev_b32 v78, 16, v103
    v_and_b32 v79, 0xffff0000, v103
    v_add_f32 v20, v64, v65
    v_mul_f32 v21, v64, v64
    v_fmac_f32 v21, v65, v65
    buffer_load_dwordx4 a[60:63], v4, s[36:39], s51 offen offset:3072
    v_add_f32 v20, v20, v66
    v_fmac_f32 v21, v66, v66
    v_add_f32 v20, v20, v67
    v_fmac_f32 v21, v67, v67
    v_add_f32 v20, v20, v68
    v_fmac_f32 v21, v68, v68
    v_add_f32 v20, v20, v69
    v_fmac_f32 v21, v69, v69
    v_add_f32 v20, v20, v70
    v_fmac_f32 v21, v70, v70
    v_add_f32 v20, v20, v71
    v_fmac_f32 v21, v71, v71
    v_add_f32 v20, v20, v72
    v_fmac_f32 v21, v72, v72
    v_add_f32 v20, v20, v73
    v_fmac_f32 v21, v73, v73
    v_add_f32 v20, v20, v74
    v_fmac_f32 v21, v74, v74
    v_add_f32 v20, v20, v75
    v_fmac_f32 v21, v75, v75
    v_add_f32 v20, v20, v76
    v_fmac_f32 v21, v76, v76
    v_add_f32 v20, v20, v77
    v_fmac_f32 v21, v77, v77
    v_add_f32 v20, v20, v78
    v_fmac_f32 v21, v78, v78
    v_add_f32 v20, v20, v79
    v_fmac_f32 v21, v79, v79
    v_lshlrev_b32 v14, 3, v1
    s_lshl_b32 s46, s3, 9
    v_add_u32 v15, s46, v14
    ds_write_b64 v15, v[20:21] offset:61440
    s_waitcnt lgkmcnt(0)
    s_barrier
    ds_read_b64 v[22:23], v14 offset:61440
    ds_read_b64 v[24:25], v14 offset:62464
    ds_read_b64 v[26:27], v14 offset:62976
    s_cmp_lg_u32 s3, 1
    s_cbranch_scc1 L_xs_53
    v_lshlrev_b32 v14, 4, v2
    s_waitcnt lgkmcnt(2)
    v_add_f32 v20, v20, v22
    v_add_f32 v21, v21, v23
    s_waitcnt lgkmcnt(1)
    v_add_f32 v20, v20, v24
    v_add_f32 v21, v21, v25
    s_waitcnt lgkmcnt(0)
    v_add_f32 v20, v20, v26
    v_add_f32 v21, v21, v27
    v_mov_b32 v22, v20
    v_mov_b32 v23, v21
    s_nop 1
    v_permlane32_swap_b32 v20, v22
    v_permlane32_swap_b32 v21, v23
    s_nop 1
    v_add_f32 v20, v20, v22
    v_add_f32 v21, v21, v23
    v_bfi_b32 v20, 1, s6, v20
    s_mov_b64 exec, s[66:67]
    s_cmp_eq_u32 s7, 0
    s_cbranch_scc1 L_stsl_54
    buffer_store_dwordx2 v[20:21], v14, s[36:39], s62 offen
L_stdn_55:
    s_mov_b64 exec, -1
L_xs_53:
    buffer_load_dword v109, v108, s[28:31], s57 offen sc1
    buffer_load_dwordx4 v[128:131], v4, s[28:31], s78 offen offset:0 sc1
    buffer_load_dwordx4 v[132:135], v4, s[28:31], s78 offen offset:1024 sc1
    buffer_load_dwordx4 v[136:139], v4, s[28:31], s78 offen offset:2048 sc1
    buffer_load_dwordx4 v[140:143], v4, s[28:31], s78 offen offset:3072 sc1
    buffer_load_dwordx4 v[144:147], v4, s[28:31], s79 offen offset:0 sc1
    buffer_load_dwordx4 v[148:151], v4, s[28:31], s79 offen offset:1024 sc1
    buffer_load_dwordx4 v[152:155], v4, s[28:31], s79 offen offset:2048 sc1
    buffer_load_dwordx4 v[156:159], v4, s[28:31], s79 offen offset:3072 sc1
    v_mov_b32 v96, v104
    v_mov_b32 v100, v105
    s_lshl_b32 s46, s3, 11
    v_add_u32 v14, s46, v4
    ds_write_b128 v14, v[96:99] offset:49664
    ds_write_b128 v14, v[100:103] offset:50688
    s_add_u32 s6, s6, 1
    s_xor_b32 s59, s59, 4096
    s_xor_b32 s74, s74, 0x10000
    s_xor_b32 s75, s75, 0x10000
    s_lshl_b32 s93, s6, 15
    s_and_b32 s93, s93, 65536
    s_xor_b32 s70, s70, 1792
L_xpb_61:
    v_mov_b32 v60, 0
    v_lshlrev_b32 v15, 3, v2
    v_add_u32 v15, s70, v15
    ds_read_b64_tr_b16 v[24:25], v7 offset:0
    ds_read_b64_tr_b16 v[26:27], v8 offset:0
    ds_read_b64_tr_b16 v[28:29], v9 offset:0
    ds_read_b64_tr_b16 v[30:31], v10 offset:0
    ds_read_b64_tr_b16 v[32:33], v7 offset:1024
    ds_read_b64_tr_b16 v[34:35], v8 offset:1024
    ds_read_b64_tr_b16 v[36:37], v9 offset:1024
    ds_read_b64_tr_b16 v[38:39], v10 offset:1024
    ds_read_b64_tr_b16 v[40:41], v7 offset:2048
    ds_read_b64_tr_b16 v[42:43], v8 offset:2048
    ds_read_b64_tr_b16 v[44:45], v9 offset:2048
    ds_read_b64_tr_b16 v[46:47], v10 offset:2048
    s_waitcnt vmcnt(8)
    v_xor_b32 v61, s75, v109
    v_and_b32 v61, 0x10000, v61
    v_cmp_ne_u32 vcc, 0, v61
    s_and_b64 vcc, vcc, s[44:45]
    s_cbranch_vccnz L_xpf_60
    s_waitcnt vmcnt(7) lgkmcnt(8)
    v_mfma_f32_32x32x16_bf16 v[64:79], v[24:27], v[128:131], 0
    ds_read_b64_tr_b16 v[48:49], v7 offset:3072
    ds_read_b64_tr_b16 v[50:51], v8 offset:3072
    buffer_load_dwordx4 v[160:163], v4, s[28:31], s80 offen offset:0 sc1
    v_bitop3_b32 v60, v60, v128, s75 bitop3:0xf6
    v_mfma_f32_32x32x16_bf16 v[80:95], v[128:131], v[28:31], 0
    ds_read_b64_tr_b16 v[52:53], v9 offset:3072
    ds_read_b64_tr_b16 v[54:55], v10 offset:3072
    s_waitcnt vmcnt(7) lgkmcnt(8)
    v_mfma_f32_32x32x16_bf16 v[64:79], v[32:35], v[132:135], v[64:79]
    ds_read_b64_tr_b16 v[24:25], v7 offset:4096
    ds_read_b64_tr_b16 v[26:27], v8 offset:4096
    buffer_load_dwordx4 v[164:167], v4, s[28:31], s80 offen offset:1024 sc1
    v_bitop3_b32 v60, v60, v132, s75 bitop3:0xf6
    v_mfma_f32_32x32x16_bf16 v[80:95], v[132:135], v[36:39], v[80:95]
    ds_read_b64_tr_b16 v[28:29], v9 offset:4096
    ds_read_b64_tr_b16 v[30:31], v10 offset:4096
    s_waitcnt vmcnt(7) lgkmcnt(8)
    v_mfma_f32_32x32x16_bf16 v[64:79], v[40:43], v[136:139], v[64:79]
    ds_read_b64_tr_b16 v[32:33], v7 offset:5120
    ds_read_b64_tr_b16 v[34:35], v8 offset:5120
    buffer_load_dwordx4 v[168:171], v4, s[28:31], s80 offen offset:2048 sc1
    v_bitop3_b32 v60, v60, v136, s75 bitop3:0xf6
    v_mfma_f32_32x32x16_bf16 v[80:95], v[136:139], v[44:47], v[80:95]
    ds_read_b64_tr_b16 v[36:37], v9 offset:5120
    ds_read_b64_tr_b16 v[38:39], v10 offset:5120
    s_waitcnt vmcnt(7) lgkmcnt(8)
    v_mfma_f32_32x32x16_bf16 v[64:79], v[48:51], v[140:143], v[64:79]
    ds_read_b64_tr_b16 v[40:41], v7 offset:6144
    ds_read_b64_tr_b16 v[42:43], v8 offset:6144
    buffer_load_dwordx4 v[172:175], v4, s[28:31], s80 offen offset:3072 sc1
    v_bitop3_b32 v60, v60, v140, s75 bitop3:0xf6
    v_mfma_f32_32x32x16_bf16 v[80:95], v[140:143], v[52:55], v[80:95]
    ds_read_b64_tr_b16 v[44:45], v9 offset:6144
    ds_read_b64_tr_b16 v[46:47], v10 offset:6144
    s_waitcnt vmcnt(7) lgkmcnt(8)
    v_mfma_f32_32x32x16_bf16 v[64:79], v[24:27], v[144:147], v[64:79]
    ds_read_b64_tr_b16 v[48:49], v7 offset:7168
    ds_read_b64_tr_b16 v[50:51], v8 offset:7168
    buffer_load_dwordx4 v[176:179], v4, s[28:31], s81 offen offset:0 sc1
    v_bitop3_b32 v60, v60, v144, s75 bitop3:0xf6
    v_mfma_f32_32x32x16_bf16 v[80:95], v[144:147], v[28:31], v[80:95]
    ds_read_b64_tr_b16 v[52:53], v9 offset:7168
    ds_read_b64_tr_b16 v[54:55], v10 offset:7168
    s_waitcnt vmcnt(7) lgkmcnt(8)
    v_mfma_f32_32x32x16_bf16 v[64:79], v[32:35], v[148:151], v[64:79]
    ds_read_b64_tr_b16 v[24:25], v7 offset:8192
    ds_read_b64_tr_b16 v[26:27], v8 offset:8192
    buffer_load_dwordx4 v[180:183], v4, s[28:31], s81 offen offset:1024 sc1
    v_bitop3_b32 v60, v60, v148, s75 bitop3:0xf6
    v_mfma_f32_32x32x16_bf16 v[80:95], v[148:151], v[36:39], v[80:95]
    ds_read_b64_tr_b16 v[28:29], v9 offset:8192
    ds_read_b64_tr_b16 v[30:31], v10 offset:8192
    s_waitcnt vmcnt(7) lgkmcnt(8)
    v_mfma_f32_32x32x16_bf16 v[64:79], v[40:43], v[152:155], v[64:79]
    ds_read_b64_tr_b16 v[32:33], v7 offset:9216
    ds_read_b64_tr_b16 v[34:35], v8 offset:9216
    buffer_load_dwordx4 v[184:187], v4, s[28:31], s81 offen offset:2048 sc1
    v_bitop3_b32 v60, v60, v152, s75 bitop3:0xf6
    v_mfma_f32_32x32x16_bf16 v[80:95], v[152:155], v[44:47], v[80:95]
    ds_read_b64_tr_b16 v[36:37], v9 offset:9216
    ds_read_b64_tr_b16 v[38:39], v10 offset:9216
    s_waitcnt vmcnt(7) lgkmcnt(8)
    v_mfma_f32_32x32x16_bf16 v[64:79], v[48:51], v[156:159], v[64:79]
    ds_read_b64_tr_b16 v[40:41], v7 offset:10240
    ds_read_b64_tr_b16 v[42:43], v8 offset:10240
    buffer_load_dwordx4 v[188:191], v4, s[28:31], s81 offen offset:3072 sc1
    v_bitop3_b32 v60, v60, v156, s75 bitop3:0xf6
    v_mfma_f32_32x32x16_bf16 v[80:95], v[156:159], v[52:55], v[80:95]
    ds_read_b64_tr_b16 v[44:45], v9 offset:10240
    ds_read_b64_tr_b16 v[46:47], v10 offset:10240
    s_waitcnt vmcnt(7) lgkmcnt(8)
    v_mfma_f32_32x32x16_bf16 v[64:79], v[24:27], v[160:163], v[64:79]
    ds_read_b64_tr_b16 v[48:49], v7 offset:11264
    ds_read_b64_tr_b16 v[50:51], v8 offset:11264
    buffer_load_dwordx4 v[192:195], v4, s[28:31], s82 offen offset:0 sc1
    v_bitop3_b32 v60, v60, v160, s75 bitop3:0xf6
    v_mfma_f32_32x32x16_bf16 v[80:95], v[160:163], v[28:31], v[80:95]
    ds_read_b64_tr_b16 v[52:53], v9 offset:11264
    ds_read_b64_tr_b16 v[54:55], v10 offset:11264
    v_and_b32 v61, 0x10000, v60
    v_cmp_ne_u32 vcc, 0, v61
    s_and_b64 vcc, vcc, s[44:45]
    s_cbranch_vccnz L_xrs_62
    s_waitcnt vmcnt(7) lgkmcnt(8)
    v_mfma_f32_32x32x16_bf16 v[64:79], v[32:35], v[164:167], v[64:79]
    ds_read_b64_tr_b16 v[24:25], v7 offset:12288
    ds_read_b64_tr_b16 v[26:27], v8 offset:12288
    buffer_load_dwordx4 v[196:199], v4, s[28:31], s82 offen offset:1024 sc1
    v_bitop3_b32 v60, v60, v164, s75 bitop3:0xf6
    v_mfma_f32_32x32x16_bf16 v[80:95], v[164:167], v[36:39], v[80:95]
    ds_read_b64_tr_b16 v[28:29], v9 offset:12288
    ds_read_b64_tr_b16 v[30:31], v10 offset:12288
    s_lshr_b32 s47, s3, 1
    s_waitcnt vmcnt(7) lgkmcnt(8)
    v_mfma_f32_32x32x16_bf16 v[64:79], v[40:43], v[168:171], v[64:79]
    ds_read_b64_tr_b16 v[32:33], v7 offset:13312
    ds_read_b64_tr_b16 v[34:35], v8 offset:13312
    buffer_load_dwordx4 v[200:203], v4, s[28:31], s82 offen offset:2048 sc1
    v_bitop3_b32 v60, v60, v168, s75 bitop3:0xf6
    v_mfma_f32_32x32x16_bf16 v[80:95], v[168:171], v[44:47], v[80:95]
    ds_read_b64_tr_b16 v[36:37], v9 offset:13312
    ds_read_b64_tr_b16 v[38:39], v10 offset:13312
    s_mul_i32 s51, s47, 1040
    s_waitcnt vmcnt(7) lgkmcnt(8)
    v_mfma_f32_32x32x16_bf16 v[64:79], v[48:51], v[172:175], v[64:79]
    ds_read_b64_tr_b16 v[40:41], v7 offset:14336
    ds_read_b64_tr_b16 v[42:43], v8 offset:14336
    buffer_load_dwordx4 v[204:207], v4, s[28:31], s82 offen offset:3072 sc1
    v_bitop3_b32 v60, v60, v172, s75 bitop3:0xf6
    v_mfma_f32_32x32x16_bf16 v[80:95], v[172:175], v[52:55], v[80:95]
    ds_read_b64_tr_b16 v[44:45], v9 offset:14336
    ds_read_b64_tr_b16 v[46:47], v10 offset:14336
    s_lshl_b32 s47, s47, 10
    s_waitcnt vmcnt(7) lgkmcnt(8)
    v_mfma_f32_32x32x16_bf16 v[64:79], v[24:27], v[176:179], v[64:79]
    ds_read_b64_tr_b16 v[48:49], v7 offset:15360
    ds_read_b64_tr_b16 v[50:51], v8 offset:15360
    buffer_load_dwordx4 v[208:211], v4, s[28:31], s83 offen offset:0 sc1
    v_bitop3_b32 v60, v60, v176, s75 bitop3:0xf6
    v_mfma_f32_32x32x16_bf16 v[80:95], v[176:179], v[28:31], v[80:95]
    ds_read_b64_tr_b16 v[52:53], v9 offset:15360
    ds_read_b64_tr_b16 v[54:55], v10 offset:15360
    s_add_u32 s76, s59, s47
    s_waitcnt vmcnt(7) lgkmcnt(8)
    v_mfma_f32_32x32x16_bf16 v[64:79], v[32:35], v[180:183], v[64:79]
    ds_read_b64_tr_b16 v[24:25], v7 offset:16384
    ds_read_b64_tr_b16 v[26:27], v8 offset:16384
    buffer_load_dwordx4 v[212:215], v4, s[28:31], s83 offen offset:1024 sc1
    v_bitop3_b32 v60, v60, v180, s75 bitop3:0xf6
    v_mfma_f32_32x32x16_bf16 v[80:95], v[180:183], v[36:39], v[80:95]
    ds_read_b64_tr_b16 v[28:29], v9 offset:16384
    ds_read_b64_tr_b16 v[30:31], v10 offset:16384
    s_mul_i32 s47, s3, 15360
    s_waitcnt vmcnt(7) lgkmcnt(8)
    v_mfma_f32_32x32x16_bf16 v[64:79], v[40:43], v[184:187], v[64:79]
    ds_read_b64_tr_b16 v[32:33], v7 offset:17408
    ds_read_b64_tr_b16 v[34:35], v8 offset:17408
    buffer_load_dwordx4 v[216:219], v4, s[28:31], s83 offen offset:2048 sc1
    v_bitop3_b32 v60, v60, v184, s75 bitop3:0xf6
    v_mfma_f32_32x32x16_bf16 v[80:95], v[184:187], v[44:47], v[80:95]
    ds_read_b64_tr_b16 v[36:37], v9 offset:17408
    ds_read_b64_tr_b16 v[38:39], v10 offset:17408
    s_sub_u32 s76, s76, s47
    s_waitcnt vmcnt(7) lgkmcnt(8)
    v_mfma_f32_32x32x16_bf16 v[64:79], v[48:51], v[188:191], v[64:79]
    ds_read_b64_tr_b16 v[40:41], v7 offset:18432
    ds_read_b64_tr_b16 v[42:43], v8 offset:18432
    buffer_load_dwordx4 v[220:223], v4, s[28:31], s83 offen offset:3072 sc1
    v_bitop3_b32 v60, v60, v188, s75 bitop3:0xf6
    v_mfma_f32_32x32x16_bf16 v[80:95], v[188:191], v[52:55], v[80:95]
    ds_read_b64_tr_b16 v[44:45], v9 offset:18432
    ds_read_b64_tr_b16 v[46:47], v10 offset:18432
    s_sub_u32 s76, s76, 16384
    s_waitcnt vmcnt(7) lgkmcnt(8)
    v_mfma_f32_32x32x16_bf16 v[64:79], v[24:27], v[192:195], v[64:79]
    ds_read_b64_tr_b16 v[48:49], v7 offset:19456
    ds_read_b64_tr_b16 v[50:51], v8 offset:19456
    buffer_load_dwordx4 v[224:227], v4, s[28:31], s64 offen offset:0 sc1
    v_bitop3_b32 v60, v60, v192, s75 bitop3:0xf6
    v_mfma_f32_32x32x16_bf16 v[80:95], v[192:195], v[28:31], v[80:95]
    ds_read_b64_tr_b16 v[52:53], v9 offset:19456
    ds_read_b64_tr_b16 v[54:55], v10 offset:19456
    s_lshl_b32 s47, s3, 10
    s_waitcnt vmcnt(7) lgkmcnt(8)
    v_mfma_f32_32x32x16_bf16 v[64:79], v[32:35], v[196:199], v[64:79]
    ds_read_b64_tr_b16 v[24:25], v7 offset:20480
    ds_read_b64_tr_b16 v[26:27], v8 offset:20480
    buffer_load_dwordx4 v[228:231], v4, s[28:31], s64 offen offset:1024 sc1
    v_bitop3_b32 v60, v60, v196, s75 bitop3:0xf6
    v_mfma_f32_32x32x16_bf16 v[80:95], v[196:199], v[36:39], v[80:95]
    ds_read_b64_tr_b16 v[28:29], v9 offset:20480
    ds_read_b64_tr_b16 v[30:31], v10 offset:20480
    buffer_load_dwordx4 v[112:115], v4, s[36:39], s60 offen sc1
    s_add_u32 s51, s51, s47
    s_waitcnt vmcnt(8) lgkmcnt(8)
    v_mfma_f32_32x32x16_bf16 v[64:79], v[40:43], v[200:203], v[64:79]
    ds_read_b64_tr_b16 v[32:33], v7 offset:21504
    ds_read_b64_tr_b16 v[34:35], v8 offset:21504
    buffer_load_dwordx4 v[232:235], v4, s[28:31], s64 offen offset:2048 sc1
    v_bitop3_b32 v60, v60, v200, s75 bitop3:0xf6
    v_mfma_f32_32x32x16_bf16 v[80:95], v[200:203], v[44:47], v[80:95]
    ds_read_b64_tr_b16 v[36:37], v9 offset:21504
    ds_read_b64_tr_b16 v[38:39], v10 offset:21504
    s_add_u32 s77, s51, 28896
    s_waitcnt vmcnt(8) lgkmcnt(8)
    v_mfma_f32_32x32x16_bf16 v[64:79], v[48:51], v[204:207], v[64:79]
    ds_read_b64_tr_b16 v[40:41], v7 offset:22528
    ds_read_b64_tr_b16 v[42:43], v8 offset:22528
    buffer_load_dwordx4 v[236:239], v4, s[28:31], s64 offen offset:3072 sc1
    v_bitop3_b32 v60, v60, v204, s75 bitop3:0xf6
    v_mfma_f32_32x32x16_bf16 v[80:95], v[204:207], v[52:55], v[80:95]
    ds_read_b64_tr_b16 v[44:45], v9 offset:22528
    ds_read_b64_tr_b16 v[46:47], v10 offset:22528
    s_cmp_eq_u32 s4, 0
    s_waitcnt vmcnt(8) lgkmcnt(8)
    v_mfma_f32_32x32x16_bf16 v[64:79], v[24:27], v[208:211], v[64:79]
    ds_read_b64_tr_b16 v[48:49], v7 offset:23552
    ds_read_b64_tr_b16 v[50:51], v8 offset:23552
    buffer_load_dwordx4 v[240:243], v4, s[28:31], s65 offen offset:0 sc1
    v_bitop3_b32 v60, v60, v208, s75 bitop3:0xf6
    v_mfma_f32_32x32x16_bf16 v[80:95], v[208:211], v[28:31], v[80:95]
    ds_read_b64_tr_b16 v[52:53], v9 offset:23552
    ds_read_b64_tr_b16 v[54:55], v10 offset:23552
    s_cselect_b32 s76, 0x7f000000, s76
    s_waitcnt vmcnt(8) lgkmcnt(8)
    v_mfma_f32_32x32x16_bf16 v[64:79], v[32:35], v[212:215], v[64:79]
    ds_read_b64_tr_b16 v[24:25], v7 offset:24576
    ds_read_b64_tr_b16 v[26:27], v8 offset:24576
    buffer_load_dwordx4 v[244:247], v4, s[28:31], s65 offen offset:1024 sc1
    v_bitop3_b32 v60, v60, v212, s75 bitop3:0xf6
    v_mfma_f32_32x32x16_bf16 v[80:95], v[212:215], v[36:39], v[80:95]
    ds_read_b64_tr_b16 v[28:29], v9 offset:24576
    ds_read_b64_tr_b16 v[30:31], v10 offset:24576
    s_cselect_b32 s27, 0, s93
    s_waitcnt vmcnt(8) lgkmcnt(8)
    v_mfma_f32_32x32x16_bf16 v[64:79], v[40:43], v[216:219], v[64:79]
    ds_read_b64_tr_b16 v[32:33], v7 offset:25600
    ds_read_b64_tr_b16 v[34:35], v8 offset:25600
    buffer_load_dwordx4 v[248:251], v4, s[28:31], s65 offen offset:2048 sc1
    v_bitop3_b32 v60, v60, v216, s75 bitop3:0xf6
    v_mfma_f32_32x32x16_bf16 v[80:95], v[216:219], v[44:47], v[80:95]
    ds_read_b64_tr_b16 v[36:37], v9 offset:25600
    ds_read_b64_tr_b16 v[38:39], v10 offset:25600
    s_waitcnt vmcnt(8) lgkmcnt(8)
    v_mfma_f32_32x32x16_bf16 v[64:79], v[48:51], v[220:223], v[64:79]
    ds_read_b64_tr_b16 v[40:41], v7 offset:26624
    ds_read_b64_tr_b16 v[42:43], v8 offset:26624
    buffer_load_dwordx4 v[252:255], v4, s[28:31], s65 offen offset:3072 sc1
    v_bitop3_b32 v60, v60, v220, s75 bitop3:0xf6
    v_mfma_f32_32x32x16_bf16 v[80:95], v[220:223], v[52:55], v[80:95]
    ds_read_b64_tr_b16 v[44:45], v9 offset:26624
    ds_read_b64_tr_b16 v[46:47], v10 offset:26624
    s_waitcnt vmcnt(8) lgkmcnt(8)
    v_mfma_f32_32x32x16_bf16 v[64:79], v[24:27], v[224:227], v[64:79]
    ds_read_b64_tr_b16 v[48:49], v7 offset:27648
    ds_read_b64_tr_b16 v[50:51], v8 offset:27648
    v_bitop3_b32 v60, v60, v224, s75 bitop3:0xf6
    v_mfma_f32_32x32x16_bf16 v[80:95], v[224:227], v[28:31], v[80:95]
    ds_read_b64_tr_b16 v[52:53], v9 offset:27648
    ds_read_b64_tr_b16 v[54:55], v10 offset:27648
    s_waitcnt vmcnt(6)
    v_lshlrev_b32 v61, 16, v112
    v_bitop3_b32 v60, v60, v61, s75 bitop3:0xf6
    v_lshlrev_b32 v61, 16, v114
    v_bitop3_b32 v60, v60, v61, s75 bitop3:0xf6
    s_waitcnt lgkmcnt(8)
    v_mfma_f32_32x32x16_bf16 v[64:79], v[32:35], v[228:231], v[64:79]
    ds_read_b64_tr_b16 v[24:25], v7 offset:28672
    ds_read_b64_tr_b16 v[26:27], v8 offset:28672
    v_add_f32 v112, v112, v114
    v_add_f32 v113, v113, v115
    v_mov_b32 v114, v112
    v_bitop3_b32 v60, v60, v228, s75 bitop3:0xf6
    v_mfma_f32_32x32x16_bf16 v[80:95], v[228:231], v[36:39], v[80:95]
    ds_read_b64_tr_b16 v[28:29], v9 offset:28672
    ds_read_b64_tr_b16 v[30:31], v10 offset:28672
    v_mov_b32 v115, v113
    v_mov_b32 v18, 0
    v_mov_b32 v19, 0
    s_waitcnt vmcnt(5) lgkmcnt(8)
    v_mfma_f32_32x32x16_bf16 v[64:79], v[40:43], v[232:235], v[64:79]
    ds_read_b64_tr_b16 v[32:33], v7 offset:29696
    ds_read_b64_tr_b16 v[34:35], v8 offset:29696
    v_permlane32_swap_b32 v112, v114
    v_permlane32_swap_b32 v113, v115
    s_lshl_b32 s46, s3, 7
    v_bitop3_b32 v60, v60, v232, s75 bitop3:0xf6
    v_mfma_f32_32x32x16_bf16 v[80:95], v[232:235], v[44:47], v[80:95]
    ds_read_b64_tr_b16 v[36:37], v9 offset:29696
    ds_read_b64_tr_b16 v[38:39], v10 offset:29696
    v_lshlrev_b32 v14, 2, v2
    v_add_f32 v112, v112, v114
    v_add_f32 v113, v113, v115
    s_waitcnt vmcnt(4) lgkmcnt(8)
    v_mfma_f32_32x32x16_bf16 v[64:79], v[48:51], v[236:239], v[64:79]
    ds_read_b64_tr_b16 v[40:41], v7 offset:30720
    ds_read_b64_tr_b16 v[42:43], v8 offset:30720
    v_mul_f32 v112, 0x3b000000, v112
    v_mul_f32 v113, 0x3b000000, v113
    v_fma_f32 v113, -v112, v112, v113
    v_bitop3_b32 v60, v60, v236, s75 bitop3:0xf6
    v_mfma_f32_32x32x16_bf16 v[80:95], v[236:239], v[52:55], v[80:95]
    ds_read_b64_tr_b16 v[44:45], v9 offset:30720
    ds_read_b64_tr_b16 v[46:47], v10 offset:30720
    v_max_f32 v113, 0, v113
    v_cvt_pk_bf16_f32 v114, v112, v113
    v_and_b32 v115, 0xffff0000, v114
    s_waitcnt vmcnt(3) lgkmcnt(8)
    v_mfma_f32_32x32x16_bf16 v[64:79], v[24:27], v[240:243], v[64:79]
    ds_read_b64_tr_b16 v[48:49], v7 offset:31744
    ds_read_b64_tr_b16 v[50:51], v8 offset:31744
    v_add_f32 v115, 0x3727c5ac, v115
    v_cvt_pk_bf16_f32 v115, v115, v115
    v_and_b32 v115, 0xffff0000, v115
    v_bitop3_b32 v60, v60, v240, s75 bitop3:0xf6
    v_mfma_f32_32x32x16_bf16 v[80:95], v[240:243], v[28:31], v[80:95]
    ds_read_b64_tr_b16 v[52:53], v9 offset:31744
    ds_read_b64_tr_b16 v[54:55], v10 offset:31744
    v_sqrt_f32 v115, v115
    v_and_b32 v114, 0xffff, v114
    v_xor_b32 v114, 0x8000, v114
    s_waitcnt vmcnt(2) lgkmcnt(8)
    v_mfma_f32_32x32x16_bf16 v[64:79], v[32:35], v[244:247], v[64:79]
    ds_read_b64 v[24:25], v15 offset:256
    ds_read_b64 v[28:29], v15 offset:512
    v_cvt_pk_bf16_f32 v115, v115, v115
    v_and_b32 v115, 0xffff0000, v115
    v_rcp_f32 v12, v115
    v_bitop3_b32 v60, v60, v244, s75 bitop3:0xf6
    v_mfma_f32_32x32x16_bf16 v[80:95], v[244:247], v[36:39], v[80:95]
    v_cndmask_b32_e64 v17, 0, v114, s[66:67]
    v_lshl_or_b32 v16, v17, 16, v17
    v_add_u32 v14, s46, v14
    s_waitcnt vmcnt(1) lgkmcnt(6)
    v_mfma_f32_32x32x16_bf16 v[64:79], v[40:43], v[248:251], v[64:79]
    ds_read_b64 v[32:33], v15 offset:0
    ds_read_b64_tr_b16 v[36:37], v5 offset:31744
    v_mul_f32 v13, 0x3eb8aa3b, v12
    v_lshlrev_b32 v21, 4, v3
    v_add_u32 v21, s46, v21
    ds_write_b32 v14, v12 offset:59392
    ds_read_b128 v[112:115], v21 offset:59392
    ds_read_b128 v[116:119], v21 offset:59424
    ds_read_b128 v[120:123], v21 offset:59456
    ds_read_b128 v[124:127], v21 offset:59488
    v_bitop3_b32 v60, v60, v248, s75 bitop3:0xf6
    v_mfma_f32_32x32x16_bf16 v[80:95], v[248:251], v[44:47], v[80:95]
    ds_read_b64_tr_b16 v[38:39], v6 offset:31744
    s_waitcnt vmcnt(0) lgkmcnt(10)
    v_mfma_f32_32x32x16_bf16 v[64:79], v[48:51], v[252:255], v[64:79]
    ds_read_b64_tr_b16 v[40:41], v5 offset:30720
    ds_read_b64_tr_b16 v[42:43], v6 offset:30720
    v_bitop3_b32 v60, v60, v252, s75 bitop3:0xf6
    v_mfma_f32_32x32x16_bf16 v[80:95], v[252:255], v[52:55], v[80:95]
    ds_read_b64_tr_b16 v[44:45], v5 offset:29696
    ds_read_b64_tr_b16 v[46:47], v6 offset:29696
    v_and_b32 v61, 0x10000, v60
    v_cmp_ne_u32 vcc, 0, v61
    s_and_b64 vcc, vcc, s[44:45]
    s_cbranch_vccnz L_g_redo_58
L_g_join_57:
    s_waitcnt lgkmcnt(12)
    v_mfma_f32_32x32x16_bf16 v[64:79], v[24:27], v[16:19], v[64:79]
    v_mfma_f32_32x32x16_bf16 v[80:95], v[16:19], v[28:31], v[80:95]
    ds_read_b64_tr_b16 v[24:25], v5 offset:28672
    ds_read_b64_tr_b16 v[26:27], v6 offset:28672
    s_nop 3
    s_waitcnt lgkmcnt(13)
    v_mfma_f32_32x32x16_bf16 v[96:111], v[32:35], v[16:19], 0
    ds_read_b64_tr_b16 v[28:29], v5 offset:27648
    ds_read_b64_tr_b16 v[30:31], v6 offset:27648
    s_mov_b32 s81, s77
    v_mul_f32 v64, v12, v64
    v_mul_f32 v65, v12, v65
    v_mul_f32 v66, v12, v66
    v_mul_f32 v67, v12, v67
    v_mul_f32 v68, v12, v68
    v_mul_f32 v69, v12, v69
    v_mul_f32 v70, v12, v70
    s_waitcnt lgkmcnt(8)
    v_mfma_f32_32x32x16_bf16 v[96:111], v[36:39], v[252:255], v[96:111]
    ds_read_b64_tr_b16 v[32:33], v5 offset:26624
    ds_read_b64_tr_b16 v[34:35], v6 offset:26624
    v_mul_f32 v71, v12, v71
    v_add_u32 v65, 0x10000, v65
    v_and_b32 v65, 0xfffe0000, v65
    v_cvt_pk_bf16_f32 v64, v64, v65
    v_cvt_pk_bf16_f32 v65, v66, v67
    v_cvt_pk_bf16_f32 v66, v68, v69
    v_cvt_pk_bf16_f32 v67, v70, v71
    s_waitcnt lgkmcnt(6)
    v_mfma_f32_32x32x16_bf16 v[96:111], v[40:43], v[248:251], v[96:111]
    ds_read_b64_tr_b16 v[36:37], v5 offset:25600
    ds_read_b64_tr_b16 v[38:39], v6 offset:25600
    v_and_b32 v64, 0xfffeffff, v64
    v_mul_f32 v72, v12, v72
    v_mul_f32 v73, v12, v73
    v_mul_f32 v74, v12, v74
    v_mul_f32 v75, v12, v75
    v_mul_f32 v76, v12, v76
    v_mul_f32 v77, v12, v77
    v_mul_f32 v78, v12, v78
    v_mfma_f32_32x32x16_bf16 v[96:111], v[44:47], v[244:247], v[96:111]
    ds_read_b64_tr_b16 v[40:41], v5 offset:24576
    ds_read_b64_tr_b16 v[42:43], v6 offset:24576
    v_mul_f32 v79, v12, v79
    v_add_u32 v73, 0x10000, v73
    v_and_b32 v73, 0xfffe0000, v73
    v_cvt_pk_bf16_f32 v68, v72, v73
    v_cvt_pk_bf16_f32 v69, v74, v75
    v_cvt_pk_bf16_f32 v70, v76, v77
    v_cvt_pk_bf16_f32 v71, v78, v79
    s_waitcnt lgkmcnt(6)
    v_mfma_f32_32x32x16_bf16 v[96:111], v[24:27], v[240:243], v[96:111]
    ds_read_b64_tr_b16 v[44:45], v5 offset:23552
    ds_read_b64_tr_b16 v[46:47], v6 offset:23552
    v_and_b32 v68, 0xfffeffff, v68
    s_cmp_lg_u32 s3, 3
    s_cbranch_scc1 L_kvsk_66
    buffer_store_dwordx4 v[64:67], v4, s[36:39], s59 offen offset:0 sc1
    buffer_store_dwordx4 v[68:71], v4, s[36:39], s59 offen offset:1024 sc1
L_kvsk_66:
    s_waitcnt lgkmcnt(15)
    v_mul_f32 v88, v120, v88
    v_mul_f32 v89, v121, v89
    v_mul_f32 v90, v122, v90
    v_mfma_f32_32x32x16_bf16 v[96:111], v[28:31], v[236:239], v[96:111]
    ds_read_b64_tr_b16 v[24:25], v5 offset:22528
    ds_read_b64_tr_b16 v[26:27], v6 offset:22528
    v_mul_f32 v91, v123, v91
    v_mul_f32 v92, v124, v92
    v_mul_f32 v93, v125, v93
    v_mul_f32 v94, v126, v94
    v_mul_f32 v95, v127, v95
    v_add_u32 v89, 0x10000, v89
    v_and_b32 v89, 0xfffe0000, v89
    s_waitcnt lgkmcnt(6)
    v_mfma_f32_32x32x16_bf16 v[96:111], v[32:35], v[232:235], v[96:111]
    ds_read_b64_tr_b16 v[28:29], v5 offset:21504
    ds_read_b64_tr_b16 v[30:31], v6 offset:21504
    v_cvt_pk_bf16_f32 v88, v88, v89
    v_cvt_pk_bf16_f32 v89, v90, v91
    v_cvt_pk_bf16_f32 v90, v92, v93
    v_cvt_pk_bf16_f32 v91, v94, v95
    v_and_b32 v88, 0xfffeffff, v88
    s_cmp_lg_u32 s3, 3
    s_cbranch_scc1 L_kvsk_67
    buffer_store_dwordx4 v[88:91], v4, s[36:39], s59 offen offset:3072 sc1
L_kvsk_67:
    v_mul_f32 v80, v112, v80
    v_mfma_f32_32x32x16_bf16 v[96:111], v[36:39], v[228:231], v[96:111]
    ds_read_b64_tr_b16 v[32:33], v5 offset:20480
    ds_read_b64_tr_b16 v[34:35], v6 offset:20480
    v_mul_f32 v81, v113, v81
    v_mul_f32 v82, v114, v82
    s_waitcnt lgkmcnt(6)
    v_mfma_f32_32x32x16_bf16 v[96:111], v[40:43], v[224:227], v[96:111]
    ds_read_b64_tr_b16 v[36:37], v5 offset:19456
    ds_read_b64_tr_b16 v[38:39], v6 offset:19456
    v_mul_f32 v83, v115, v83
    v_mul_f32 v84, v116, v84
    v_mul_f32 v85, v117, v85
    v_mfma_f32_32x32x16_bf16 v[96:111], v[44:47], v[220:223], v[96:111]
    ds_read_b64_tr_b16 v[40:41], v5 offset:18432
    ds_read_b64_tr_b16 v[42:43], v6 offset:18432
L_wb_68:
    s_add_u32 s51, s42, 524288
    buffer_load_dwordx4 a[64:67], v4, s[36:39], s51 offen offset:0
    v_mul_f32 v86, v118, v86
    s_waitcnt lgkmcnt(6)
    v_mfma_f32_32x32x16_bf16 v[96:111], v[24:27], v[216:219], v[96:111]
    ds_read_b64_tr_b16 v[44:45], v5 offset:17408
    ds_read_b64_tr_b16 v[46:47], v6 offset:17408
L_wb_70:
    buffer_load_dwordx4 a[68:71], v4, s[36:39], s51 offen offset:1024
    v_mul_f32 v87, v119, v87
    v_cvt_pk_bf16_f32 v80, v80, v81
    v_mfma_f32_32x32x16_bf16 v[96:111], v[28:31], v[212:215], v[96:111]
    ds_read_b64_tr_b16 v[24:25], v5 offset:16384
    ds_read_b64_tr_b16 v[26:27], v6 offset:16384
L_wb_72:
    buffer_load_dwordx4 a[72:75], v4, s[36:39], s51 offen offset:2048
    v_cvt_pk_bf16_f32 v81, v82, v83
    s_waitcnt lgkmcnt(6)
    v_mfma_f32_32x32x16_bf16 v[96:111], v[32:35], v[208:211], v[96:111]
    ds_read_b64_tr_b16 v[28:29], v5 offset:15360
    ds_read_b64_tr_b16 v[30:31], v6 offset:15360
L_wb_74:
    buffer_load_dwordx4 a[76:79], v4, s[36:39], s51 offen offset:3072
    v_cvt_pk_bf16_f32 v82, v84, v85
    v_cvt_pk_bf16_f32 v83, v86, v87
    v_mfma_f32_32x32x16_bf16 v[96:111], v[36:39], v[204:207], v[96:111]
    ds_read_b64_tr_b16 v[32:33], v5 offset:14336
    ds_read_b64_tr_b16 v[34:35], v6 offset:14336
L_wb_76:
    s_add_u32 s51, s42, 528384
    buffer_load_dwordx4 a[80:83], v4, s[36:39], s51 offen offset:0
    s_mul_i32 s46, s3, 4128
    s_waitcnt lgkmcnt(6)
    v_mfma_f32_32x32x16_bf16 v[96:111], v[40:43], v[200:203], v[96:111]
    ds_read_b64_tr_b16 v[36:37], v5 offset:13312
    ds_read_b64_tr_b16 v[38:39], v6 offset:13312
L_wb_78:
    buffer_load_dwordx4 a[84:87], v4, s[36:39], s51 offen offset:1024
    v_add_u32 v248, s46, v4
    ds_write_b128 v248, v[64:67] offset:33024
    v_mfma_f32_32x32x16_bf16 v[96:111], v[44:47], v[196:199], v[96:111]
    ds_read_b64_tr_b16 v[40:41], v5 offset:12288
    ds_read_b64_tr_b16 v[42:43], v6 offset:12288
L_wb_80:
    buffer_load_dwordx4 a[88:91], v4, s[36:39], s51 offen offset:2048
    ds_write_b128 v248, v[68:71] offset:34048
    s_waitcnt lgkmcnt(8)
    v_mfma_f32_32x32x16_bf16 v[96:111], v[24:27], v[192:195], v[96:111]
    ds_read_b64_tr_b16 v[44:45], v5 offset:11264
    ds_read_b64_tr_b16 v[46:47], v6 offset:11264
L_wb_82:
    buffer_load_dwordx4 a[92:95], v4, s[36:39], s51 offen offset:3072
    ds_write_b128 v248, v[80:83] offset:35072
    v_mfma_f32_32x32x16_bf16 v[96:111], v[28:31], v[188:191], v[96:111]
    ds_read_b64_tr_b16 v[24:25], v5 offset:10240
    ds_read_b64_tr_b16 v[26:27], v6 offset:10240
L_wb_84:
    s_add_u32 s51, s43, 524288
    buffer_load_dwordx4 a[96:99], v4, s[36:39], s51 offen offset:0
    ds_write_b128 v248, v[88:91] offset:36112
    s_waitcnt lgkmcnt(10)
    v_mfma_f32_32x32x16_bf16 v[96:111], v[32:35], v[184:187], v[96:111]
    ds_read_b64_tr_b16 v[28:29], v5 offset:9216
    ds_read_b64_tr_b16 v[30:31], v6 offset:9216
L_wb_86:
    buffer_load_dwordx4 a[100:103], v4, s[36:39], s51 offen offset:1024
    s_add_u32 s46, s46, 1024
    v_mov_b32 v14, s46
    v_mfma_f32_32x32x16_bf16 v[96:111], v[36:39], v[180:183], v[96:111]
    ds_read_b64_tr_b16 v[32:33], v5 offset:8192
    ds_read_b64_tr_b16 v[34:35], v6 offset:8192
L_wb_88:
    buffer_load_dwordx4 a[104:107], v4, s[36:39], s51 offen offset:2048
    v_add_u32 v251, 0x400, v248
    s_waitcnt lgkmcnt(8)
    v_mfma_f32_32x32x16_bf16 v[96:111], v[40:43], v[176:179], v[96:111]
    ds_read_b64_tr_b16 v[36:37], v5 offset:7168
    ds_read_b64_tr_b16 v[38:39], v6 offset:7168
L_wb_90:
    buffer_load_dwordx4 a[108:111], v4, s[36:39], s51 offen offset:3072
    v_add_u32 v250, 0x100, v248
    v_cndmask_b32_e64 v249, v14, v248, s[72:73]
    v_mfma_f32_32x32x16_bf16 v[96:111], v[44:47], v[172:175], v[96:111]
    ds_read_b64_tr_b16 v[40:41], v5 offset:6144
    ds_read_b64_tr_b16 v[42:43], v6 offset:6144
L_wb_92:
    s_add_u32 s51, s43, 528384
    buffer_load_dwordx4 a[112:115], v4, s[36:39], s51 offen offset:0
    v_cndmask_b32_e64 v250, v14, v250, s[72:73]
    s_waitcnt lgkmcnt(6)
    v_mfma_f32_32x32x16_bf16 v[96:111], v[24:27], v[168:171], v[96:111]
    ds_read_b64_tr_b16 v[44:45], v5 offset:5120
    ds_read_b64_tr_b16 v[46:47], v6 offset:5120
L_wb_94:
    buffer_load_dwordx4 a[116:119], v4, s[36:39], s51 offen offset:1024
    v_lshlrev_b32 v14, 2, v3
    v_sub_u32 v14, v14, v2
    v_mfma_f32_32x32x16_bf16 v[96:111], v[28:31], v[164:167], v[96:111]
    ds_read_b64_tr_b16 v[24:25], v5 offset:4096
    ds_read_b64_tr_b16 v[26:27], v6 offset:4096
L_wb_96:
    buffer_load_dwordx4 a[120:123], v4, s[36:39], s51 offen offset:2048
    v_lshlrev_b32 v14, 2, v14
    s_waitcnt lgkmcnt(6)
    v_mfma_f32_32x32x16_bf16 v[96:111], v[32:35], v[160:163], v[96:111]
    ds_read_b64_tr_b16 v[28:29], v5 offset:3072
    ds_read_b64_tr_b16 v[30:31], v6 offset:3072
L_wb_98:
    buffer_load_dwordx4 a[124:127], v4, s[36:39], s51 offen offset:3072
    v_add_u32 v14, 60544, v14
    ds_read2_b32 v[232:233], v14 offset0:0 offset1:1
    v_mfma_f32_32x32x16_bf16 v[96:111], v[36:39], v[156:159], v[96:111]
    ds_read_b64_tr_b16 v[32:33], v5 offset:2048
    ds_read_b64_tr_b16 v[34:35], v6 offset:2048
    ds_read2_b32 v[234:235], v14 offset0:2 offset1:3
    ds_read2_b32 v[236:237], v14 offset0:8 offset1:9
    s_waitcnt lgkmcnt(9)
    v_mfma_f32_32x32x16_bf16 v[96:111], v[40:43], v[152:155], v[96:111]
    ds_read_b64_tr_b16 v[36:37], v5 offset:1024
    ds_read_b64_tr_b16 v[38:39], v6 offset:1024
    s_cmp_eq_u32 s3, 3
    s_cbranch_scc1 L_nbb_100
    s_add_u32 m0, s81, 0
    s_nop 0
    buffer_load_dwordx4 v4, s[36:39], s76 offen offset:0 sc1 lds
L_nbb_100:
    ds_read2_b32 v[238:239], v14 offset0:10 offset1:11
    v_mfma_f32_32x32x16_bf16 v[96:111], v[44:47], v[148:151], v[96:111]
    ds_read_b64_tr_b16 v[40:41], v5 offset:0
    ds_read_b64_tr_b16 v[42:43], v6 offset:0
    ds_read2_b32 v[240:241], v14 offset0:16 offset1:17
    ds_read2_b32 v[242:243], v14 offset0:18 offset1:19
    s_waitcnt lgkmcnt(12)
    v_mfma_f32_32x32x16_bf16 v[96:111], v[24:27], v[144:147], v[96:111]
    ds_read2_b32 v[244:245], v14 offset0:24 offset1:25
    ds_read2_b32 v[246:247], v14 offset0:26 offset1:27
    ds_read2_b32 v[56:57], v14 offset0:80 offset1:81
    ds_read2_b32 v[58:59], v14 offset0:82 offset1:83
    ds_read2_b32 v[60:61], v14 offset0:88 offset1:89
    ds_read_b128 v[160:163], v248 offset:33024
    ds_read_b128 v[164:167], v249 offset:35072
    v_mfma_f32_32x32x16_bf16 v[96:111], v[28:31], v[140:143], v[96:111]
    ds_read2_b32 v[62:63], v14 offset0:90 offset1:91
    ds_read_b128 v[168:171], v249 offset:36112
    ds_read_b128 v[172:175], v251 offset:33024
    s_waitcnt lgkmcnt(15)
    v_mfma_f32_32x32x16_bf16 v[96:111], v[32:35], v[136:139], v[96:111]
    ds_read_b128 v[176:179], v250 offset:35072
    ds_read_b128 v[180:183], v250 offset:36112
    v_mfma_f32_32x32x16_bf16 v[96:111], v[36:39], v[132:135], v[96:111]
    s_waitcnt lgkmcnt(14)
    v_mfma_f32_32x32x16_bf16 v[96:111], v[40:43], v[128:131], v[96:111]
    s_nop 7
    s_nop 3
    v_mul_f32 v96, v13, v96
    v_mul_f32 v97, v13, v97
    v_mul_f32 v98, v13, v98
    v_mul_f32 v99, v13, v99
    v_mul_f32 v100, v13, v100
    v_mul_f32 v101, v13, v101
    v_mul_f32 v102, v13, v102
    v_mul_f32 v103, v13, v103
    v_cvt_pk_bf16_f32 v16, v96, v97
    v_cvt_pk_bf16_f32 v17, v98, v99
    v_cvt_pk_bf16_f32 v18, v100, v101
    v_cvt_pk_bf16_f32 v19, v102, v103
    s_waitcnt lgkmcnt(0)
    s_nop 0
    v_mfma_f32_32x32x16_bf16 v[128:143], v[160:163], v[16:19], v[232:247]
    v_mul_f32 v104, v13, v104
    v_mul_f32 v105, v13, v105
    v_mul_f32 v106, v13, v106
    v_mul_f32 v107, v13, v107
    v_mul_f32 v108, v13, v108
    v_mul_f32 v109, v13, v109
    v_mul_f32 v110, v13, v110
    v_mul_f32 v111, v13, v111
    v_cvt_pk_bf16_f32 v20, v104, v105
    v_cvt_pk_bf16_f32 v21, v106, v107
    v_cvt_pk_bf16_f32 v22, v108, v109
    v_cvt_pk_bf16_f32 v23, v110, v111
    s_nop 1
    v_mfma_f32_32x32x16_bf16 v[144:159], v[172:175], v[20:23], v[232:247]
    v_exp_f32 v128, v128
    v_exp_f32 v129, v129
    v_exp_f32 v130, v130
    v_exp_f32 v131, v131
    v_exp_f32 v132, v132
    v_exp_f32 v133, v133
    v_exp_f32 v134, v134
    v_exp_f32 v135, v135
    v_exp_f32 v136, v136
    v_exp_f32 v137, v137
    v_exp_f32 v138, v138
    v_exp_f32 v139, v139
    v_exp_f32 v140, v140
    v_exp_f32 v141, v141
    v_exp_f32 v142, v142
    v_exp_f32 v143, v143
    v_cvt_pk_bf16_f32 v128, v128, v129
    v_cvt_pk_bf16_f32 v129, v130, v131
    v_cvt_pk_bf16_f32 v130, v132, v133
    v_cvt_pk_bf16_f32 v131, v134, v135
    v_cvt_pk_bf16_f32 v132, v136, v137
    v_cvt_pk_bf16_f32 v133, v138, v139
    v_cvt_pk_bf16_f32 v134, v140, v141
    v_cvt_pk_bf16_f32 v135, v142, v143
    s_cmp_eq_u32 s3, 3
    s_cbranch_scc1 L_nbw_101
    v_add_u32 v27, s81, v4
    s_waitcnt vmcnt(0)
    ds_read_b32 v40, v27 offset:0
L_nbw_101:
    v_exp_f32 v144, v144
    v_mfma_f32_32x32x16_bf16 v[96:111], v[164:167], v[128:131], 0
    v_exp_f32 v145, v145
    v_exp_f32 v146, v146
    v_exp_f32 v147, v147
    s_cmp_eq_u32 s3, 3
    s_cbranch_scc1 L_nbw_102
    s_waitcnt lgkmcnt(0)
    v_xor_b32 v14, s27, v40
    v_and_b32 v14, 0x10000, v14
    v_cmp_ne_u32 vcc, 0, v14
    s_and_b64 vcc, vcc, s[44:45]
    s_cbranch_vccnz L_slow_103
L_back_104:
L_nbw_102:
    s_barrier
    ds_read_b128 v[184:187], v248 offset:28896
    ds_read_b128 v[192:195], v249 offset:31984
    ds_read_b128 v[196:199], v251 offset:28896
    ds_read_b128 v[204:207], v250 offset:31984
    s_cmp_lg_u32 s3, 3
    s_cbranch_scc1 L_ds_106
    v_mul_u32_u24 v25, 2044, v1
    v_mov_b32 v26, 0
    s_sub_u32 s46, s99, 4088
    s_min_u32 s47, s4, 2
    s_lshr_b32 s47, 12, s47
    s_and_b32 s47, s47, 3
    s_cbranch_scc0 L_ds_106
    s_mov_b32 exec_lo, s47
    s_mov_b32 exec_hi, 0
    buffer_store_dword v26, v25, s[36:39], s46 offen sc1
    s_mov_b64 exec, -1
L_ds_106:
    v_exp_f32 v148, v148
    v_exp_f32 v149, v149
    v_exp_f32 v150, v150
    v_exp_f32 v151, v151
    v_mfma_f32_32x32x16_bf16 v[96:111], v[168:171], v[132:135], v[96:111]
    v_exp_f32 v152, v152
    v_exp_f32 v153, v153
    v_exp_f32 v154, v154
    v_exp_f32 v155, v155
    v_exp_f32 v156, v156
    v_exp_f32 v157, v157
    s_waitcnt lgkmcnt(3)
    v_mfma_f32_32x32x16_bf16 v[64:79], v[184:187], v[16:19], v[48:63]
    v_exp_f32 v158, v158
    v_exp_f32 v159, v159
    v_cvt_pk_bf16_f32 v144, v144, v145
    v_cvt_pk_bf16_f32 v145, v146, v147
    v_cvt_pk_bf16_f32 v146, v148, v149
    v_cvt_pk_bf16_f32 v147, v150, v151
    s_waitcnt lgkmcnt(1)
    v_mfma_f32_32x32x16_bf16 v[80:95], v[196:199], v[20:23], v[48:63]
    v_cvt_pk_bf16_f32 v148, v152, v153
    v_cvt_pk_bf16_f32 v149, v154, v155
    v_cvt_pk_bf16_f32 v150, v156, v157
    v_cvt_pk_bf16_f32 v151, v158, v159
    v_exp_f32 v72, v72
    v_exp_f32 v73, v73
    v_mfma_f32_32x32x16_bf16 v[112:127], v[176:179], v[144:147], 0
    v_exp_f32 v74, v74
    v_exp_f32 v75, v75
    v_exp_f32 v76, v76
    v_exp_f32 v77, v77
    v_exp_f32 v78, v78
    v_exp_f32 v79, v79
    v_mfma_f32_32x32x16_bf16 v[112:127], v[180:183], v[148:151], v[112:127]
    v_cvt_pk_bf16_f32 v68, v72, v73
    v_cvt_pk_bf16_f32 v69, v74, v75
    v_cvt_pk_bf16_f32 v70, v76, v77
    v_cvt_pk_bf16_f32 v71, v78, v79
    v_exp_f32 v88, v88
    v_exp_f32 v89, v89
    v_exp_f32 v90, v90
    v_exp_f32 v91, v91
    v_exp_f32 v92, v92
    v_exp_f32 v93, v93
    v_exp_f32 v94, v94
    v_exp_f32 v95, v95
    v_mfma_f32_32x32x16_bf16 v[96:111], v[192:195], v[68:71], v[96:111]
    v_cvt_pk_bf16_f32 v84, v88, v89
    v_cvt_pk_bf16_f32 v85, v90, v91
    v_cvt_pk_bf16_f32 v86, v92, v93
    v_cvt_pk_bf16_f32 v87, v94, v95
    s_nop 1
    s_waitcnt lgkmcnt(0)
    v_mfma_f32_32x32x16_bf16 v[112:127], v[204:207], v[84:87], v[112:127]
    s_nop 3
    v_rcp_f32 v28, v104
    v_mov_b32 v29, 0x10000
    v_mul_f32 v96, v28, v96
    v_mul_f32 v97, v28, v97
    v_mul_f32 v98, v28, v98
    v_mul_f32 v99, v28, v99
    v_mul_f32 v100, v28, v100
    v_mul_f32 v101, v28, v101
    v_mul_f32 v102, v28, v102
    v_mul_f32 v103, v28, v103
    v_add_u32 v97, s75, v97
    v_and_b32 v97, 0xfffe0000, v97
    v_cvt_pk_bf16_f32 v64, v96, v97
    v_cvt_pk_bf16_f32 v65, v98, v99
    v_cvt_pk_bf16_f32 v66, v100, v101
    v_cvt_pk_bf16_f32 v67, v102, v103
    v_bfi_b32 v64, v29, s74, v64
    v_max_f32 v25, v104, v120
    v_min_f32 v26, v104, v120
    v_add_f32 v27, v104, v120
    v_cmp_nle_f32 vcc, v25, s100
    v_cmp_nge_f32 s[68:69], v26, s101
    s_or_b64 vcc, vcc, s[68:69]
    v_cmp_u_f32 s[68:69], v27, v27
    s_or_b64 vcc, vcc, s[68:69]
    s_cbranch_vccnz L_fb_107
L_fbk_108:
    s_cmp_eq_u32 s7, 0
    s_cbranch_scc1 L_stsl_116
    buffer_store_dwordx4 v[64:67], v4, s[36:39], s58 offen
L_stdn_117:
    v_rcp_f32 v28, v120
    v_mov_b32 v29, 0x10000
    v_mul_f32 v112, v28, v112
    v_mul_f32 v113, v28, v113
    v_mul_f32 v114, v28, v114
    v_mul_f32 v115, v28, v115
    v_mul_f32 v116, v28, v116
    v_mul_f32 v117, v28, v117
    v_mul_f32 v118, v28, v118
    v_mul_f32 v119, v28, v119
    v_add_u32 v113, s75, v113
    v_and_b32 v113, 0xfffe0000, v113
    v_cvt_pk_bf16_f32 v68, v112, v113
    v_cvt_pk_bf16_f32 v69, v114, v115
    v_cvt_pk_bf16_f32 v70, v116, v117
    v_cvt_pk_bf16_f32 v71, v118, v119
    v_bfi_b32 v68, v29, s74, v68
    s_cmp_eq_u32 s7, 0
    s_cbranch_scc1 L_stsl_118
    buffer_store_dwordx4 v[68:71], v4, s[36:39], s58 offen offset:1024
L_stdn_119:
    s_mul_i32 s81, s3, 8256
    s_mov_b32 s76, s63
    s_add_u32 s77, s63, 4096
    s_barrier
    s_lshl_b32 s46, s3, 11
    v_add_u32 v14, s46, v4
    ds_read_b128 v[96:99], v14 offset:49664
    ds_read_b128 v[100:103], v14 offset:50688
    s_mul_i32 s46, s3, 8256
    v_add_u32 v104, s46, v4
    s_add_u32 s46, s3, 1
    s_and_b32 s46, s46, 3
    s_mul_i32 s46, s46, 8256
    v_add_u32 v105, s46, v4
    s_add_u32 s46, s3, 2
    s_and_b32 s46, s46, 3
    s_mul_i32 s46, s46, 8256
    v_add_u32 v106, s46, v4
    s_add_u32 s46, s3, 3
    s_and_b32 s46, s46, 3
    s_mul_i32 s46, s46, 8256
    v_add_u32 v107, s46, v4
    s_waitcnt lgkmcnt(0)
    v_lshlrev_b32 v64, 16, v96
    v_and_b32 v65, 0xffff0000, v96
    v_lshlrev_b32 v66, 16, v97
    v_and_b32 v67, 0xffff0000, v97
    v_lshlrev_b32 v68, 16, v98
    v_and_b32 v69, 0xffff0000, v98
    v_lshlrev_b32 v70, 16, v99
    v_and_b32 v71, 0xffff0000, v99
    v_lshlrev_b32 v72, 16, v100
    v_and_b32 v73, 0xffff0000, v100
    v_lshlrev_b32 v74, 16, v101
    v_and_b32 v75, 0xffff0000, v101
    v_lshlrev_b32 v76, 16, v102
    v_and_b32 v77, 0xffff0000, v102
    v_lshlrev_b32 v78, 16, v103
    v_and_b32 v79, 0xffff0000, v103
L_trr_121:
L_swr_125:
L_sw_124:
    s_lshl_b32 s46, s3, 10
    s_add_u32 s46, s46, 65536
    v_add_u32 v32, s46, v4
    s_add_u32 m0, s81, 0
    v_add_u32 v33, 0x10000, v32
    buffer_load_dwordx4 v4, s[36:39], s76 offen offset:0 sc1 lds
    ds_read_b128 a[128:131], v32 offset:32768
    ds_write_b128 v32, a[160:163] offset:32768
    buffer_load_dwordx4 v4, s[36:39], s76 offen offset:1024 sc1 lds
    ds_read_b128 a[132:135], v32 offset:36864
    ds_write_b128 v32, a[164:167] offset:36864
    buffer_load_dwordx4 v4, s[36:39], s76 offen offset:2048 sc1 lds
    ds_read_b128 a[136:139], v32 offset:40960
    s_add_u32 m0, s81, 16
    ds_write_b128 v32, a[168:171] offset:40960
    buffer_load_dwordx4 v4, s[36:39], s76 offen offset:3072 sc1 lds
    ds_read_b128 a[140:143], v32 offset:45056
    s_add_u32 m0, s81, 4128
    ds_write_b128 v32, a[172:175] offset:45056
    buffer_load_dwordx4 v4, s[36:39], s77 offen offset:0 sc1 lds
    ds_read_b128 a[144:147], v32 offset:49152
    ds_write_b128 v32, a[176:179] offset:49152
    buffer_load_dwordx4 v4, s[36:39], s77 offen offset:1024 sc1 lds
    ds_read_b128 a[148:151], v32 offset:53248
    ds_write_b128 v32, a[180:183] offset:53248
    buffer_load_dwordx4 v4, s[36:39], s77 offen offset:2048 sc1 lds
    s_add_u32 m0, s81, 4144
    s_nop 0
    buffer_load_dwordx4 v4, s[36:39], s77 offen offset:3072 sc1 lds
    s_mov_b32 s52, 0
L_opv_128:
L_ort_131:
    s_waitcnt vmcnt(7)
    ds_read_b128 v[128:131], v104 offset:0
    s_waitcnt vmcnt(6)
    ds_read_b128 v[132:135], v104 offset:1024
    s_waitcnt vmcnt(5)
    ds_read_b128 v[136:139], v104 offset:2048
    s_waitcnt lgkmcnt(2)
    v_mfma_f32_32x32x16_bf16 v[64:79], a[0:3], v[128:131], v[64:79]
    v_xor_b32 v14, s74, v128
    s_waitcnt vmcnt(4)
    ds_read_b128 v[140:143], v104 offset:3088
    s_waitcnt lgkmcnt(2)
    v_mfma_f32_32x32x16_bf16 v[64:79], a[4:7], v[132:135], v[64:79]
    v_bitop3_b32 v14, v14, v132, s74 bitop3:0xf6
    s_waitcnt vmcnt(3)
    ds_read_b128 v[144:147], v104 offset:4128
    s_waitcnt lgkmcnt(2)
    v_mfma_f32_32x32x16_bf16 v[64:79], a[8:11], v[136:139], v[64:79]
    v_bitop3_b32 v14, v14, v136, s74 bitop3:0xf6
    s_waitcnt vmcnt(2)
    ds_read_b128 v[148:151], v104 offset:5152
    s_waitcnt lgkmcnt(2)
    v_mfma_f32_32x32x16_bf16 v[64:79], a[12:15], v[140:143], v[64:79]
    v_bitop3_b32 v14, v14, v140, s74 bitop3:0xf6
    s_waitcnt vmcnt(1)
    ds_read_b128 v[152:155], v104 offset:6176
    s_waitcnt lgkmcnt(2)
    v_mfma_f32_32x32x16_bf16 v[64:79], a[16:19], v[144:147], v[64:79]
    v_bitop3_b32 v14, v14, v144, s74 bitop3:0xf6
    s_waitcnt vmcnt(0)
    ds_read_b128 v[156:159], v104 offset:7216
    s_waitcnt lgkmcnt(2)
    v_bitop3_b32 v14, v14, v148, s74 bitop3:0xf6
    s_waitcnt lgkmcnt(1)
    v_bitop3_b32 v14, v14, v152, s74 bitop3:0xf6
    s_waitcnt lgkmcnt(0)
    v_bitop3_b32 v14, v14, v156, s74 bitop3:0xf6
    v_and_b32 v14, 0x10000, v14
    v_cmp_ne_u32 vcc, 0, v14
    s_and_b64 vcc, vcc, s[44:45]
    s_cbranch_vccnz L_osl_132
    s_barrier
    ds_read_b128 v[160:163], v105 offset:0
    ds_read_b128 v[164:167], v105 offset:1024
    ds_read_b128 v[168:171], v105 offset:2048
    ds_read_b128 v[172:175], v105 offset:3088
    v_mfma_f32_32x32x16_bf16 v[64:79], a[20:23], v[148:151], v[64:79]
    ds_read_b128 v[176:179], v105 offset:4128
    ds_read_b128 v[180:183], v105 offset:5152
    ds_read_b128 a[152:155], v32 offset:57344
    ds_write_b128 v32, a[184:187] offset:57344
    v_mfma_f32_32x32x16_bf16 v[64:79], a[24:27], v[152:155], v[64:79]
    v_and_b32 v14, 1, v1
    v_lshlrev_b32 v14, 2, v14
    buffer_load_dword v110, v14, s[36:39], s99 offen offset:4 sc1
    ds_read_b128 v[184:187], v105 offset:6176
    ds_read_b128 v[188:191], v105 offset:7216
    v_mfma_f32_32x32x16_bf16 v[64:79], a[28:31], v[156:159], v[64:79]
    ds_read_b128 v[192:195], v106 offset:0
    ds_read_b128 v[196:199], v106 offset:1024
    ds_read_b128 a[156:159], v32 offset:61440
    ds_write_b128 v32, a[188:191] offset:61440
    s_add_u32 s78, s88, 0
    s_and_b32 s78, s78, 7
    s_waitcnt lgkmcnt(13)
    v_mfma_f32_32x32x16_bf16 v[64:79], a[32:35], v[160:163], v[64:79]
    ds_read_b128 v[200:203], v106 offset:2048
    ds_read_b128 v[204:207], v106 offset:3088
    s_lshl_b32 s78, s78, 12
    s_add_u32 s78, s78, s57
    s_waitcnt lgkmcnt(14)
    v_mfma_f32_32x32x16_bf16 v[64:79], a[36:39], v[164:167], v[64:79]
    ds_read_b128 v[208:211], v106 offset:4128
    ds_read_b128 v[212:215], v106 offset:5152
    s_add_u32 s79, s88, 1
    s_and_b32 s79, s79, 7
    s_waitcnt lgkmcnt(15)
    v_mfma_f32_32x32x16_bf16 v[64:79], a[40:43], v[168:171], v[64:79]
    ds_read_b128 v[216:219], v106 offset:6176
    ds_read_b128 v[220:223], v106 offset:7216
    ds_read_b128 a[160:163], v33 offset:0
    ds_write_b128 v33, a[192:195] offset:0
    s_lshl_b32 s79, s79, 12
    s_add_u32 s79, s79, s57
    s_waitcnt lgkmcnt(15)
    v_mfma_f32_32x32x16_bf16 v[64:79], a[44:47], v[172:175], v[64:79]
    ds_read_b128 v[224:227], v107 offset:0
    s_add_u32 s80, s88, 2
    s_and_b32 s80, s80, 7
    s_waitcnt lgkmcnt(15)
    v_mfma_f32_32x32x16_bf16 v[64:79], a[48:51], v[176:179], v[64:79]
    ds_read_b128 v[228:231], v107 offset:1024
    s_lshl_b32 s80, s80, 12
    s_add_u32 s80, s80, s57
    s_waitcnt lgkmcnt(15)
    v_mfma_f32_32x32x16_bf16 v[64:79], a[52:55], v[180:183], v[64:79]
    ds_read_b128 v[232:235], v107 offset:2048
    ds_read_b128 a[164:167], v33 offset:4096
    ds_write_b128 v33, a[196:199] offset:4096
    s_add_u32 s81, s88, 3
    s_and_b32 s81, s81, 7
    s_waitcnt lgkmcnt(15)
    v_mfma_f32_32x32x16_bf16 v[64:79], a[56:59], v[184:187], v[64:79]
    ds_read_b128 v[236:239], v107 offset:3088
    s_lshl_b32 s81, s81, 12
    s_add_u32 s81, s81, s57
    s_waitcnt lgkmcnt(15)
    v_mfma_f32_32x32x16_bf16 v[64:79], a[60:63], v[188:191], v[64:79]
    ds_read_b128 v[240:243], v107 offset:4128
    ds_read_b128 a[168:171], v33 offset:8192
    ds_write_b128 v33, a[200:203] offset:8192
    s_add_u32 s82, s88, 4
    s_and_b32 s82, s82, 7
    s_waitcnt lgkmcnt(15)
    v_mfma_f32_32x32x16_bf16 v[64:79], a[64:67], v[192:195], v[64:79]
    ds_read_b128 v[244:247], v107 offset:5152
    s_lshl_b32 s82, s82, 12
    s_add_u32 s82, s82, s57
    s_waitcnt lgkmcnt(15)
    v_mfma_f32_32x32x16_bf16 v[64:79], a[68:71], v[196:199], v[64:79]
    ds_read_b128 v[248:251], v107 offset:6176
    s_add_u32 s83, s88, 5
    s_and_b32 s83, s83, 7
    s_waitcnt lgkmcnt(15)
    v_mfma_f32_32x32x16_bf16 v[64:79], a[72:75], v[200:203], v[64:79]
    ds_read_b128 v[252:255], v107 offset:7216
    ds_read_b128 a[172:175], v33 offset:12288
    ds_write_b128 v33, a[204:207] offset:12288
    s_lshl_b32 s83, s83, 12
    s_add_u32 s83, s83, s57
    s_waitcnt lgkmcnt(15)
    v_mfma_f32_32x32x16_bf16 v[64:79], a[76:79], v[204:207], v[64:79]
    s_add_u32 s64, s88, 6
    s_and_b32 s64, s64, 7
    s_waitcnt lgkmcnt(15)
    v_mfma_f32_32x32x16_bf16 v[64:79], a[80:83], v[208:211], v[64:79]
    s_lshl_b32 s64, s64, 12
    s_add_u32 s64, s64, s57
    s_waitcnt lgkmcnt(15)
    v_mfma_f32_32x32x16_bf16 v[64:79], a[84:87], v[212:215], v[64:79]
    ds_read_b128 a[176:179], v33 offset:16384
    ds_write_b128 v33, a[208:211] offset:16384
    s_add_u32 s65, s88, 7
    s_and_b32 s65, s65, 7
    s_waitcnt lgkmcnt(15)
    v_mfma_f32_32x32x16_bf16 v[64:79], a[88:91], v[216:219], v[64:79]
    s_lshl_b32 s65, s65, 12
    s_add_u32 s65, s65, s57
    s_waitcnt lgkmcnt(15)
    v_mfma_f32_32x32x16_bf16 v[64:79], a[92:95], v[220:223], v[64:79]
    ds_read_b128 a[180:183], v33 offset:20480
    ds_write_b128 v33, a[212:215] offset:20480
    v_lshrrev_b32 v108, 2, v1
    v_lshlrev_b32 v108, 11, v108
    s_waitcnt lgkmcnt(15)
    v_mfma_f32_32x32x16_bf16 v[64:79], a[96:99], v[224:227], v[64:79]
    v_add_u32 v108, 2032, v108
    s_waitcnt lgkmcnt(15)
    v_mfma_f32_32x32x16_bf16 v[64:79], a[100:103], v[228:231], v[64:79]
    s_waitcnt lgkmcnt(15)
    v_mfma_f32_32x32x16_bf16 v[64:79], a[104:107], v[232:235], v[64:79]
    ds_read_b128 a[184:187], v33 offset:24576
    ds_write_b128 v33, a[216:219] offset:24576
    s_waitcnt lgkmcnt(14)
    v_mfma_f32_32x32x16_bf16 v[64:79], a[108:111], v[236:239], v[64:79]
    s_waitcnt lgkmcnt(13)
    v_mfma_f32_32x32x16_bf16 v[64:79], a[112:115], v[240:243], v[64:79]
    s_waitcnt lgkmcnt(10)
    v_mfma_f32_32x32x16_bf16 v[64:79], a[116:119], v[244:247], v[64:79]
    ds_read_b128 a[188:191], v33 offset:28672
    ds_write_b128 v33, a[220:223] offset:28672
    s_waitcnt lgkmcnt(11)
    v_mfma_f32_32x32x16_bf16 v[64:79], a[120:123], v[248:251], v[64:79]
    s_waitcnt lgkmcnt(10)
    v_mfma_f32_32x32x16_bf16 v[64:79], a[124:127], v[252:255], v[64:79]
L_opD_126:
    s_nop 2
    v_mov_b32 v22, 0x10000
    s_nop 7
    v_add_u32 v104, s75, v65
    v_and_b32 v104, 0xfffe0000, v104
    v_add_u32 v105, s75, v73
    v_and_b32 v105, 0xfffe0000, v105
    v_cvt_pk_bf16_f32 v96, v64, v104
    v_cvt_pk_bf16_f32 v97, v66, v67
    v_cvt_pk_bf16_f32 v98, v68, v69
    v_cvt_pk_bf16_f32 v99, v70, v71
    v_cvt_pk_bf16_f32 v100, v72, v105
    v_cvt_pk_bf16_f32 v101, v74, v75
    v_cvt_pk_bf16_f32 v102, v76, v77
    v_cvt_pk_bf16_f32 v103, v78, v79
    v_bfi_b32 v96, v22, s74, v96
    v_bfi_b32 v100, v22, s74, v100
    s_cmp_eq_u32 s7, 0
    s_cbranch_scc1 L_stsl_134
    buffer_store_dwordx4 v[96:99], v4, s[28:31], s61 offen
    buffer_store_dwordx4 v[100:103], v4, s[28:31], s61 offen offset:1024
L_stdn_135:
    v_cvt_pk_bf16_f32 v104, v64, v65
    v_cvt_pk_bf16_f32 v105, v72, v73
    v_lshlrev_b32 v64, 16, v104
    v_and_b32 v65, 0xffff0000, v104
    v_lshlrev_b32 v66, 16, v97
    v_and_b32 v67, 0xffff0000, v97
    v_lshlrev_b32 v68, 16, v98
    v_and_b32 v69, 0xffff0000, v98
    v_lshlrev_b32 v70, 16, v99
    v_and_b32 v71, 0xffff0000, v99
    v_lshlrev_b32 v72, 16, v105
    v_and_b32 v73, 0xffff0000, v105
    v_lshlrev_b32 v74, 16, v101
    v_and_b32 v75, 0xffff0000, v101
    v_lshlrev_b32 v76, 16, v102
    v_and_b32 v77, 0xffff0000, v102
    v_lshlrev_b32 v78, 16, v103
    v_and_b32 v79, 0xffff0000, v103
    v_add_f32 v20, v64, v65
    v_mul_f32 v21, v64, v64
    v_fmac_f32 v21, v65, v65
    v_add_f32 v20, v20, v66
    v_fmac_f32 v21, v66, v66
    v_add_f32 v20, v20, v67
    v_fmac_f32 v21, v67, v67
    v_add_f32 v20, v20, v68
    v_fmac_f32 v21, v68, v68
    v_add_f32 v20, v20, v69
    v_fmac_f32 v21, v69, v69
    v_add_f32 v20, v20, v70
    v_fmac_f32 v21, v70, v70
    v_add_f32 v20, v20, v71
    v_fmac_f32 v21, v71, v71
    v_add_f32 v20, v20, v72
    v_fmac_f32 v21, v72, v72
    v_add_f32 v20, v20, v73
    v_fmac_f32 v21, v73, v73
    v_add_f32 v20, v20, v74
    v_fmac_f32 v21, v74, v74
    v_add_f32 v20, v20, v75
    v_fmac_f32 v21, v75, v75
    v_add_f32 v20, v20, v76
    v_fmac_f32 v21, v76, v76
    v_add_f32 v20, v20, v77
    v_fmac_f32 v21, v77, v77
    v_add_f32 v20, v20, v78
    v_fmac_f32 v21, v78, v78
    v_add_f32 v20, v20, v79
    v_fmac_f32 v21, v79, v79
    v_lshlrev_b32 v14, 3, v1
    s_lshl_b32 s46, s3, 9
    v_add_u32 v15, s46, v14
    ds_write_b64 v15, v[20:21] offset:61440
    s_waitcnt lgkmcnt(0)
    s_barrier
    ds_read_b64 v[22:23], v14 offset:61440
    ds_read_b64 v[24:25], v14 offset:62464
    ds_read_b64 v[26:27], v14 offset:62976
    s_cmp_lg_u32 s3, 1
    s_cbranch_scc1 L_xs_136
    v_lshlrev_b32 v14, 4, v2
    s_waitcnt lgkmcnt(2)
    v_add_f32 v20, v20, v22
    v_add_f32 v21, v21, v23
    s_waitcnt lgkmcnt(1)
    v_add_f32 v20, v20, v24
    v_add_f32 v21, v21, v25
    s_waitcnt lgkmcnt(0)
    v_add_f32 v20, v20, v26
    v_add_f32 v21, v21, v27
    v_mov_b32 v22, v20
    v_mov_b32 v23, v21
    s_nop 1
    v_permlane32_swap_b32 v20, v22
    v_permlane32_swap_b32 v21, v23
    s_nop 1
    v_add_f32 v20, v20, v22
    v_add_f32 v21, v21, v23
    v_bfi_b32 v20, 1, s6, v20
    s_mov_b64 exec, s[66:67]
    s_cmp_eq_u32 s7, 0
    s_cbranch_scc1 L_stsl_137
    buffer_store_dwordx2 v[20:21], v14, s[36:39], s62 offen
L_stdn_138:
    s_mov_b64 exec, -1
L_xs_136:
    buffer_load_dword v109, v108, s[28:31], s57 offen sc1
    buffer_load_dwordx4 v[128:131], v4, s[28:31], s78 offen offset:0 sc1
    buffer_load_dwordx4 v[132:135], v4, s[28:31], s78 offen offset:1024 sc1
    buffer_load_dwordx4 v[136:139], v4, s[28:31], s78 offen offset:2048 sc1
    buffer_load_dwordx4 v[140:143], v4, s[28:31], s78 offen offset:3072 sc1
    buffer_load_dwordx4 v[144:147], v4, s[28:31], s79 offen offset:0 sc1
    buffer_load_dwordx4 v[148:151], v4, s[28:31], s79 offen offset:1024 sc1
    buffer_load_dwordx4 v[152:155], v4, s[28:31], s79 offen offset:2048 sc1
    buffer_load_dwordx4 v[156:159], v4, s[28:31], s79 offen offset:3072 sc1
    v_mov_b32 v96, v104
    v_mov_b32 v100, v105
    s_lshl_b32 s46, s3, 11
    v_add_u32 v14, s46, v4
    ds_write_b128 v14, v[96:99] offset:49664
    ds_write_b128 v14, v[100:103] offset:50688
    s_add_u32 s6, s6, 1
    s_xor_b32 s59, s59, 4096
    s_xor_b32 s74, s74, 0x10000
    s_xor_b32 s75, s75, 0x10000
    s_lshl_b32 s93, s6, 15
    s_and_b32 s93, s93, 65536
    s_xor_b32 s70, s70, 1792
L_sw_143:
    v_mov_b32 v106, v32
L_xpb_146:
    v_mov_b32 v60, 0
    v_lshlrev_b32 v15, 3, v2
    v_add_u32 v15, s70, v15
    ds_read_b64_tr_b16 v[24:25], v7 offset:0
    ds_read_b64_tr_b16 v[26:27], v8 offset:0
    ds_read_b64_tr_b16 v[28:29], v9 offset:0
    ds_read_b64_tr_b16 v[30:31], v10 offset:0
    ds_read_b64_tr_b16 v[32:33], v7 offset:1024
    ds_read_b64_tr_b16 v[34:35], v8 offset:1024
    ds_read_b64_tr_b16 v[36:37], v9 offset:1024
    ds_read_b64_tr_b16 v[38:39], v10 offset:1024
    ds_read_b64_tr_b16 v[40:41], v7 offset:2048
    ds_read_b64_tr_b16 v[42:43], v8 offset:2048
    ds_read_b64_tr_b16 v[44:45], v9 offset:2048
    ds_read_b64_tr_b16 v[46:47], v10 offset:2048
    s_waitcnt vmcnt(8)
    v_cmp_eq_u32 s[16:17], -1, v110
    v_xor_b32 v61, s75, v109
    v_and_b32 v61, 0x10000, v61
    v_cmp_ne_u32 vcc, 0, v61
    s_and_b64 vcc, vcc, s[44:45]
    s_cbranch_vccnz L_xpf_145
    s_waitcnt vmcnt(7) lgkmcnt(8)
    v_mfma_f32_32x32x16_bf16 v[64:79], v[24:27], v[128:131], 0
    ds_read_b64_tr_b16 v[48:49], v7 offset:3072
    ds_read_b64_tr_b16 v[50:51], v8 offset:3072
    buffer_load_dwordx4 v[160:163], v4, s[28:31], s80 offen offset:0 sc1
    v_bitop3_b32 v60, v60, v128, s75 bitop3:0xf6
    v_mfma_f32_32x32x16_bf16 v[80:95], v[128:131], v[28:31], 0
    ds_read_b64_tr_b16 v[52:53], v9 offset:3072
    ds_read_b64_tr_b16 v[54:55], v10 offset:3072
    s_waitcnt vmcnt(7) lgkmcnt(8)
    v_mfma_f32_32x32x16_bf16 v[64:79], v[32:35], v[132:135], v[64:79]
    ds_read_b64_tr_b16 v[24:25], v7 offset:4096
    ds_read_b64_tr_b16 v[26:27], v8 offset:4096
    buffer_load_dwordx4 v[164:167], v4, s[28:31], s80 offen offset:1024 sc1
    v_bitop3_b32 v60, v60, v132, s75 bitop3:0xf6
    v_mfma_f32_32x32x16_bf16 v[80:95], v[132:135], v[36:39], v[80:95]
    ds_read_b64_tr_b16 v[28:29], v9 offset:4096
    ds_read_b64_tr_b16 v[30:31], v10 offset:4096
    s_waitcnt vmcnt(7) lgkmcnt(8)
    v_mfma_f32_32x32x16_bf16 v[64:79], v[40:43], v[136:139], v[64:79]
    ds_read_b64_tr_b16 v[32:33], v7 offset:5120
    ds_read_b64_tr_b16 v[34:35], v8 offset:5120
    buffer_load_dwordx4 v[168:171], v4, s[28:31], s80 offen offset:2048 sc1
    v_bitop3_b32 v60, v60, v136, s75 bitop3:0xf6
    v_mfma_f32_32x32x16_bf16 v[80:95], v[136:139], v[44:47], v[80:95]
    ds_read_b64_tr_b16 v[36:37], v9 offset:5120
    ds_read_b64_tr_b16 v[38:39], v10 offset:5120
    s_waitcnt vmcnt(7) lgkmcnt(8)
    v_mfma_f32_32x32x16_bf16 v[64:79], v[48:51], v[140:143], v[64:79]
    ds_read_b64_tr_b16 v[40:41], v7 offset:6144
    ds_read_b64_tr_b16 v[42:43], v8 offset:6144
    buffer_load_dwordx4 v[172:175], v4, s[28:31], s80 offen offset:3072 sc1
    v_bitop3_b32 v60, v60, v140, s75 bitop3:0xf6
    v_mfma_f32_32x32x16_bf16 v[80:95], v[140:143], v[52:55], v[80:95]
    ds_read_b64_tr_b16 v[44:45], v9 offset:6144
    ds_read_b64_tr_b16 v[46:47], v10 offset:6144
    s_waitcnt vmcnt(7) lgkmcnt(8)
    v_mfma_f32_32x32x16_bf16 v[64:79], v[24:27], v[144:147], v[64:79]
    ds_read_b64_tr_b16 v[48:49], v7 offset:7168
    ds_read_b64_tr_b16 v[50:51], v8 offset:7168
    buffer_load_dwordx4 v[176:179], v4, s[28:31], s81 offen offset:0 sc1
    v_bitop3_b32 v60, v60, v144, s75 bitop3:0xf6
    v_mfma_f32_32x32x16_bf16 v[80:95], v[144:147], v[28:31], v[80:95]
    ds_read_b64_tr_b16 v[52:53], v9 offset:7168
    ds_read_b64_tr_b16 v[54:55], v10 offset:7168
    s_waitcnt vmcnt(7) lgkmcnt(8)
    v_mfma_f32_32x32x16_bf16 v[64:79], v[32:35], v[148:151], v[64:79]
    ds_read_b64_tr_b16 v[24:25], v7 offset:8192
    ds_read_b64_tr_b16 v[26:27], v8 offset:8192
    buffer_load_dwordx4 v[180:183], v4, s[28:31], s81 offen offset:1024 sc1
    v_bitop3_b32 v60, v60, v148, s75 bitop3:0xf6
    v_mfma_f32_32x32x16_bf16 v[80:95], v[148:151], v[36:39], v[80:95]
    ds_read_b64_tr_b16 v[28:29], v9 offset:8192
    ds_read_b64_tr_b16 v[30:31], v10 offset:8192
    s_waitcnt vmcnt(7) lgkmcnt(8)
    v_mfma_f32_32x32x16_bf16 v[64:79], v[40:43], v[152:155], v[64:79]
    ds_read_b64_tr_b16 v[32:33], v7 offset:9216
    ds_read_b64_tr_b16 v[34:35], v8 offset:9216
    buffer_load_dwordx4 v[184:187], v4, s[28:31], s81 offen offset:2048 sc1
    v_bitop3_b32 v60, v60, v152, s75 bitop3:0xf6
    v_mfma_f32_32x32x16_bf16 v[80:95], v[152:155], v[44:47], v[80:95]
    ds_read_b64_tr_b16 v[36:37], v9 offset:9216
    ds_read_b64_tr_b16 v[38:39], v10 offset:9216
    s_waitcnt vmcnt(7) lgkmcnt(8)
    v_mfma_f32_32x32x16_bf16 v[64:79], v[48:51], v[156:159], v[64:79]
    ds_read_b64_tr_b16 v[40:41], v7 offset:10240
    ds_read_b64_tr_b16 v[42:43], v8 offset:10240
    buffer_load_dwordx4 v[188:191], v4, s[28:31], s81 offen offset:3072 sc1
    v_bitop3_b32 v60, v60, v156, s75 bitop3:0xf6
    v_mfma_f32_32x32x16_bf16 v[80:95], v[156:159], v[52:55], v[80:95]
    ds_read_b64_tr_b16 v[44:45], v9 offset:10240
    ds_read_b64_tr_b16 v[46:47], v10 offset:10240
    s_waitcnt vmcnt(7) lgkmcnt(8)
    v_mfma_f32_32x32x16_bf16 v[64:79], v[24:27], v[160:163], v[64:79]
    ds_read_b64_tr_b16 v[48:49], v7 offset:11264
    ds_read_b64_tr_b16 v[50:51], v8 offset:11264
    buffer_load_dwordx4 v[192:195], v4, s[28:31], s82 offen offset:0 sc1
    v_bitop3_b32 v60, v60, v160, s75 bitop3:0xf6
    v_mfma_f32_32x32x16_bf16 v[80:95], v[160:163], v[28:31], v[80:95]
    ds_read_b64_tr_b16 v[52:53], v9 offset:11264
    ds_read_b64_tr_b16 v[54:55], v10 offset:11264
    v_and_b32 v61, 0x10000, v60
    v_cmp_ne_u32 vcc, 0, v61
    s_and_b64 vcc, vcc, s[44:45]
    s_cbranch_vccnz L_xrs_147
    s_waitcnt vmcnt(7) lgkmcnt(8)
    v_mfma_f32_32x32x16_bf16 v[64:79], v[32:35], v[164:167], v[64:79]
    ds_read_b64_tr_b16 v[24:25], v7 offset:12288
    ds_read_b64_tr_b16 v[26:27], v8 offset:12288
    buffer_load_dwordx4 v[196:199], v4, s[28:31], s82 offen offset:1024 sc1
    v_bitop3_b32 v60, v60, v164, s75 bitop3:0xf6
    v_mfma_f32_32x32x16_bf16 v[80:95], v[164:167], v[36:39], v[80:95]
    ds_read_b64_tr_b16 v[28:29], v9 offset:12288
    ds_read_b64_tr_b16 v[30:31], v10 offset:12288
    ds_read_b128 a[192:195], v106 offset:0
    ds_write_b128 v106, a[224:227] offset:0
    s_waitcnt vmcnt(7) lgkmcnt(10)
    v_mfma_f32_32x32x16_bf16 v[64:79], v[40:43], v[168:171], v[64:79]
    ds_read_b64_tr_b16 v[32:33], v7 offset:13312
    ds_read_b64_tr_b16 v[34:35], v8 offset:13312
    buffer_load_dwordx4 v[200:203], v4, s[28:31], s82 offen offset:2048 sc1
    v_bitop3_b32 v60, v60, v168, s75 bitop3:0xf6
    v_mfma_f32_32x32x16_bf16 v[80:95], v[168:171], v[44:47], v[80:95]
    ds_read_b64_tr_b16 v[36:37], v9 offset:13312
    ds_read_b64_tr_b16 v[38:39], v10 offset:13312
    s_waitcnt vmcnt(7) lgkmcnt(10)
    v_mfma_f32_32x32x16_bf16 v[64:79], v[48:51], v[172:175], v[64:79]
    ds_read_b64_tr_b16 v[40:41], v7 offset:14336
    ds_read_b64_tr_b16 v[42:43], v8 offset:14336
    buffer_load_dwordx4 v[204:207], v4, s[28:31], s82 offen offset:3072 sc1
    v_bitop3_b32 v60, v60, v172, s75 bitop3:0xf6
    v_mfma_f32_32x32x16_bf16 v[80:95], v[172:175], v[52:55], v[80:95]
    ds_read_b64_tr_b16 v[44:45], v9 offset:14336
    ds_read_b64_tr_b16 v[46:47], v10 offset:14336
    ds_read_b128 a[196:199], v106 offset:4096
    ds_write_b128 v106, a[228:231] offset:4096
    s_waitcnt vmcnt(7) lgkmcnt(12)
    v_mfma_f32_32x32x16_bf16 v[64:79], v[24:27], v[176:179], v[64:79]
    ds_read_b64_tr_b16 v[48:49], v7 offset:15360
    ds_read_b64_tr_b16 v[50:51], v8 offset:15360
    buffer_load_dwordx4 v[208:211], v4, s[28:31], s83 offen offset:0 sc1
    v_bitop3_b32 v60, v60, v176, s75 bitop3:0xf6
    v_mfma_f32_32x32x16_bf16 v[80:95], v[176:179], v[28:31], v[80:95]
    ds_read_b64_tr_b16 v[52:53], v9 offset:15360
    ds_read_b64_tr_b16 v[54:55], v10 offset:15360
    s_waitcnt vmcnt(7) lgkmcnt(10)
    v_mfma_f32_32x32x16_bf16 v[64:79], v[32:35], v[180:183], v[64:79]
    ds_read_b64_tr_b16 v[24:25], v7 offset:16384
    ds_read_b64_tr_b16 v[26:27], v8 offset:16384
    buffer_load_dwordx4 v[212:215], v4, s[28:31], s83 offen offset:1024 sc1
    v_bitop3_b32 v60, v60, v180, s75 bitop3:0xf6
    v_mfma_f32_32x32x16_bf16 v[80:95], v[180:183], v[36:39], v[80:95]
    ds_read_b64_tr_b16 v[28:29], v9 offset:16384
    ds_read_b64_tr_b16 v[30:31], v10 offset:16384
    ds_read_b128 a[200:203], v106 offset:8192
    ds_write_b128 v106, a[232:235] offset:8192
    s_waitcnt vmcnt(7) lgkmcnt(12)
    v_mfma_f32_32x32x16_bf16 v[64:79], v[40:43], v[184:187], v[64:79]
    ds_read_b64_tr_b16 v[32:33], v7 offset:17408
    ds_read_b64_tr_b16 v[34:35], v8 offset:17408
    buffer_load_dwordx4 v[216:219], v4, s[28:31], s83 offen offset:2048 sc1
    v_bitop3_b32 v60, v60, v184, s75 bitop3:0xf6
    v_mfma_f32_32x32x16_bf16 v[80:95], v[184:187], v[44:47], v[80:95]
    ds_read_b64_tr_b16 v[36:37], v9 offset:17408
    ds_read_b64_tr_b16 v[38:39], v10 offset:17408
    s_waitcnt vmcnt(7) lgkmcnt(10)
    v_mfma_f32_32x32x16_bf16 v[64:79], v[48:51], v[188:191], v[64:79]
    ds_read_b64_tr_b16 v[40:41], v7 offset:18432
    ds_read_b64_tr_b16 v[42:43], v8 offset:18432
    buffer_load_dwordx4 v[220:223], v4, s[28:31], s83 offen offset:3072 sc1
    v_bitop3_b32 v60, v60, v188, s75 bitop3:0xf6
    v_mfma_f32_32x32x16_bf16 v[80:95], v[188:191], v[52:55], v[80:95]
    ds_read_b64_tr_b16 v[44:45], v9 offset:18432
    ds_read_b64_tr_b16 v[46:47], v10 offset:18432
    ds_read_b128 a[204:207], v106 offset:12288
    ds_write_b128 v106, a[236:239] offset:12288
    s_waitcnt vmcnt(7) lgkmcnt(12)
    v_mfma_f32_32x32x16_bf16 v[64:79], v[24:27], v[192:195], v[64:79]
    ds_read_b64_tr_b16 v[48:49], v7 offset:19456
    ds_read_b64_tr_b16 v[50:51], v8 offset:19456
    buffer_load_dwordx4 v[224:227], v4, s[28:31], s64 offen offset:0 sc1
    v_bitop3_b32 v60, v60, v192, s75 bitop3:0xf6
    v_mfma_f32_32x32x16_bf16 v[80:95], v[192:195], v[28:31], v[80:95]
    ds_read_b64_tr_b16 v[52:53], v9 offset:19456
    ds_read_b64_tr_b16 v[54:55], v10 offset:19456
    s_waitcnt vmcnt(7) lgkmcnt(10)
    v_mfma_f32_32x32x16_bf16 v[64:79], v[32:35], v[196:199], v[64:79]
    ds_read_b64_tr_b16 v[24:25], v7 offset:20480
    ds_read_b64_tr_b16 v[26:27], v8 offset:20480
    buffer_load_dwordx4 v[228:231], v4, s[28:31], s64 offen offset:1024 sc1
    v_bitop3_b32 v60, v60, v196, s75 bitop3:0xf6
    v_mfma_f32_32x32x16_bf16 v[80:95], v[196:199], v[36:39], v[80:95]
    ds_read_b64_tr_b16 v[28:29], v9 offset:20480
    ds_read_b64_tr_b16 v[30:31], v10 offset:20480
    ds_read_b128 a[208:211], v106 offset:16384
    ds_write_b128 v106, a[240:243] offset:16384
    buffer_load_dwordx4 v[112:115], v4, s[36:39], s60 offen sc1
    s_waitcnt vmcnt(8) lgkmcnt(12)
    v_mfma_f32_32x32x16_bf16 v[64:79], v[40:43], v[200:203], v[64:79]
    ds_read_b64_tr_b16 v[32:33], v7 offset:21504
    ds_read_b64_tr_b16 v[34:35], v8 offset:21504
    buffer_load_dwordx4 v[232:235], v4, s[28:31], s64 offen offset:2048 sc1
    v_bitop3_b32 v60, v60, v200, s75 bitop3:0xf6
    v_mfma_f32_32x32x16_bf16 v[80:95], v[200:203], v[44:47], v[80:95]
    ds_read_b64_tr_b16 v[36:37], v9 offset:21504
    ds_read_b64_tr_b16 v[38:39], v10 offset:21504
    s_waitcnt vmcnt(8) lgkmcnt(10)
    v_mfma_f32_32x32x16_bf16 v[64:79], v[48:51], v[204:207], v[64:79]
    ds_read_b64_tr_b16 v[40:41], v7 offset:22528
    ds_read_b64_tr_b16 v[42:43], v8 offset:22528
    buffer_load_dwordx4 v[236:239], v4, s[28:31], s64 offen offset:3072 sc1
    v_bitop3_b32 v60, v60, v204, s75 bitop3:0xf6
    v_mfma_f32_32x32x16_bf16 v[80:95], v[204:207], v[52:55], v[80:95]
    ds_read_b64_tr_b16 v[44:45], v9 offset:22528
    ds_read_b64_tr_b16 v[46:47], v10 offset:22528
    ds_read_b128 a[212:215], v106 offset:20480
    ds_write_b128 v106, a[244:247] offset:20480
    s_waitcnt vmcnt(8) lgkmcnt(12)
    v_mfma_f32_32x32x16_bf16 v[64:79], v[24:27], v[208:211], v[64:79]
    ds_read_b64_tr_b16 v[48:49], v7 offset:23552
    ds_read_b64_tr_b16 v[50:51], v8 offset:23552
    buffer_load_dwordx4 v[240:243], v4, s[28:31], s65 offen offset:0 sc1
    v_bitop3_b32 v60, v60, v208, s75 bitop3:0xf6
    v_mfma_f32_32x32x16_bf16 v[80:95], v[208:211], v[28:31], v[80:95]
    ds_read_b64_tr_b16 v[52:53], v9 offset:23552
    ds_read_b64_tr_b16 v[54:55], v10 offset:23552
    s_waitcnt vmcnt(8) lgkmcnt(10)
    v_mfma_f32_32x32x16_bf16 v[64:79], v[32:35], v[212:215], v[64:79]
    ds_read_b64_tr_b16 v[24:25], v7 offset:24576
    ds_read_b64_tr_b16 v[26:27], v8 offset:24576
    buffer_load_dwordx4 v[244:247], v4, s[28:31], s65 offen offset:1024 sc1
    v_bitop3_b32 v60, v60, v212, s75 bitop3:0xf6
    v_mfma_f32_32x32x16_bf16 v[80:95], v[212:215], v[36:39], v[80:95]
    ds_read_b64_tr_b16 v[28:29], v9 offset:24576
    ds_read_b64_tr_b16 v[30:31], v10 offset:24576
    ds_read_b128 a[216:219], v106 offset:24576
    ds_write_b128 v106, a[248:251] offset:24576
    s_waitcnt vmcnt(8) lgkmcnt(12)
    v_mfma_f32_32x32x16_bf16 v[64:79], v[40:43], v[216:219], v[64:79]
    ds_read_b64_tr_b16 v[32:33], v7 offset:25600
    ds_read_b64_tr_b16 v[34:35], v8 offset:25600
    buffer_load_dwordx4 v[248:251], v4, s[28:31], s65 offen offset:2048 sc1
    v_bitop3_b32 v60, v60, v216, s75 bitop3:0xf6
    v_mfma_f32_32x32x16_bf16 v[80:95], v[216:219], v[44:47], v[80:95]
    ds_read_b64_tr_b16 v[36:37], v9 offset:25600
    ds_read_b64_tr_b16 v[38:39], v10 offset:25600
    s_waitcnt vmcnt(8) lgkmcnt(10)
    v_mfma_f32_32x32x16_bf16 v[64:79], v[48:51], v[220:223], v[64:79]
    ds_read_b64_tr_b16 v[40:41], v7 offset:26624
    ds_read_b64_tr_b16 v[42:43], v8 offset:26624
    buffer_load_dwordx4 v[252:255], v4, s[28:31], s65 offen offset:3072 sc1
    v_bitop3_b32 v60, v60, v220, s75 bitop3:0xf6
    v_mfma_f32_32x32x16_bf16 v[80:95], v[220:223], v[52:55], v[80:95]
    ds_read_b64_tr_b16 v[44:45], v9 offset:26624
    ds_read_b64_tr_b16 v[46:47], v10 offset:26624
    ds_read_b128 a[220:223], v106 offset:28672
    ds_write_b128 v106, a[252:255] offset:28672
    s_waitcnt vmcnt(8) lgkmcnt(12)
    v_mfma_f32_32x32x16_bf16 v[64:79], v[24:27], v[224:227], v[64:79]
    ds_read_b64_tr_b16 v[48:49], v7 offset:27648
    ds_read_b64_tr_b16 v[50:51], v8 offset:27648
    v_bitop3_b32 v60, v60, v224, s75 bitop3:0xf6
    v_mfma_f32_32x32x16_bf16 v[80:95], v[224:227], v[28:31], v[80:95]
    ds_read_b64_tr_b16 v[52:53], v9 offset:27648
    ds_read_b64_tr_b16 v[54:55], v10 offset:27648
    s_waitcnt vmcnt(6)
    v_lshlrev_b32 v61, 16, v112
    v_bitop3_b32 v60, v60, v61, s75 bitop3:0xf6
    v_lshlrev_b32 v61, 16, v114
    v_bitop3_b32 v60, v60, v61, s75 bitop3:0xf6
    s_waitcnt lgkmcnt(10)
    v_mfma_f32_32x32x16_bf16 v[64:79], v[32:35], v[228:231], v[64:79]
    ds_read_b64_tr_b16 v[24:25], v7 offset:28672
    ds_read_b64_tr_b16 v[26:27], v8 offset:28672
    v_add_f32 v112, v112, v114
    v_add_f32 v113, v113, v115
    v_mov_b32 v114, v112
    v_bitop3_b32 v60, v60, v228, s75 bitop3:0xf6
    v_mfma_f32_32x32x16_bf16 v[80:95], v[228:231], v[36:39], v[80:95]
    ds_read_b64_tr_b16 v[28:29], v9 offset:28672
    ds_read_b64_tr_b16 v[30:31], v10 offset:28672
    v_mov_b32 v115, v113
    v_mov_b32 v18, 0
    v_mov_b32 v19, 0
    s_waitcnt vmcnt(5) lgkmcnt(10)
    v_mfma_f32_32x32x16_bf16 v[64:79], v[40:43], v[232:235], v[64:79]
    ds_read_b64_tr_b16 v[32:33], v7 offset:29696
    ds_read_b64_tr_b16 v[34:35], v8 offset:29696
    v_permlane32_swap_b32 v112, v114
    v_permlane32_swap_b32 v113, v115
    s_lshl_b32 s46, s3, 7
    v_bitop3_b32 v60, v60, v232, s75 bitop3:0xf6
    v_mfma_f32_32x32x16_bf16 v[80:95], v[232:235], v[44:47], v[80:95]
    ds_read_b64_tr_b16 v[36:37], v9 offset:29696
    ds_read_b64_tr_b16 v[38:39], v10 offset:29696
    v_lshlrev_b32 v14, 2, v2
    v_add_f32 v112, v112, v114
    v_add_f32 v113, v113, v115
    s_waitcnt vmcnt(4) lgkmcnt(8)
    v_mfma_f32_32x32x16_bf16 v[64:79], v[48:51], v[236:239], v[64:79]
    ds_read_b64_tr_b16 v[40:41], v7 offset:30720
    ds_read_b64_tr_b16 v[42:43], v8 offset:30720
    v_mul_f32 v112, 0x3b000000, v112
    v_mul_f32 v113, 0x3b000000, v113
    v_fma_f32 v113, -v112, v112, v113
    v_bitop3_b32 v60, v60, v236, s75 bitop3:0xf6
    v_mfma_f32_32x32x16_bf16 v[80:95], v[236:239], v[52:55], v[80:95]
    ds_read_b64_tr_b16 v[44:45], v9 offset:30720
    ds_read_b64_tr_b16 v[46:47], v10 offset:30720
    v_max_f32 v113, 0, v113
    v_cvt_pk_bf16_f32 v114, v112, v113
    v_and_b32 v115, 0xffff0000, v114
    s_barrier
    s_waitcnt vmcnt(3) lgkmcnt(8)
    v_mfma_f32_32x32x16_bf16 v[64:79], v[24:27], v[240:243], v[64:79]
    ds_read_b64_tr_b16 v[48:49], v7 offset:31744
    ds_read_b64_tr_b16 v[50:51], v8 offset:31744
    v_add_f32 v115, 0x3727c5ac, v115
    v_cvt_pk_bf16_f32 v115, v115, v115
    v_and_b32 v115, 0xffff0000, v115
    v_bitop3_b32 v60, v60, v240, s75 bitop3:0xf6
    v_mfma_f32_32x32x16_bf16 v[80:95], v[240:243], v[28:31], v[80:95]
    ds_read_b64_tr_b16 v[52:53], v9 offset:31744
    ds_read_b64_tr_b16 v[54:55], v10 offset:31744
    v_sqrt_f32 v115, v115
    v_and_b32 v114, 0xffff, v114
    v_xor_b32 v114, 0x8000, v114
    s_waitcnt vmcnt(2) lgkmcnt(8)
    v_mfma_f32_32x32x16_bf16 v[64:79], v[32:35], v[244:247], v[64:79]
    ds_read_b64 v[24:25], v15 offset:256
    ds_read_b64 v[28:29], v15 offset:512
    v_cvt_pk_bf16_f32 v115, v115, v115
    v_and_b32 v115, 0xffff0000, v115
    v_rcp_f32 v12, v115
    v_bitop3_b32 v60, v60, v244, s75 bitop3:0xf6
    v_mfma_f32_32x32x16_bf16 v[80:95], v[244:247], v[36:39], v[80:95]
    v_cndmask_b32_e64 v17, 0, v114, s[66:67]
    v_lshl_or_b32 v16, v17, 16, v17
    v_add_u32 v14, s46, v14
    s_waitcnt vmcnt(1) lgkmcnt(6)
    v_mfma_f32_32x32x16_bf16 v[64:79], v[40:43], v[248:251], v[64:79]
    ds_read_b64 v[32:33], v15 offset:0
    ds_read_b64_tr_b16 v[36:37], v5 offset:31744
    v_mul_f32 v13, 0x3eb8aa3b, v12
    v_lshlrev_b32 v21, 4, v3
    v_add_u32 v21, s46, v21
    ds_write_b32 v14, v12 offset:59392
    ds_read_b128 v[112:115], v21 offset:59392
    ds_read_b128 v[116:119], v21 offset:59424
    ds_read_b128 v[120:123], v21 offset:59456
    ds_read_b128 v[124:127], v21 offset:59488
    v_bitop3_b32 v60, v60, v248, s75 bitop3:0xf6
    v_mfma_f32_32x32x16_bf16 v[80:95], v[248:251], v[44:47], v[80:95]
    ds_read_b64_tr_b16 v[38:39], v6 offset:31744
    s_waitcnt vmcnt(0) lgkmcnt(10)
    v_mfma_f32_32x32x16_bf16 v[64:79], v[48:51], v[252:255], v[64:79]
    ds_read_b64_tr_b16 v[40:41], v5 offset:30720
    ds_read_b64_tr_b16 v[42:43], v6 offset:30720
    v_bitop3_b32 v60, v60, v252, s75 bitop3:0xf6
    v_mfma_f32_32x32x16_bf16 v[80:95], v[252:255], v[52:55], v[80:95]
    ds_read_b64_tr_b16 v[44:45], v5 offset:29696
    ds_read_b64_tr_b16 v[46:47], v6 offset:29696
    v_and_b32 v61, 0x10000, v60
    v_cmp_ne_u32 vcc, 0, v61
    s_and_b64 vcc, vcc, s[44:45]
    s_cbranch_vccnz L_g_redo_141
L_g_join_140:
    s_waitcnt lgkmcnt(12)
    v_mfma_f32_32x32x16_bf16 v[64:79], v[24:27], v[16:19], v[64:79]
    v_mfma_f32_32x32x16_bf16 v[80:95], v[16:19], v[28:31], v[80:95]
    ds_read_b64_tr_b16 v[24:25], v5 offset:28672
    ds_read_b64_tr_b16 v[26:27], v6 offset:28672
    s_waitcnt lgkmcnt(13)
    v_mfma_f32_32x32x16_bf16 v[96:111], v[32:35], v[16:19], 0
    ds_read_b64_tr_b16 v[28:29], v5 offset:27648
    ds_read_b64_tr_b16 v[30:31], v6 offset:27648
    s_lshr_b32 s68, 0x7fff, s4
    s_and_b32 s68, s68, 3
    s_and_b32 s68, s68, s44
    s_and_b32 s69, s68, s16
    s_cbranch_scc1 L_fsl_152
L_fsk_151:
    v_mul_f32 v64, v12, v64
    v_mul_f32 v65, v12, v65
    v_mul_f32 v66, v12, v66
    v_mul_f32 v67, v12, v67
    s_waitcnt lgkmcnt(8)
    v_mfma_f32_32x32x16_bf16 v[96:111], v[36:39], v[252:255], v[96:111]
    ds_read_b64_tr_b16 v[32:33], v5 offset:26624
    ds_read_b64_tr_b16 v[34:35], v6 offset:26624
    v_mul_f32 v68, v12, v68
    v_mul_f32 v69, v12, v69
    v_mul_f32 v70, v12, v70
    v_mul_f32 v71, v12, v71
    v_and_b32 v65, 0xfffe0000, v65
    v_cvt_pk_bf16_f32 v64, v64, v65
    v_cvt_pk_bf16_f32 v65, v66, v67
    s_waitcnt lgkmcnt(6)
    v_mfma_f32_32x32x16_bf16 v[96:111], v[40:43], v[248:251], v[96:111]
    ds_read_b64_tr_b16 v[36:37], v5 offset:25600
    ds_read_b64_tr_b16 v[38:39], v6 offset:25600
    v_cvt_pk_bf16_f32 v66, v68, v69
    v_cvt_pk_bf16_f32 v67, v70, v71
    v_or_b32 v64, 0x10000, v64
    buffer_store_dwordx4 v[64:67], v4, s[36:39], s59 offen offset:0 sc1
L_kvsk_154:
    v_mul_f32 v72, v12, v72
    v_mul_f32 v73, v12, v73
    v_mul_f32 v74, v12, v74
    v_mfma_f32_32x32x16_bf16 v[96:111], v[44:47], v[244:247], v[96:111]
    ds_read_b64_tr_b16 v[40:41], v5 offset:24576
    ds_read_b64_tr_b16 v[42:43], v6 offset:24576
    v_mul_f32 v75, v12, v75
    v_mul_f32 v76, v12, v76
    v_mul_f32 v77, v12, v77
    v_mul_f32 v78, v12, v78
    v_mul_f32 v79, v12, v79
    v_and_b32 v73, 0xfffe0000, v73
    v_cvt_pk_bf16_f32 v68, v72, v73
    s_waitcnt lgkmcnt(6)
    v_mfma_f32_32x32x16_bf16 v[96:111], v[24:27], v[240:243], v[96:111]
    ds_read_b64_tr_b16 v[44:45], v5 offset:23552
    ds_read_b64_tr_b16 v[46:47], v6 offset:23552
    v_cvt_pk_bf16_f32 v69, v74, v75
    v_cvt_pk_bf16_f32 v70, v76, v77
    v_cvt_pk_bf16_f32 v71, v78, v79
    v_or_b32 v68, 0x10000, v68
    buffer_store_dwordx4 v[68:71], v4, s[36:39], s59 offen offset:1024 sc1
L_kvsk_155:
    s_waitcnt lgkmcnt(15)
    v_mfma_f32_32x32x16_bf16 v[96:111], v[28:31], v[236:239], v[96:111]
    ds_read_b64_tr_b16 v[24:25], v5 offset:22528
    ds_read_b64_tr_b16 v[26:27], v6 offset:22528
    v_mul_f32 v88, v120, v88
    v_mul_f32 v89, v121, v89
    v_mul_f32 v90, v122, v90
    v_mul_f32 v91, v123, v91
    v_mul_f32 v92, v124, v92
    v_mul_f32 v93, v125, v93
    v_mul_f32 v94, v126, v94
    s_waitcnt lgkmcnt(6)
    v_mfma_f32_32x32x16_bf16 v[96:111], v[32:35], v[232:235], v[96:111]
    ds_read_b64_tr_b16 v[28:29], v5 offset:21504
    ds_read_b64_tr_b16 v[30:31], v6 offset:21504
    v_mul_f32 v95, v127, v95
    v_and_b32 v89, 0xfffe0000, v89
    v_cvt_pk_bf16_f32 v88, v88, v89
    v_cvt_pk_bf16_f32 v89, v90, v91
    v_cvt_pk_bf16_f32 v90, v92, v93
    v_cvt_pk_bf16_f32 v91, v94, v95
    v_or_b32 v88, 0x10000, v88
    buffer_store_dwordx4 v[88:91], v4, s[36:39], s59 offen offset:3072 sc1
L_kvsk_156:
    v_mfma_f32_32x32x16_bf16 v[96:111], v[36:39], v[228:231], v[96:111]
    ds_read_b64_tr_b16 v[32:33], v5 offset:20480
    ds_read_b64_tr_b16 v[34:35], v6 offset:20480
    v_mul_f32 v80, v112, v80
    v_mul_f32 v81, v113, v81
    v_mul_f32 v82, v114, v82
    v_mul_f32 v83, v115, v83
    v_mul_f32 v84, v116, v84
    v_mul_f32 v85, v117, v85
    v_mul_f32 v86, v118, v86
    s_waitcnt lgkmcnt(6)
    v_mfma_f32_32x32x16_bf16 v[96:111], v[40:43], v[224:227], v[96:111]
    ds_read_b64_tr_b16 v[36:37], v5 offset:19456
    ds_read_b64_tr_b16 v[38:39], v6 offset:19456
    v_mul_f32 v87, v119, v87
    v_and_b32 v81, 0xfffe0000, v81
    v_cvt_pk_bf16_f32 v80, v80, v81
    v_cvt_pk_bf16_f32 v81, v82, v83
    v_cvt_pk_bf16_f32 v82, v84, v85
    v_cvt_pk_bf16_f32 v83, v86, v87
    v_or_b32 v80, 0x10000, v80
    buffer_store_dwordx4 v[80:83], v4, s[36:39], s59 offen offset:2048 sc1
L_kvsk_157:
    v_mfma_f32_32x32x16_bf16 v[96:111], v[44:47], v[220:223], v[96:111]
    ds_read_b64_tr_b16 v[40:41], v5 offset:18432
    ds_read_b64_tr_b16 v[42:43], v6 offset:18432
    s_mul_i32 s46, s3, 4128
    v_add_u32 v248, s46, v4
    s_waitcnt lgkmcnt(6)
    v_mfma_f32_32x32x16_bf16 v[96:111], v[24:27], v[216:219], v[96:111]
    ds_read_b64_tr_b16 v[44:45], v5 offset:17408
    ds_read_b64_tr_b16 v[46:47], v6 offset:17408
    ds_write_b128 v248, v[64:67] offset:33024
    v_mfma_f32_32x32x16_bf16 v[96:111], v[28:31], v[212:215], v[96:111]
    ds_read_b64_tr_b16 v[24:25], v5 offset:16384
    ds_read_b64_tr_b16 v[26:27], v6 offset:16384
    ds_write_b128 v248, v[68:71] offset:34048
    s_waitcnt lgkmcnt(8)
    v_mfma_f32_32x32x16_bf16 v[96:111], v[32:35], v[208:211], v[96:111]
    ds_read_b64_tr_b16 v[28:29], v5 offset:15360
    ds_read_b64_tr_b16 v[30:31], v6 offset:15360
    ds_write_b128 v248, v[80:83] offset:35072
    v_mfma_f32_32x32x16_bf16 v[96:111], v[36:39], v[204:207], v[96:111]
    ds_read_b64_tr_b16 v[32:33], v5 offset:14336
    ds_read_b64_tr_b16 v[34:35], v6 offset:14336
    ds_write_b128 v248, v[88:91] offset:36112
    s_waitcnt lgkmcnt(10)
    v_mfma_f32_32x32x16_bf16 v[96:111], v[40:43], v[200:203], v[96:111]
    ds_read_b64_tr_b16 v[36:37], v5 offset:13312
    ds_read_b64_tr_b16 v[38:39], v6 offset:13312
    s_add_u32 s46, s46, 1024
    v_mov_b32 v14, s46
    v_add_u32 v251, 0x400, v248
    v_mfma_f32_32x32x16_bf16 v[96:111], v[44:47], v[196:199], v[96:111]
    ds_read_b64_tr_b16 v[40:41], v5 offset:12288
    ds_read_b64_tr_b16 v[42:43], v6 offset:12288
    v_add_u32 v250, 0x100, v248
    v_cndmask_b32_e64 v249, v14, v248, s[72:73]
    s_waitcnt lgkmcnt(8)
    v_mfma_f32_32x32x16_bf16 v[96:111], v[24:27], v[192:195], v[96:111]
    ds_read_b64_tr_b16 v[44:45], v5 offset:11264
    ds_read_b64_tr_b16 v[46:47], v6 offset:11264
    v_cndmask_b32_e64 v250, v14, v250, s[72:73]
    v_lshlrev_b32 v14, 2, v3
    v_sub_u32 v14, v14, v2
    v_mfma_f32_32x32x16_bf16 v[96:111], v[28:31], v[188:191], v[96:111]
    ds_read_b64_tr_b16 v[24:25], v5 offset:10240
    ds_read_b64_tr_b16 v[26:27], v6 offset:10240
    v_lshlrev_b32 v14, 2, v14
    v_add_u32 v14, 60032, v14
    s_waitcnt lgkmcnt(6)
    v_mfma_f32_32x32x16_bf16 v[96:111], v[32:35], v[184:187], v[96:111]
    ds_read_b64_tr_b16 v[28:29], v5 offset:9216
    ds_read_b64_tr_b16 v[30:31], v6 offset:9216
    ds_read2_b32 v[232:233], v14 offset0:0 offset1:1
    ds_read2_b32 v[234:235], v14 offset0:2 offset1:3
    ds_read2_b32 v[236:237], v14 offset0:8 offset1:9
    v_mfma_f32_32x32x16_bf16 v[96:111], v[36:39], v[180:183], v[96:111]
    ds_read_b64_tr_b16 v[32:33], v5 offset:8192
    ds_read_b64_tr_b16 v[34:35], v6 offset:8192
    ds_read2_b32 v[238:239], v14 offset0:10 offset1:11
    ds_read2_b32 v[240:241], v14 offset0:16 offset1:17
    s_waitcnt lgkmcnt(11)
    v_mfma_f32_32x32x16_bf16 v[96:111], v[40:43], v[176:179], v[96:111]
    ds_read_b64_tr_b16 v[36:37], v5 offset:7168
    ds_read_b64_tr_b16 v[38:39], v6 offset:7168
    ds_read2_b32 v[242:243], v14 offset0:18 offset1:19
    ds_read2_b32 v[244:245], v14 offset0:24 offset1:25
    ds_read2_b32 v[246:247], v14 offset0:26 offset1:27
    v_mfma_f32_32x32x16_bf16 v[96:111], v[44:47], v[172:175], v[96:111]
    ds_read_b64_tr_b16 v[40:41], v5 offset:6144
    ds_read_b64_tr_b16 v[42:43], v6 offset:6144
    s_waitcnt lgkmcnt(14)
    v_mfma_f32_32x32x16_bf16 v[96:111], v[24:27], v[168:171], v[96:111]
    ds_read_b64_tr_b16 v[44:45], v5 offset:5120
    ds_read_b64_tr_b16 v[46:47], v6 offset:5120
    v_mfma_f32_32x32x16_bf16 v[96:111], v[28:31], v[164:167], v[96:111]
    ds_read_b64_tr_b16 v[24:25], v5 offset:4096
    ds_read_b64_tr_b16 v[26:27], v6 offset:4096
    s_waitcnt lgkmcnt(9)
    v_mfma_f32_32x32x16_bf16 v[96:111], v[32:35], v[160:163], v[96:111]
    ds_read_b64_tr_b16 v[28:29], v5 offset:3072
    ds_read_b64_tr_b16 v[30:31], v6 offset:3072
    v_mfma_f32_32x32x16_bf16 v[96:111], v[36:39], v[156:159], v[96:111]
    ds_read_b64_tr_b16 v[32:33], v5 offset:2048
    ds_read_b64_tr_b16 v[34:35], v6 offset:2048
    s_waitcnt lgkmcnt(6)
    v_mfma_f32_32x32x16_bf16 v[96:111], v[40:43], v[152:155], v[96:111]
    ds_read_b64_tr_b16 v[36:37], v5 offset:1024
    ds_read_b64_tr_b16 v[38:39], v6 offset:1024
    v_mfma_f32_32x32x16_bf16 v[96:111], v[44:47], v[148:151], v[96:111]
    ds_read_b64_tr_b16 v[40:41], v5 offset:0
    ds_read_b64_tr_b16 v[42:43], v6 offset:0
    s_waitcnt lgkmcnt(6)
    v_mfma_f32_32x32x16_bf16 v[96:111], v[24:27], v[144:147], v[96:111]
    ds_read_b128 v[160:163], v248 offset:33024
    ds_read_b128 v[164:167], v249 offset:35072
    v_mfma_f32_32x32x16_bf16 v[96:111], v[28:31], v[140:143], v[96:111]
    ds_read_b128 v[168:171], v249 offset:36112
    ds_read_b128 v[172:175], v251 offset:33024
    s_waitcnt lgkmcnt(6)
    v_mfma_f32_32x32x16_bf16 v[96:111], v[32:35], v[136:139], v[96:111]
    ds_read_b128 v[176:179], v250 offset:35072
    ds_read_b128 v[180:183], v250 offset:36112
    v_mfma_f32_32x32x16_bf16 v[96:111], v[36:39], v[132:135], v[96:111]
    s_waitcnt lgkmcnt(6)
    v_mfma_f32_32x32x16_bf16 v[96:111], v[40:43], v[128:131], v[96:111]
    v_add_u32 v248, s12, v4
    v_add_u32 v249, s14, v4
    v_mov_b32 v14, s25
    v_cndmask_b32_e64 v249, v14, v249, s[72:73]
    v_add_u32 v251, s13, v4
    v_add_u32 v250, s15, v4
    v_mov_b32 v14, s26
    v_cndmask_b32_e64 v250, v14, v250, s[72:73]
    s_sub_u32 s46, s3, 8
    s_lshl_b32 s47, s46, 14
    s_add_u32 s76, s59, s47
    s_add_u32 s77, s76, 16384
    s_add_i32 s46, s46, s54
    s_cmp_lt_i32 s46, 0
    s_cselect_b32 s76, 0x7f000000, s76
    s_cselect_b32 s77, 0x7f000000, s77
    s_cselect_b32 s27, 0, s93
    s_mul_i32 s81, s3, 8256
    s_lshl_b32 s46, s3, 10
    s_add_u32 s46, s46, 65536
    v_add_u32 v32, s46, v4
    v_add_u32 v33, 0x10000, v32
    s_lshl_b32 s46, s3, 10
    v_add_u32 v27, s46, v4
    v_xor_b32 v28, 0xc00, v27
    s_nop 0
    s_cmp_ge_u32 s3, 2
    s_cbranch_scc1 L_qxh_158
    v_mul_f32 v96, v13, v96
    v_mul_f32 v97, v13, v97
    v_mul_f32 v98, v13, v98
    v_mul_f32 v99, v13, v99
    v_mul_f32 v100, v13, v100
    v_mul_f32 v101, v13, v101
    v_mul_f32 v102, v13, v102
    v_mul_f32 v103, v13, v103
    v_cvt_pk_bf16_f32 v16, v96, v97
    v_cvt_pk_bf16_f32 v17, v98, v99
    v_cvt_pk_bf16_f32 v18, v100, v101
    v_cvt_pk_bf16_f32 v19, v102, v103
    s_waitcnt lgkmcnt(0)
    s_nop 0
    v_mfma_f32_32x32x16_bf16 v[128:143], v[160:163], v[16:19], v[232:247]
    v_mul_f32 v104, v13, v104
    v_mul_f32 v105, v13, v105
    v_mul_f32 v106, v13, v106
    v_mul_f32 v107, v13, v107
    v_mul_f32 v108, v13, v108
    v_mul_f32 v109, v13, v109
    v_mul_f32 v110, v13, v110
    v_mul_f32 v111, v13, v111
    v_cvt_pk_bf16_f32 v20, v104, v105
    v_cvt_pk_bf16_f32 v21, v106, v107
    v_cvt_pk_bf16_f32 v22, v108, v109
    v_cvt_pk_bf16_f32 v23, v110, v111
    ds_write_b128 v27, v[20:23] offset:61440
    v_exp_f32 v128, v128
    v_exp_f32 v129, v129
    v_exp_f32 v130, v130
    s_waitcnt lgkmcnt(0)
    s_barrier
    ds_read_b128 v[20:23], v28 offset:61440
    ds_read_b128 v[172:175], v251 offset:33024
    ds_read_b128 v[176:179], v250 offset:35072
    ds_read_b128 v[180:183], v250 offset:36112
    ds_read_b128 v[184:187], v251 offset:28896
    ds_read_b128 v[188:191], v250 offset:30944
    ds_read_b128 v[192:195], v250 offset:31984
    v_exp_f32 v131, v131
    v_exp_f32 v132, v132
    s_add_u32 m0, s81, 0
    v_exp_f32 v133, v133
    buffer_load_dwordx4 v4, s[36:39], s76 offen offset:0 sc1 lds
    buffer_load_dwordx4 v4, s[36:39], s76 offen offset:1024 sc1 lds
    ds_write_b128 v32, a[128:131] offset:32768
    s_add_u32 m0, s81, 0
    ds_write_b128 v32, a[132:135] offset:36864
    buffer_load_dwordx4 v4, s[36:39], s76 offen offset:2048 sc1 lds
    ds_write_b128 v32, a[136:139] offset:40960
    v_exp_f32 v134, v134
    v_exp_f32 v135, v135
    v_exp_f32 v136, v136
    v_exp_f32 v137, v137
    v_exp_f32 v138, v138
    s_waitcnt lgkmcnt(8)
    v_mfma_f32_32x32x16_bf16 v[144:159], v[172:175], v[20:23], v[232:247]
    v_exp_f32 v139, v139
    ds_read_b128 v[196:199], v251 offset:24768
    ds_read_b128 v[200:203], v250 offset:26816
    ds_read_b128 v[204:207], v250 offset:27856
    v_exp_f32 v140, v140
    s_add_u32 m0, s81, 16
    v_exp_f32 v141, v141
    buffer_load_dwordx4 v4, s[36:39], s76 offen offset:3072 sc1 lds
    s_add_u32 m0, s81, 4128
    ds_write_b128 v32, a[140:143] offset:45056
    buffer_load_dwordx4 v4, s[36:39], s77 offen offset:0 sc1 lds
    buffer_load_dwordx4 v4, s[36:39], s77 offen offset:1024 sc1 lds
    ds_write_b128 v32, a[144:147] offset:49152
    v_exp_f32 v142, v142
    v_exp_f32 v143, v143
    v_cvt_pk_bf16_f32 v128, v128, v129
    s_waitcnt lgkmcnt(10)
    v_mfma_f32_32x32x16_bf16 v[64:79], v[184:187], v[20:23], 0
    v_cvt_pk_bf16_f32 v129, v130, v131
    v_cvt_pk_bf16_f32 v130, v132, v133
    v_cvt_pk_bf16_f32 v131, v134, v135
    v_cvt_pk_bf16_f32 v132, v136, v137
    s_add_u32 m0, s81, 4128
    v_cvt_pk_bf16_f32 v133, v138, v139
    buffer_load_dwordx4 v4, s[36:39], s77 offen offset:2048 sc1 lds
    s_add_u32 m0, s81, 4144
    ds_write_b128 v32, a[148:151] offset:53248
    buffer_load_dwordx4 v4, s[36:39], s77 offen offset:3072 sc1 lds
    ds_write_b128 v32, a[152:155] offset:57344
    v_cvt_pk_bf16_f32 v134, v140, v141
    v_cvt_pk_bf16_f32 v135, v142, v143
    v_exp_f32 v144, v144
    v_exp_f32 v145, v145
    v_mfma_f32_32x32x16_bf16 v[96:111], v[164:167], v[128:131], 0
    v_exp_f32 v146, v146
    v_exp_f32 v147, v147
    ds_write_b128 v32, a[156:159] offset:61440
    s_add_u32 s83, s40, 0
    buffer_load_dwordx4 a[224:227], v4, s[36:39], s83 offen offset:0
    v_exp_f32 v148, v148
    v_exp_f32 v149, v149
    v_exp_f32 v150, v150
    v_exp_f32 v151, v151
    v_mfma_f32_32x32x16_bf16 v[96:111], v[168:171], v[132:135], v[96:111]
    v_exp_f32 v152, v152
    v_exp_f32 v153, v153
    ds_write_b128 v33, a[160:163] offset:0
    ds_write_b128 v33, a[164:167] offset:4096
    buffer_load_dwordx4 a[228:231], v4, s[36:39], s83 offen offset:1024
    v_exp_f32 v154, v154
    v_exp_f32 v155, v155
    v_exp_f32 v156, v156
    v_exp_f32 v157, v157
    s_waitcnt lgkmcnt(9)
    v_mfma_f32_32x32x16_bf16 v[80:95], v[196:199], v[20:23], 0
    v_exp_f32 v158, v158
    v_exp_f32 v159, v159
    ds_write_b128 v33, a[168:171] offset:8192
    buffer_load_dwordx4 a[232:235], v4, s[36:39], s83 offen offset:2048
    v_cvt_pk_bf16_f32 v144, v144, v145
    v_cvt_pk_bf16_f32 v145, v146, v147
    v_cvt_pk_bf16_f32 v146, v148, v149
    v_cvt_pk_bf16_f32 v147, v150, v151
    v_cvt_pk_bf16_f32 v148, v152, v153
    ds_write_b128 v33, a[172:175] offset:12288
    buffer_load_dwordx4 a[236:239], v4, s[36:39], s83 offen offset:3072
    v_cvt_pk_bf16_f32 v149, v154, v155
    v_cvt_pk_bf16_f32 v150, v156, v157
    v_cvt_pk_bf16_f32 v151, v158, v159
    v_exp_f32 v64, v64
    v_exp_f32 v65, v65
    v_mfma_f32_32x32x16_bf16 v[112:127], v[176:179], v[144:147], 0
    v_exp_f32 v66, v66
    v_exp_f32 v67, v67
    ds_write_b128 v33, a[176:179] offset:16384
    s_add_u32 s83, s40, 4096
    buffer_load_dwordx4 a[240:243], v4, s[36:39], s83 offen offset:0
    v_exp_f32 v68, v68
    v_exp_f32 v69, v69
    v_exp_f32 v70, v70
    v_exp_f32 v71, v71
    v_mfma_f32_32x32x16_bf16 v[112:127], v[180:183], v[148:151], v[112:127]
    v_exp_f32 v72, v72
    v_exp_f32 v73, v73
    ds_write_b128 v33, a[180:183] offset:20480
    buffer_load_dwordx4 a[244:247], v4, s[36:39], s83 offen offset:1024
    v_exp_f32 v74, v74
    v_exp_f32 v75, v75
    v_exp_f32 v76, v76
    v_exp_f32 v77, v77
    v_exp_f32 v78, v78
    v_exp_f32 v79, v79
    ds_write_b128 v33, a[184:187] offset:24576
    buffer_load_dwordx4 a[248:251], v4, s[36:39], s83 offen offset:2048
    v_cvt_pk_bf16_f32 v64, v64, v65
    v_cvt_pk_bf16_f32 v65, v66, v67
    v_cvt_pk_bf16_f32 v66, v68, v69
    v_cvt_pk_bf16_f32 v67, v70, v71
    v_cvt_pk_bf16_f32 v68, v72, v73
    ds_write_b128 v33, a[188:191] offset:28672
    buffer_load_dwordx4 a[252:255], v4, s[36:39], s83 offen offset:3072
    v_cvt_pk_bf16_f32 v69, v74, v75
    v_cvt_pk_bf16_f32 v70, v76, v77
    v_cvt_pk_bf16_f32 v71, v78, v79
    s_branch L_qxd_159
L_qxh_158:
    v_mul_f32 v104, v13, v104
    v_mul_f32 v105, v13, v105
    v_mul_f32 v106, v13, v106
    v_mul_f32 v107, v13, v107
    v_mul_f32 v108, v13, v108
    v_mul_f32 v109, v13, v109
    v_mul_f32 v110, v13, v110
    v_mul_f32 v111, v13, v111
    v_cvt_pk_bf16_f32 v20, v104, v105
    v_cvt_pk_bf16_f32 v21, v106, v107
    v_cvt_pk_bf16_f32 v22, v108, v109
    v_cvt_pk_bf16_f32 v23, v110, v111
    s_waitcnt lgkmcnt(0)
    s_nop 0
    v_mfma_f32_32x32x16_bf16 v[144:159], v[172:175], v[20:23], v[232:247]
    v_mul_f32 v96, v13, v96
    v_mul_f32 v97, v13, v97
    v_mul_f32 v98, v13, v98
    v_mul_f32 v99, v13, v99
    v_mul_f32 v100, v13, v100
    v_mul_f32 v101, v13, v101
    v_mul_f32 v102, v13, v102
    v_mul_f32 v103, v13, v103
    v_cvt_pk_bf16_f32 v16, v96, v97
    v_cvt_pk_bf16_f32 v17, v98, v99
    v_cvt_pk_bf16_f32 v18, v100, v101
    v_cvt_pk_bf16_f32 v19, v102, v103
    ds_write_b128 v27, v[16:19] offset:61440
    v_exp_f32 v144, v144
    v_exp_f32 v145, v145
    v_exp_f32 v146, v146
    s_waitcnt lgkmcnt(0)
    s_barrier
    ds_read_b128 v[16:19], v28 offset:61440
    ds_read_b128 v[160:163], v248 offset:33024
    ds_read_b128 v[164:167], v249 offset:35072
    ds_read_b128 v[168:171], v249 offset:36112
    ds_read_b128 v[184:187], v251 offset:28896
    ds_read_b128 v[188:191], v250 offset:30944
    ds_read_b128 v[192:195], v250 offset:31984
    v_exp_f32 v147, v147
    v_exp_f32 v148, v148
    s_add_u32 m0, s81, 0
    v_exp_f32 v149, v149
    buffer_load_dwordx4 v4, s[36:39], s76 offen offset:0 sc1 lds
    buffer_load_dwordx4 v4, s[36:39], s76 offen offset:1024 sc1 lds
    ds_write_b128 v32, a[128:131] offset:32768
    s_add_u32 m0, s81, 0
    ds_write_b128 v32, a[132:135] offset:36864
    buffer_load_dwordx4 v4, s[36:39], s76 offen offset:2048 sc1 lds
    ds_write_b128 v32, a[136:139] offset:40960
    v_exp_f32 v150, v150
    v_exp_f32 v151, v151
    v_exp_f32 v152, v152
    v_exp_f32 v153, v153
    v_exp_f32 v154, v154
    s_waitcnt lgkmcnt(8)
    v_mfma_f32_32x32x16_bf16 v[128:143], v[160:163], v[16:19], v[232:247]
    v_exp_f32 v155, v155
    ds_read_b128 v[196:199], v251 offset:24768
    ds_read_b128 v[200:203], v250 offset:26816
    ds_read_b128 v[204:207], v250 offset:27856
    v_exp_f32 v156, v156
    s_add_u32 m0, s81, 16
    v_exp_f32 v157, v157
    buffer_load_dwordx4 v4, s[36:39], s76 offen offset:3072 sc1 lds
    s_add_u32 m0, s81, 4128
    ds_write_b128 v32, a[140:143] offset:45056
    buffer_load_dwordx4 v4, s[36:39], s77 offen offset:0 sc1 lds
    buffer_load_dwordx4 v4, s[36:39], s77 offen offset:1024 sc1 lds
    ds_write_b128 v32, a[144:147] offset:49152
    v_exp_f32 v158, v158
    v_exp_f32 v159, v159
    v_cvt_pk_bf16_f32 v144, v144, v145
    s_waitcnt lgkmcnt(10)
    v_mfma_f32_32x32x16_bf16 v[64:79], v[184:187], v[20:23], 0
    v_cvt_pk_bf16_f32 v145, v146, v147
    v_cvt_pk_bf16_f32 v146, v148, v149
    v_cvt_pk_bf16_f32 v147, v150, v151
    v_cvt_pk_bf16_f32 v148, v152, v153
    s_add_u32 m0, s81, 4128
    v_cvt_pk_bf16_f32 v149, v154, v155
    buffer_load_dwordx4 v4, s[36:39], s77 offen offset:2048 sc1 lds
    s_add_u32 m0, s81, 4144
    ds_write_b128 v32, a[148:151] offset:53248
    buffer_load_dwordx4 v4, s[36:39], s77 offen offset:3072 sc1 lds
    ds_write_b128 v32, a[152:155] offset:57344
    v_cvt_pk_bf16_f32 v150, v156, v157
    v_cvt_pk_bf16_f32 v151, v158, v159
    v_exp_f32 v128, v128
    v_exp_f32 v129, v129
    v_mfma_f32_32x32x16_bf16 v[112:127], v[176:179], v[144:147], 0
    v_exp_f32 v130, v130
    v_exp_f32 v131, v131
    ds_write_b128 v32, a[156:159] offset:61440
    s_add_u32 s83, s40, 0
    buffer_load_dwordx4 a[224:227], v4, s[36:39], s83 offen offset:0
    v_exp_f32 v132, v132
    v_exp_f32 v133, v133
    v_exp_f32 v134, v134
    v_exp_f32 v135, v135
    v_mfma_f32_32x32x16_bf16 v[112:127], v[180:183], v[148:151], v[112:127]
    v_exp_f32 v136, v136
    v_exp_f32 v137, v137
    ds_write_b128 v33, a[160:163] offset:0
    ds_write_b128 v33, a[164:167] offset:4096
    buffer_load_dwordx4 a[228:231], v4, s[36:39], s83 offen offset:1024
    v_exp_f32 v138, v138
    v_exp_f32 v139, v139
    v_exp_f32 v140, v140
    v_exp_f32 v141, v141
    s_waitcnt lgkmcnt(9)
    v_mfma_f32_32x32x16_bf16 v[80:95], v[196:199], v[20:23], 0
    v_exp_f32 v142, v142
    v_exp_f32 v143, v143
    ds_write_b128 v33, a[168:171] offset:8192
    buffer_load_dwordx4 a[232:235], v4, s[36:39], s83 offen offset:2048
    v_cvt_pk_bf16_f32 v128, v128, v129
    v_cvt_pk_bf16_f32 v129, v130, v131
    v_cvt_pk_bf16_f32 v130, v132, v133
    v_cvt_pk_bf16_f32 v131, v134, v135
    v_cvt_pk_bf16_f32 v132, v136, v137
    ds_write_b128 v33, a[172:175] offset:12288
    buffer_load_dwordx4 a[236:239], v4, s[36:39], s83 offen offset:3072
    v_cvt_pk_bf16_f32 v133, v138, v139
    v_cvt_pk_bf16_f32 v134, v140, v141
    v_cvt_pk_bf16_f32 v135, v142, v143
    v_exp_f32 v64, v64
    v_exp_f32 v65, v65
    v_mfma_f32_32x32x16_bf16 v[96:111], v[164:167], v[128:131], 0
    v_exp_f32 v66, v66
    v_exp_f32 v67, v67
    ds_write_b128 v33, a[176:179] offset:16384
    s_add_u32 s83, s40, 4096
    buffer_load_dwordx4 a[240:243], v4, s[36:39], s83 offen offset:0
    v_exp_f32 v68, v68
    v_exp_f32 v69, v69
    v_exp_f32 v70, v70
    v_exp_f32 v71, v71
    v_mfma_f32_32x32x16_bf16 v[96:111], v[168:171], v[132:135], v[96:111]
    v_exp_f32 v72, v72
    v_exp_f32 v73, v73
    ds_write_b128 v33, a[180:183] offset:20480
    buffer_load_dwordx4 a[244:247], v4, s[36:39], s83 offen offset:1024
    v_exp_f32 v74, v74
    v_exp_f32 v75, v75
    v_exp_f32 v76, v76
    v_exp_f32 v77, v77
    v_exp_f32 v78, v78
    v_exp_f32 v79, v79
    ds_write_b128 v33, a[184:187] offset:24576
    buffer_load_dwordx4 a[248:251], v4, s[36:39], s83 offen offset:2048
    v_cvt_pk_bf16_f32 v64, v64, v65
    v_cvt_pk_bf16_f32 v65, v66, v67
    v_cvt_pk_bf16_f32 v66, v68, v69
    v_cvt_pk_bf16_f32 v67, v70, v71
    v_cvt_pk_bf16_f32 v68, v72, v73
    ds_write_b128 v33, a[188:191] offset:28672
    buffer_load_dwordx4 a[252:255], v4, s[36:39], s83 offen offset:3072
    v_cvt_pk_bf16_f32 v69, v74, v75
    v_cvt_pk_bf16_f32 v70, v76, v77
    v_cvt_pk_bf16_f32 v71, v78, v79
L_qxd_159:
    v_add_u32 v27, s81, v4
    s_waitcnt vmcnt(8)
    ds_read_b32 v40, v27 offset:0
    ds_read_b32 v41, v27 offset:1024
    ds_read_b32 v42, v27 offset:2048
    ds_read_b32 v43, v27 offset:3088
    ds_read_b32 v44, v27 offset:4128
    ds_read_b32 v45, v27 offset:5152
    ds_read_b32 v46, v27 offset:6176
    ds_read_b32 v47, v27 offset:7216
L_nbw_160:
    v_exp_f32 v80, v80
    v_mfma_f32_32x32x16_bf16 v[112:127], v[188:191], v[64:67], v[112:127]
    v_exp_f32 v81, v81
    v_exp_f32 v82, v82
    v_exp_f32 v83, v83
    s_waitcnt lgkmcnt(0)
    v_xor_b32 v14, s27, v40
    v_bitop3_b32 v14, v14, v41, s27 bitop3:0xf6
    v_bitop3_b32 v14, v14, v42, s27 bitop3:0xf6
    v_bitop3_b32 v14, v14, v43, s27 bitop3:0xf6
    v_bitop3_b32 v14, v14, v44, s27 bitop3:0xf6
    v_bitop3_b32 v14, v14, v45, s27 bitop3:0xf6
    v_bitop3_b32 v14, v14, v46, s27 bitop3:0xf6
    v_bitop3_b32 v14, v14, v47, s27 bitop3:0xf6
    v_and_b32 v14, 0x10000, v14
    v_cmp_ne_u32 vcc, 0, v14
    s_and_b64 vcc, vcc, s[44:45]
    s_cbranch_vccnz L_slow_162
L_back_163:
L_nbw_161:
    s_barrier
    ds_read_b128 v[208:211], v248 offset:28896
    ds_read_b128 v[212:215], v249 offset:30944
    ds_read_b128 v[216:219], v249 offset:31984
    ds_read_b128 v[220:223], v251 offset:20640
    ds_read_b128 v[224:227], v250 offset:22688
    ds_read_b128 v[228:231], v250 offset:23728
    v_exp_f32 v84, v84
    v_exp_f32 v85, v85
    ds_write_b128 v32, a[192:195] offset:0
    s_add_u32 s83, s41, 0
    buffer_load_dwordx4 a[128:131], v4, s[36:39], s83 offen offset:0
    v_exp_f32 v86, v86
    v_exp_f32 v87, v87
    v_mfma_f32_32x32x16_bf16 v[112:127], v[192:195], v[68:71], v[112:127]
    v_exp_f32 v88, v88
    v_exp_f32 v89, v89
    v_exp_f32 v90, v90
    v_exp_f32 v91, v91
    v_exp_f32 v92, v92
    v_exp_f32 v93, v93
    s_waitcnt lgkmcnt(6)
    v_mfma_f32_32x32x16_bf16 v[128:143], v[208:211], v[16:19], 0
    v_exp_f32 v94, v94
    ds_read_b128 v[160:163], v248 offset:24768
    ds_read_b128 v[164:167], v249 offset:26816
    ds_read_b128 v[168:171], v249 offset:27856
    v_exp_f32 v95, v95
    v_cvt_pk_bf16_f32 v80, v80, v81
    ds_write_b128 v32, a[196:199] offset:4096
    buffer_load_dwordx4 a[132:135], v4, s[36:39], s83 offen offset:1024
    v_cvt_pk_bf16_f32 v81, v82, v83
    v_cvt_pk_bf16_f32 v82, v84, v85
    v_cvt_pk_bf16_f32 v83, v86, v87
    s_waitcnt lgkmcnt(7)
    v_mfma_f32_32x32x16_bf16 v[144:159], v[220:223], v[20:23], 0
    v_cvt_pk_bf16_f32 v84, v88, v89
    v_cvt_pk_bf16_f32 v85, v90, v91
    v_cvt_pk_bf16_f32 v86, v92, v93
    v_cvt_pk_bf16_f32 v87, v94, v95
    ds_read_b128 v[172:175], v251 offset:16512
    ds_read_b128 v[176:179], v250 offset:18560
    ds_read_b128 v[180:183], v250 offset:19600
    v_exp_f32 v128, v128
    v_exp_f32 v129, v129
    v_mfma_f32_32x32x16_bf16 v[112:127], v[200:203], v[80:83], v[112:127]
    v_exp_f32 v130, v130
    v_exp_f32 v131, v131
    buffer_load_dwordx4 a[136:139], v4, s[36:39], s83 offen offset:2048
    v_exp_f32 v132, v132
    v_exp_f32 v133, v133
    v_exp_f32 v134, v134
    v_exp_f32 v135, v135
    v_mfma_f32_32x32x16_bf16 v[112:127], v[204:207], v[84:87], v[112:127]
    v_exp_f32 v136, v136
    v_exp_f32 v137, v137
    ds_write_b128 v32, a[200:203] offset:8192
    v_exp_f32 v138, v138
    v_exp_f32 v139, v139
    v_exp_f32 v140, v140
    v_exp_f32 v141, v141
    s_waitcnt lgkmcnt(7)
    v_mfma_f32_32x32x16_bf16 v[64:79], v[160:163], v[16:19], 0
    v_exp_f32 v142, v142
    v_exp_f32 v143, v143
    buffer_load_dwordx4 a[140:143], v4, s[36:39], s83 offen offset:3072
    v_cvt_pk_bf16_f32 v128, v128, v129
    v_cvt_pk_bf16_f32 v129, v130, v131
    v_cvt_pk_bf16_f32 v130, v132, v133
    v_cvt_pk_bf16_f32 v131, v134, v135
    v_cvt_pk_bf16_f32 v132, v136, v137
    ds_write_b128 v32, a[204:207] offset:12288
    v_cvt_pk_bf16_f32 v133, v138, v139
    v_cvt_pk_bf16_f32 v134, v140, v141
    v_cvt_pk_bf16_f32 v135, v142, v143
    ds_read_b128 v[184:187], v248 offset:20640
    ds_read_b128 v[188:191], v249 offset:22688
    ds_read_b128 v[192:195], v249 offset:23728
    v_exp_f32 v144, v144
    v_exp_f32 v145, v145
    v_mfma_f32_32x32x16_bf16 v[96:111], v[212:215], v[128:131], v[96:111]
    v_exp_f32 v146, v146
    v_exp_f32 v147, v147
    s_add_u32 s83, s41, 4096
    buffer_load_dwordx4 a[144:147], v4, s[36:39], s83 offen offset:0
    v_exp_f32 v148, v148
    v_exp_f32 v149, v149
    v_exp_f32 v150, v150
    v_exp_f32 v151, v151
    v_mfma_f32_32x32x16_bf16 v[96:111], v[216:219], v[132:135], v[96:111]
    v_exp_f32 v152, v152
    v_exp_f32 v153, v153
    v_exp_f32 v154, v154
    v_exp_f32 v155, v155
    v_exp_f32 v156, v156
    v_exp_f32 v157, v157
    s_waitcnt lgkmcnt(7)
    v_mfma_f32_32x32x16_bf16 v[80:95], v[172:175], v[20:23], 0
    v_exp_f32 v158, v158
    v_exp_f32 v159, v159
    ds_write_b128 v32, a[208:211] offset:16384
    buffer_load_dwordx4 a[148:151], v4, s[36:39], s83 offen offset:1024
    v_cvt_pk_bf16_f32 v144, v144, v145
    v_cvt_pk_bf16_f32 v145, v146, v147
    v_cvt_pk_bf16_f32 v146, v148, v149
    v_cvt_pk_bf16_f32 v147, v150, v151
    v_cvt_pk_bf16_f32 v148, v152, v153
    v_cvt_pk_bf16_f32 v149, v154, v155
    v_cvt_pk_bf16_f32 v150, v156, v157
    v_cvt_pk_bf16_f32 v151, v158, v159
    v_lshlrev_b32 v14, 2, v3
    v_sub_u32 v14, v14, v2
    v_lshlrev_b32 v14, 2, v14
    v_add_u32 v14, 60288, v14
    ds_read2_b32 v[232:233], v14 offset0:0 offset1:1
    ds_read2_b32 v[234:235], v14 offset0:2 offset1:3
    ds_read2_b32 v[236:237], v14 offset0:8 offset1:9
    ds_read2_b32 v[238:239], v14 offset0:10 offset1:11
    ds_read2_b32 v[240:241], v14 offset0:16 offset1:17
    ds_read2_b32 v[242:243], v14 offset0:18 offset1:19
    ds_read2_b32 v[244:245], v14 offset0:24 offset1:25
    ds_read2_b32 v[246:247], v14 offset0:26 offset1:27
    ds_read_b128 v[196:199], v251 offset:12384
    ds_read_b128 v[200:203], v250 offset:14432
    ds_read_b128 v[204:207], v250 offset:15472
    v_exp_f32 v64, v64
    v_exp_f32 v65, v65
    v_mfma_f32_32x32x16_bf16 v[112:127], v[224:227], v[144:147], v[112:127]
    v_exp_f32 v66, v66
    v_exp_f32 v67, v67
    ds_write_b128 v32, a[212:215] offset:20480
    buffer_load_dwordx4 a[152:155], v4, s[36:39], s83 offen offset:2048
    v_exp_f32 v68, v68
    v_exp_f32 v69, v69
    v_exp_f32 v70, v70
    v_exp_f32 v71, v71
    v_mfma_f32_32x32x16_bf16 v[112:127], v[228:231], v[148:151], v[112:127]
    v_exp_f32 v72, v72
    v_exp_f32 v73, v73
    v_exp_f32 v74, v74
    v_exp_f32 v75, v75
    v_exp_f32 v76, v76
    v_exp_f32 v77, v77
    s_waitcnt lgkmcnt(15)
    v_mfma_f32_32x32x16_bf16 v[128:143], v[184:187], v[16:19], 0
    v_exp_f32 v78, v78
    v_exp_f32 v79, v79
    buffer_load_dwordx4 a[156:159], v4, s[36:39], s83 offen offset:3072
    v_cvt_pk_bf16_f32 v64, v64, v65
    v_cvt_pk_bf16_f32 v65, v66, v67
    v_cvt_pk_bf16_f32 v66, v68, v69
    v_cvt_pk_bf16_f32 v67, v70, v71
    v_cvt_pk_bf16_f32 v68, v72, v73
    ds_write_b128 v32, a[216:219] offset:24576
    v_cvt_pk_bf16_f32 v69, v74, v75
    v_cvt_pk_bf16_f32 v70, v76, v77
    v_cvt_pk_bf16_f32 v71, v78, v79
    ds_read_b128 v[208:211], v248 offset:16512
    ds_read_b128 v[212:215], v249 offset:18560
    ds_read_b128 v[216:219], v249 offset:19600
    v_exp_f32 v80, v80
    v_exp_f32 v81, v81
    v_mfma_f32_32x32x16_bf16 v[96:111], v[164:167], v[64:67], v[96:111]
    v_exp_f32 v82, v82
    v_exp_f32 v83, v83
    s_add_u32 s83, s42, 0
    buffer_load_dwordx4 a[160:163], v4, s[36:39], s83 offen offset:0
    v_exp_f32 v84, v84
    v_exp_f32 v85, v85
    v_exp_f32 v86, v86
    v_exp_f32 v87, v87
    v_mfma_f32_32x32x16_bf16 v[96:111], v[168:171], v[68:71], v[96:111]
    v_exp_f32 v88, v88
    v_exp_f32 v89, v89
    ds_write_b128 v32, a[220:223] offset:28672
    v_exp_f32 v90, v90
    v_exp_f32 v91, v91
    v_exp_f32 v92, v92
    v_exp_f32 v93, v93
    s_waitcnt lgkmcnt(8)
    v_mfma_f32_32x32x16_bf16 v[144:159], v[196:199], v[20:23], 0
    v_exp_f32 v94, v94
    v_exp_f32 v95, v95
    buffer_load_dwordx4 a[164:167], v4, s[36:39], s83 offen offset:1024
    v_cvt_pk_bf16_f32 v80, v80, v81
    v_cvt_pk_bf16_f32 v81, v82, v83
    v_cvt_pk_bf16_f32 v82, v84, v85
    v_cvt_pk_bf16_f32 v83, v86, v87
    v_cvt_pk_bf16_f32 v84, v88, v89
    v_cvt_pk_bf16_f32 v85, v90, v91
    v_cvt_pk_bf16_f32 v86, v92, v93
    v_cvt_pk_bf16_f32 v87, v94, v95
    ds_read_b128 v[220:223], v251 offset:8256
    ds_read_b128 v[224:227], v250 offset:10304
    ds_read_b128 v[228:231], v250 offset:11344
    v_exp_f32 v128, v128
    v_exp_f32 v129, v129
    v_mfma_f32_32x32x16_bf16 v[112:127], v[176:179], v[80:83], v[112:127]
    v_exp_f32 v130, v130
    v_exp_f32 v131, v131
    buffer_load_dwordx4 a[168:171], v4, s[36:39], s83 offen offset:2048
    v_exp_f32 v132, v132
    v_exp_f32 v133, v133
    v_exp_f32 v134, v134
    v_exp_f32 v135, v135
    v_mfma_f32_32x32x16_bf16 v[112:127], v[180:183], v[84:87], v[112:127]
    v_exp_f32 v136, v136
    v_exp_f32 v137, v137
    v_exp_f32 v138, v138
    v_exp_f32 v139, v139
    v_exp_f32 v140, v140
    v_exp_f32 v141, v141
    s_waitcnt lgkmcnt(6)
    v_mfma_f32_32x32x16_bf16 v[64:79], v[208:211], v[16:19], 0
    v_exp_f32 v142, v142
    v_exp_f32 v143, v143
    buffer_load_dwordx4 a[172:175], v4, s[36:39], s83 offen offset:3072
    v_cvt_pk_bf16_f32 v128, v128, v129
    v_cvt_pk_bf16_f32 v129, v130, v131
    v_cvt_pk_bf16_f32 v130, v132, v133
    v_cvt_pk_bf16_f32 v131, v134, v135
    v_cvt_pk_bf16_f32 v132, v136, v137
    v_cvt_pk_bf16_f32 v133, v138, v139
    v_cvt_pk_bf16_f32 v134, v140, v141
    v_cvt_pk_bf16_f32 v135, v142, v143
    ds_read_b128 v[160:163], v248 offset:12384
    ds_read_b128 v[164:167], v249 offset:14432
    ds_read_b128 v[168:171], v249 offset:15472
    v_exp_f32 v144, v144
    v_exp_f32 v145, v145
    v_mfma_f32_32x32x16_bf16 v[96:111], v[188:191], v[128:131], v[96:111]
    v_exp_f32 v146, v146
    v_exp_f32 v147, v147
    v_exp_f32 v148, v148
    v_exp_f32 v149, v149
    v_exp_f32 v150, v150
    v_exp_f32 v151, v151
    v_mfma_f32_32x32x16_bf16 v[96:111], v[192:195], v[132:135], v[96:111]
    v_exp_f32 v152, v152
    v_exp_f32 v153, v153
    s_add_u32 s83, s42, 4096
    buffer_load_dwordx4 a[176:179], v4, s[36:39], s83 offen offset:0
    v_exp_f32 v154, v154
    v_exp_f32 v155, v155
    v_exp_f32 v156, v156
    v_exp_f32 v157, v157
    s_waitcnt lgkmcnt(5)
    v_mfma_f32_32x32x16_bf16 v[80:95], v[220:223], v[20:23], 0
    v_exp_f32 v158, v158
    v_exp_f32 v159, v159
    v_cvt_pk_bf16_f32 v144, v144, v145
    v_cvt_pk_bf16_f32 v145, v146, v147
    v_cvt_pk_bf16_f32 v146, v148, v149
    v_cvt_pk_bf16_f32 v147, v150, v151
    v_cvt_pk_bf16_f32 v148, v152, v153
    buffer_load_dwordx4 a[180:183], v4, s[36:39], s83 offen offset:1024
    v_cvt_pk_bf16_f32 v149, v154, v155
    v_cvt_pk_bf16_f32 v150, v156, v157
    v_cvt_pk_bf16_f32 v151, v158, v159
    ds_read_b128 v[172:175], v251 offset:4128
    ds_read_b128 v[176:179], v250 offset:6176
    ds_read_b128 v[180:183], v250 offset:7216
    v_exp_f32 v64, v64
    v_exp_f32 v65, v65
    v_mfma_f32_32x32x16_bf16 v[112:127], v[200:203], v[144:147], v[112:127]
    v_exp_f32 v66, v66
    v_exp_f32 v67, v67
    v_exp_f32 v68, v68
    v_exp_f32 v69, v69
    v_exp_f32 v70, v70
    v_exp_f32 v71, v71
    v_mfma_f32_32x32x16_bf16 v[112:127], v[204:207], v[148:151], v[112:127]
    v_exp_f32 v72, v72
    v_exp_f32 v73, v73
    buffer_load_dwordx4 a[184:187], v4, s[36:39], s83 offen offset:2048
    v_exp_f32 v74, v74
    v_exp_f32 v75, v75
    v_exp_f32 v76, v76
    v_exp_f32 v77, v77
    s_waitcnt lgkmcnt(5)
    v_mfma_f32_32x32x16_bf16 v[128:143], v[160:163], v[16:19], 0
    v_exp_f32 v78, v78
    v_exp_f32 v79, v79
    v_cvt_pk_bf16_f32 v64, v64, v65
    v_cvt_pk_bf16_f32 v65, v66, v67
    v_cvt_pk_bf16_f32 v66, v68, v69
    v_cvt_pk_bf16_f32 v67, v70, v71
    v_cvt_pk_bf16_f32 v68, v72, v73
    buffer_load_dwordx4 a[188:191], v4, s[36:39], s83 offen offset:3072
    v_cvt_pk_bf16_f32 v69, v74, v75
    v_cvt_pk_bf16_f32 v70, v76, v77
    v_cvt_pk_bf16_f32 v71, v78, v79
    ds_read_b128 v[184:187], v248 offset:8256
    ds_read_b128 v[188:191], v249 offset:10304
    ds_read_b128 v[192:195], v249 offset:11344
    v_exp_f32 v80, v80
    v_exp_f32 v81, v81
    v_mfma_f32_32x32x16_bf16 v[96:111], v[212:215], v[64:67], v[96:111]
    v_exp_f32 v82, v82
    v_exp_f32 v83, v83
    v_exp_f32 v84, v84
    v_exp_f32 v85, v85
    v_exp_f32 v86, v86
    v_exp_f32 v87, v87
    v_mfma_f32_32x32x16_bf16 v[96:111], v[216:219], v[68:71], v[96:111]
    v_exp_f32 v88, v88
    v_exp_f32 v89, v89
    s_add_u32 s83, s43, 0
    buffer_load_dwordx4 a[192:195], v4, s[36:39], s83 offen offset:0
    v_exp_f32 v90, v90
    v_exp_f32 v91, v91
    v_exp_f32 v92, v92
    v_exp_f32 v93, v93
    s_waitcnt lgkmcnt(5)
    v_mfma_f32_32x32x16_bf16 v[144:159], v[172:175], v[20:23], 0
    v_exp_f32 v94, v94
    v_exp_f32 v95, v95
    v_cvt_pk_bf16_f32 v80, v80, v81
    v_cvt_pk_bf16_f32 v81, v82, v83
    v_cvt_pk_bf16_f32 v82, v84, v85
    v_cvt_pk_bf16_f32 v83, v86, v87
    v_cvt_pk_bf16_f32 v84, v88, v89
    buffer_load_dwordx4 a[196:199], v4, s[36:39], s83 offen offset:1024
    v_cvt_pk_bf16_f32 v85, v90, v91
    v_cvt_pk_bf16_f32 v86, v92, v93
    v_cvt_pk_bf16_f32 v87, v94, v95
    ds_read_b128 v[196:199], v248 offset:4128
    ds_read_b128 v[200:203], v249 offset:6176
    ds_read_b128 v[204:207], v249 offset:7216
    v_exp_f32 v128, v128
    v_exp_f32 v129, v129
    v_mfma_f32_32x32x16_bf16 v[112:127], v[224:227], v[80:83], v[112:127]
    v_exp_f32 v130, v130
    v_exp_f32 v131, v131
    v_exp_f32 v132, v132
    v_exp_f32 v133, v133
    v_exp_f32 v134, v134
    v_exp_f32 v135, v135
    v_mfma_f32_32x32x16_bf16 v[112:127], v[228:231], v[84:87], v[112:127]
    v_exp_f32 v136, v136
    v_exp_f32 v137, v137
    buffer_load_dwordx4 a[200:203], v4, s[36:39], s83 offen offset:2048
    v_exp_f32 v138, v138
    v_exp_f32 v139, v139
    v_exp_f32 v140, v140
    v_exp_f32 v141, v141
    s_waitcnt lgkmcnt(5)
    v_mfma_f32_32x32x16_bf16 v[64:79], v[184:187], v[16:19], 0
    v_exp_f32 v142, v142
    v_exp_f32 v143, v143
    v_cvt_pk_bf16_f32 v128, v128, v129
    v_cvt_pk_bf16_f32 v129, v130, v131
    v_cvt_pk_bf16_f32 v130, v132, v133
    v_cvt_pk_bf16_f32 v131, v134, v135
    v_cvt_pk_bf16_f32 v132, v136, v137
    buffer_load_dwordx4 a[204:207], v4, s[36:39], s83 offen offset:3072
    v_cvt_pk_bf16_f32 v133, v138, v139
    v_cvt_pk_bf16_f32 v134, v140, v141
    v_cvt_pk_bf16_f32 v135, v142, v143
    ds_read_b128 v[208:211], v251 offset:0
    ds_read_b128 v[212:215], v250 offset:2048
    ds_read_b128 v[216:219], v250 offset:3088
    v_exp_f32 v144, v144
    v_exp_f32 v145, v145
    v_mfma_f32_32x32x16_bf16 v[96:111], v[164:167], v[128:131], v[96:111]
    v_exp_f32 v146, v146
    v_exp_f32 v147, v147
    v_exp_f32 v148, v148
    v_exp_f32 v149, v149
    v_exp_f32 v150, v150
    v_exp_f32 v151, v151
    v_mfma_f32_32x32x16_bf16 v[96:111], v[168:171], v[132:135], v[96:111]
    v_exp_f32 v152, v152
    v_exp_f32 v153, v153
    s_add_u32 s83, s43, 4096
    buffer_load_dwordx4 a[208:211], v4, s[36:39], s83 offen offset:0
    v_exp_f32 v154, v154
    v_exp_f32 v155, v155
    v_exp_f32 v156, v156
    v_exp_f32 v157, v157
    s_waitcnt lgkmcnt(5)
    v_mfma_f32_32x32x16_bf16 v[80:95], v[196:199], v[16:19], 0
    v_exp_f32 v158, v158
    v_exp_f32 v159, v159
    v_cvt_pk_bf16_f32 v144, v144, v145
    v_cvt_pk_bf16_f32 v145, v146, v147
    v_cvt_pk_bf16_f32 v146, v148, v149
    v_cvt_pk_bf16_f32 v147, v150, v151
    v_cvt_pk_bf16_f32 v148, v152, v153
    buffer_load_dwordx4 a[212:215], v4, s[36:39], s83 offen offset:1024
    v_cvt_pk_bf16_f32 v149, v154, v155
    v_cvt_pk_bf16_f32 v150, v156, v157
    v_cvt_pk_bf16_f32 v151, v158, v159
    ds_read_b128 v[220:223], v248 offset:0
    ds_read_b128 v[224:227], v249 offset:2048
    ds_read_b128 v[228:231], v249 offset:3088
    v_exp_f32 v64, v64
    v_exp_f32 v65, v65
    v_mfma_f32_32x32x16_bf16 v[112:127], v[176:179], v[144:147], v[112:127]
    v_exp_f32 v66, v66
    v_exp_f32 v67, v67
    v_exp_f32 v68, v68
    v_exp_f32 v69, v69
    v_exp_f32 v70, v70
    v_exp_f32 v71, v71
    v_mfma_f32_32x32x16_bf16 v[112:127], v[180:183], v[148:151], v[112:127]
    v_exp_f32 v72, v72
    v_exp_f32 v73, v73
    buffer_load_dwordx4 a[216:219], v4, s[36:39], s83 offen offset:2048
    v_exp_f32 v74, v74
    v_exp_f32 v75, v75
    v_exp_f32 v76, v76
    v_exp_f32 v77, v77
    s_waitcnt lgkmcnt(5)
    v_mfma_f32_32x32x16_bf16 v[128:143], v[208:211], v[20:23], v[232:247]
    v_exp_f32 v78, v78
    v_exp_f32 v79, v79
    v_cvt_pk_bf16_f32 v64, v64, v65
    v_cvt_pk_bf16_f32 v65, v66, v67
    v_cvt_pk_bf16_f32 v66, v68, v69
    v_cvt_pk_bf16_f32 v67, v70, v71
    v_cvt_pk_bf16_f32 v68, v72, v73
    buffer_load_dwordx4 a[220:223], v4, s[36:39], s83 offen offset:3072
    v_cvt_pk_bf16_f32 v69, v74, v75
    v_cvt_pk_bf16_f32 v70, v76, v77
    v_cvt_pk_bf16_f32 v71, v78, v79
    v_exp_f32 v80, v80
    v_exp_f32 v81, v81
    v_mfma_f32_32x32x16_bf16 v[96:111], v[188:191], v[64:67], v[96:111]
    v_exp_f32 v82, v82
    v_exp_f32 v83, v83
    v_exp_f32 v84, v84
    v_exp_f32 v85, v85
    v_exp_f32 v86, v86
    v_exp_f32 v87, v87
    v_mfma_f32_32x32x16_bf16 v[96:111], v[192:195], v[68:71], v[96:111]
    v_exp_f32 v88, v88
    v_exp_f32 v89, v89
    v_exp_f32 v90, v90
    v_exp_f32 v91, v91
    v_exp_f32 v92, v92
    v_exp_f32 v93, v93
    s_waitcnt lgkmcnt(2)
    v_mfma_f32_32x32x16_bf16 v[144:159], v[220:223], v[16:19], v[232:247]
    v_exp_f32 v94, v94
    v_exp_f32 v95, v95
    v_cvt_pk_bf16_f32 v80, v80, v81
    v_cvt_pk_bf16_f32 v81, v82, v83
    v_cvt_pk_bf16_f32 v82, v84, v85
    v_cvt_pk_bf16_f32 v83, v86, v87
    v_cvt_pk_bf16_f32 v84, v88, v89
    v_cvt_pk_bf16_f32 v85, v90, v91
    v_cvt_pk_bf16_f32 v86, v92, v93
    v_cvt_pk_bf16_f32 v87, v94, v95
    v_exp_f32 v128, v128
    v_exp_f32 v129, v129
    v_mfma_f32_32x32x16_bf16 v[96:111], v[200:203], v[80:83], v[96:111]
    v_exp_f32 v130, v130
    v_exp_f32 v131, v131
    v_exp_f32 v132, v132
    v_exp_f32 v133, v133
    v_exp_f32 v134, v134
    v_exp_f32 v135, v135
    v_mfma_f32_32x32x16_bf16 v[96:111], v[204:207], v[84:87], v[96:111]
    v_exp_f32 v136, v136
    v_exp_f32 v137, v137
    v_exp_f32 v138, v138
    v_exp_f32 v139, v139
    v_exp_f32 v140, v140
    v_exp_f32 v141, v141
    v_exp_f32 v142, v142
    v_exp_f32 v143, v143
    v_cvt_pk_bf16_f32 v128, v128, v129
    v_cvt_pk_bf16_f32 v129, v130, v131
    v_cvt_pk_bf16_f32 v130, v132, v133
    v_cvt_pk_bf16_f32 v131, v134, v135
    v_cvt_pk_bf16_f32 v132, v136, v137
    v_cvt_pk_bf16_f32 v133, v138, v139
    v_cvt_pk_bf16_f32 v134, v140, v141
    v_cvt_pk_bf16_f32 v135, v142, v143
    v_exp_f32 v144, v144
    v_exp_f32 v145, v145
    v_mfma_f32_32x32x16_bf16 v[112:127], v[212:215], v[128:131], v[112:127]
    v_exp_f32 v146, v146
    v_exp_f32 v147, v147
    v_exp_f32 v148, v148
    v_exp_f32 v149, v149
    v_exp_f32 v150, v150
    v_exp_f32 v151, v151
    v_mfma_f32_32x32x16_bf16 v[112:127], v[216:219], v[132:135], v[112:127]
    v_exp_f32 v152, v152
    v_exp_f32 v153, v153
    v_exp_f32 v154, v154
    v_exp_f32 v155, v155
    v_exp_f32 v156, v156
    v_exp_f32 v157, v157
    v_exp_f32 v158, v158
    v_exp_f32 v159, v159
    v_cvt_pk_bf16_f32 v144, v144, v145
    v_cvt_pk_bf16_f32 v145, v146, v147
    v_cvt_pk_bf16_f32 v146, v148, v149
    v_cvt_pk_bf16_f32 v147, v150, v151
    v_cvt_pk_bf16_f32 v148, v152, v153
    v_cvt_pk_bf16_f32 v149, v154, v155
    v_cvt_pk_bf16_f32 v150, v156, v157
    v_cvt_pk_bf16_f32 v151, v158, v159
    s_nop 1
    s_waitcnt lgkmcnt(0)
    v_mfma_f32_32x32x16_bf16 v[96:111], v[224:227], v[144:147], v[96:111]
    v_mfma_f32_32x32x16_bf16 v[96:111], v[228:231], v[148:151], v[96:111]
    s_add_u32 s82, s58, s92
    s_add_u32 s83, s58, s94
    v_rcp_f32 v28, v120
    v_mov_b32 v29, 0x10000
    v_mul_f32 v112, v28, v112
    v_mul_f32 v113, v28, v113
    v_mul_f32 v114, v28, v114
    v_mul_f32 v115, v28, v115
    v_mul_f32 v116, v28, v116
    v_mul_f32 v117, v28, v117
    v_mul_f32 v118, v28, v118
    v_mul_f32 v119, v28, v119
    v_add_u32 v113, s75, v113
    v_and_b32 v113, 0xfffe0000, v113
    v_cvt_pk_bf16_f32 v68, v112, v113
    v_cvt_pk_bf16_f32 v69, v114, v115
    v_cvt_pk_bf16_f32 v70, v116, v117
    v_cvt_pk_bf16_f32 v71, v118, v119
    v_bfi_b32 v68, v29, s74, v68
    v_max_f32 v25, v104, v120
    v_min_f32 v26, v104, v120
    v_add_f32 v27, v104, v120
    v_cmp_nle_f32 vcc, v25, s100
    v_cmp_nge_f32 s[68:69], v26, s101
    s_or_b64 vcc, vcc, s[68:69]
    v_cmp_u_f32 s[68:69], v27, v27
    s_or_b64 vcc, vcc, s[68:69]
    s_cbranch_vccnz L_fb_165
L_fbk_166:
    s_cmp_eq_u32 s7, 0
    s_cbranch_scc1 L_stsl_174
    buffer_store_dwordx4 v[68:71], v4, s[36:39], s83 offen
L_stdn_175:
    v_rcp_f32 v28, v104
    v_mov_b32 v29, 0x10000
    v_mul_f32 v96, v28, v96
    v_mul_f32 v97, v28, v97
    v_mul_f32 v98, v28, v98
    v_mul_f32 v99, v28, v99
    v_mul_f32 v100, v28, v100
    v_mul_f32 v101, v28, v101
    v_mul_f32 v102, v28, v102
    v_mul_f32 v103, v28, v103
    v_add_u32 v97, s75, v97
    v_and_b32 v97, 0xfffe0000, v97
    v_cvt_pk_bf16_f32 v64, v96, v97
    v_cvt_pk_bf16_f32 v65, v98, v99
    v_cvt_pk_bf16_f32 v66, v100, v101
    v_cvt_pk_bf16_f32 v67, v102, v103
    v_bfi_b32 v64, v29, s74, v64
    s_cmp_eq_u32 s7, 0
    s_cbranch_scc1 L_stsl_176
    buffer_store_dwordx4 v[64:67], v4, s[36:39], s82 offen
L_stdn_177:
    s_mul_i32 s81, s3, 8256
    s_mov_b32 s76, s63
    s_add_u32 s77, s63, 4096
    s_barrier
    s_lshl_b32 s46, s3, 11
    v_add_u32 v14, s46, v4
    ds_read_b128 v[96:99], v14 offset:49664
    ds_read_b128 v[100:103], v14 offset:50688
    s_mul_i32 s46, s3, 8256
    v_add_u32 v104, s46, v4
    s_add_u32 s46, s3, 1
    s_and_b32 s46, s46, 3
    s_mul_i32 s46, s46, 8256
    v_add_u32 v105, s46, v4
    s_add_u32 s46, s3, 2
    s_and_b32 s46, s46, 3
    s_mul_i32 s46, s46, 8256
    v_add_u32 v106, s46, v4
    s_add_u32 s46, s3, 3
    s_and_b32 s46, s46, 3
    s_mul_i32 s46, s46, 8256
    v_add_u32 v107, s46, v4
    s_waitcnt lgkmcnt(0)
    v_lshlrev_b32 v64, 16, v96
    v_and_b32 v65, 0xffff0000, v96
    v_lshlrev_b32 v66, 16, v97
    v_and_b32 v67, 0xffff0000, v97
    v_lshlrev_b32 v68, 16, v98
    v_and_b32 v69, 0xffff0000, v98
    v_lshlrev_b32 v70, 16, v99
    v_and_b32 v71, 0xffff0000, v99
    v_lshlrev_b32 v72, 16, v100
    v_and_b32 v73, 0xffff0000, v100
    v_lshlrev_b32 v74, 16, v101
    v_and_b32 v75, 0xffff0000, v101
    v_lshlrev_b32 v76, 16, v102
    v_and_b32 v77, 0xffff0000, v102
    v_lshlrev_b32 v78, 16, v103
    s_add_u32 m0, s81, 0
    v_and_b32 v79, 0xffff0000, v103
    buffer_load_dwordx4 v4, s[36:39], s76 offen offset:0 sc1 lds
    buffer_load_dwordx4 v4, s[36:39], s76 offen offset:1024 sc1 lds
    buffer_load_dwordx4 v4, s[36:39], s76 offen offset:2048 sc1 lds
    s_add_u32 m0, s81, 16
    s_nop 0
    buffer_load_dwordx4 v4, s[36:39], s76 offen offset:3072 sc1 lds
    s_add_u32 m0, s81, 4128
    s_nop 0
    buffer_load_dwordx4 v4, s[36:39], s77 offen offset:0 sc1 lds
    buffer_load_dwordx4 v4, s[36:39], s77 offen offset:1024 sc1 lds
    buffer_load_dwordx4 v4, s[36:39], s77 offen offset:2048 sc1 lds
    s_add_u32 m0, s81, 4144
    s_nop 0
    buffer_load_dwordx4 v4, s[36:39], s77 offen offset:3072 sc1 lds
L_trr_179:
L_swr_183:
    s_mov_b32 s52, 0
L_opv_187:
L_ort_189:
    s_waitcnt vmcnt(7)
    ds_read_b128 v[128:131], v104 offset:0
    s_waitcnt vmcnt(6)
    ds_read_b128 v[132:135], v104 offset:1024
    s_waitcnt vmcnt(5)
    ds_read_b128 v[136:139], v104 offset:2048
    s_waitcnt lgkmcnt(2)
    v_mfma_f32_32x32x16_bf16 v[64:79], a[224:227], v[128:131], v[64:79]
    v_xor_b32 v14, s74, v128
    s_waitcnt vmcnt(4)
    ds_read_b128 v[140:143], v104 offset:3088
    s_waitcnt lgkmcnt(2)
    v_mfma_f32_32x32x16_bf16 v[64:79], a[228:231], v[132:135], v[64:79]
    v_bitop3_b32 v14, v14, v132, s74 bitop3:0xf6
    s_waitcnt vmcnt(3)
    ds_read_b128 v[144:147], v104 offset:4128
    s_waitcnt lgkmcnt(2)
    v_mfma_f32_32x32x16_bf16 v[64:79], a[232:235], v[136:139], v[64:79]
    v_bitop3_b32 v14, v14, v136, s74 bitop3:0xf6
    s_waitcnt vmcnt(2)
    ds_read_b128 v[148:151], v104 offset:5152
    s_waitcnt lgkmcnt(2)
    v_mfma_f32_32x32x16_bf16 v[64:79], a[236:239], v[140:143], v[64:79]
    v_bitop3_b32 v14, v14, v140, s74 bitop3:0xf6
    s_waitcnt vmcnt(1)
    ds_read_b128 v[152:155], v104 offset:6176
    s_waitcnt lgkmcnt(2)
    v_mfma_f32_32x32x16_bf16 v[64:79], a[240:243], v[144:147], v[64:79]
    v_bitop3_b32 v14, v14, v144, s74 bitop3:0xf6
    s_waitcnt vmcnt(0)
    ds_read_b128 v[156:159], v104 offset:7216
    s_waitcnt lgkmcnt(2)
    v_bitop3_b32 v14, v14, v148, s74 bitop3:0xf6
    s_waitcnt lgkmcnt(1)
    v_bitop3_b32 v14, v14, v152, s74 bitop3:0xf6
    s_waitcnt lgkmcnt(0)
    v_bitop3_b32 v14, v14, v156, s74 bitop3:0xf6
    v_and_b32 v14, 0x10000, v14
    v_cmp_ne_u32 vcc, 0, v14
    s_and_b64 vcc, vcc, s[44:45]
    s_cbranch_vccnz L_osl_190
    s_barrier
    ds_read_b128 v[160:163], v105 offset:0
    ds_read_b128 v[164:167], v105 offset:1024
    ds_read_b128 v[168:171], v105 offset:2048
    ds_read_b128 v[172:175], v105 offset:3088
    v_mfma_f32_32x32x16_bf16 v[64:79], a[244:247], v[148:151], v[64:79]
    ds_read_b128 v[176:179], v105 offset:4128
    ds_read_b128 v[180:183], v105 offset:5152
    v_mfma_f32_32x32x16_bf16 v[64:79], a[248:251], v[152:155], v[64:79]
    ds_read_b128 v[184:187], v105 offset:6176
    ds_read_b128 v[188:191], v105 offset:7216
    v_mfma_f32_32x32x16_bf16 v[64:79], a[252:255], v[156:159], v[64:79]
    ds_read_b128 v[192:195], v106 offset:0
    ds_read_b128 v[196:199], v106 offset:1024
    s_add_u32 s78, s57, 0
    s_waitcnt lgkmcnt(9)
    v_mfma_f32_32x32x16_bf16 v[64:79], a[128:131], v[160:163], v[64:79]
    ds_read_b128 v[200:203], v106 offset:2048
    ds_read_b128 v[204:207], v106 offset:3088
    s_add_u32 s79, s57, 4096
    s_waitcnt lgkmcnt(10)
    v_mfma_f32_32x32x16_bf16 v[64:79], a[132:135], v[164:167], v[64:79]
    ds_read_b128 v[208:211], v106 offset:4128
    ds_read_b128 v[212:215], v106 offset:5152
    s_add_u32 s80, s57, 8192
    s_waitcnt lgkmcnt(11)
    v_mfma_f32_32x32x16_bf16 v[64:79], a[136:139], v[168:171], v[64:79]
    ds_read_b128 v[216:219], v106 offset:6176
    ds_read_b128 v[220:223], v106 offset:7216
    s_add_u32 s81, s57, 12288
    s_waitcnt lgkmcnt(12)
    v_mfma_f32_32x32x16_bf16 v[64:79], a[140:143], v[172:175], v[64:79]
    ds_read_b128 v[224:227], v107 offset:0
    s_add_u32 s82, s57, 16384
    s_waitcnt lgkmcnt(12)
    v_mfma_f32_32x32x16_bf16 v[64:79], a[144:147], v[176:179], v[64:79]
    ds_read_b128 v[228:231], v107 offset:1024
    s_add_u32 s83, s57, 20480
    s_waitcnt lgkmcnt(12)
    v_mfma_f32_32x32x16_bf16 v[64:79], a[148:151], v[180:183], v[64:79]
    ds_read_b128 v[232:235], v107 offset:2048
    s_add_u32 s64, s57, 24576
    s_waitcnt lgkmcnt(12)
    v_mfma_f32_32x32x16_bf16 v[64:79], a[152:155], v[184:187], v[64:79]
    ds_read_b128 v[236:239], v107 offset:3088
    s_add_u32 s65, s57, 28672
    s_waitcnt lgkmcnt(12)
    v_mfma_f32_32x32x16_bf16 v[64:79], a[156:159], v[188:191], v[64:79]
    ds_read_b128 v[240:243], v107 offset:4128
    v_lshrrev_b32 v108, 2, v1
    s_waitcnt lgkmcnt(12)
    v_mfma_f32_32x32x16_bf16 v[64:79], a[160:163], v[192:195], v[64:79]
    ds_read_b128 v[244:247], v107 offset:5152
    v_lshlrev_b32 v108, 11, v108
    s_waitcnt lgkmcnt(12)
    v_mfma_f32_32x32x16_bf16 v[64:79], a[164:167], v[196:199], v[64:79]
    ds_read_b128 v[248:251], v107 offset:6176
    v_add_u32 v108, 2032, v108
    s_waitcnt lgkmcnt(12)
    v_mfma_f32_32x32x16_bf16 v[64:79], a[168:171], v[200:203], v[64:79]
    ds_read_b128 v[252:255], v107 offset:7216
    s_waitcnt lgkmcnt(12)
    v_mfma_f32_32x32x16_bf16 v[64:79], a[172:175], v[204:207], v[64:79]
    s_waitcnt lgkmcnt(11)
    v_mfma_f32_32x32x16_bf16 v[64:79], a[176:179], v[208:211], v[64:79]
    s_waitcnt lgkmcnt(10)
    v_mfma_f32_32x32x16_bf16 v[64:79], a[180:183], v[212:215], v[64:79]
    s_waitcnt lgkmcnt(9)
    v_mfma_f32_32x32x16_bf16 v[64:79], a[184:187], v[216:219], v[64:79]
    s_waitcnt lgkmcnt(8)
    v_mfma_f32_32x32x16_bf16 v[64:79], a[188:191], v[220:223], v[64:79]
    s_waitcnt lgkmcnt(7)
    v_mfma_f32_32x32x16_bf16 v[64:79], a[192:195], v[224:227], v[64:79]
    s_waitcnt lgkmcnt(6)
    v_mfma_f32_32x32x16_bf16 v[64:79], a[196:199], v[228:231], v[64:79]
    s_waitcnt lgkmcnt(5)
    v_mfma_f32_32x32x16_bf16 v[64:79], a[200:203], v[232:235], v[64:79]
    s_waitcnt lgkmcnt(4)
    v_mfma_f32_32x32x16_bf16 v[64:79], a[204:207], v[236:239], v[64:79]
    s_waitcnt lgkmcnt(3)
    v_mfma_f32_32x32x16_bf16 v[64:79], a[208:211], v[240:243], v[64:79]
    s_waitcnt lgkmcnt(2)
    v_mfma_f32_32x32x16_bf16 v[64:79], a[212:215], v[244:247], v[64:79]
    s_waitcnt lgkmcnt(1)
    v_mfma_f32_32x32x16_bf16 v[64:79], a[216:219], v[248:251], v[64:79]
    s_waitcnt lgkmcnt(0)
    v_mfma_f32_32x32x16_bf16 v[64:79], a[220:223], v[252:255], v[64:79]
L_opD_184:
    s_nop 2
    v_mov_b32 v22, 0x10000
    s_nop 7
    v_add_u32 v104, s75, v65
    v_and_b32 v104, 0xfffe0000, v104
    v_add_u32 v105, s75, v73
    v_and_b32 v105, 0xfffe0000, v105
    v_cvt_pk_bf16_f32 v96, v64, v104
    v_cvt_pk_bf16_f32 v97, v66, v67
    v_cvt_pk_bf16_f32 v98, v68, v69
    v_cvt_pk_bf16_f32 v99, v70, v71
    v_cvt_pk_bf16_f32 v100, v72, v105
    v_cvt_pk_bf16_f32 v101, v74, v75
    v_cvt_pk_bf16_f32 v102, v76, v77
    v_cvt_pk_bf16_f32 v103, v78, v79
    v_bfi_b32 v96, v22, s74, v96
    v_bfi_b32 v100, v22, s74, v100
    s_cmp_eq_u32 s7, 0
    s_cbranch_scc1 L_stsl_192
    buffer_store_dwordx4 v[96:99], v4, s[28:31], s61 offen
    buffer_store_dwordx4 v[100:103], v4, s[28:31], s61 offen offset:1024
L_stdn_193:
    v_cvt_pk_bf16_f32 v104, v64, v65
    v_cvt_pk_bf16_f32 v105, v72, v73
    v_lshlrev_b32 v64, 16, v104
    v_and_b32 v65, 0xffff0000, v104
    v_lshlrev_b32 v66, 16, v97
    v_and_b32 v67, 0xffff0000, v97
    v_lshlrev_b32 v68, 16, v98
    v_and_b32 v69, 0xffff0000, v98
    v_lshlrev_b32 v70, 16, v99
    v_and_b32 v71, 0xffff0000, v99
    v_lshlrev_b32 v72, 16, v105
    v_and_b32 v73, 0xffff0000, v105
    v_lshlrev_b32 v74, 16, v101
    v_and_b32 v75, 0xffff0000, v101
    v_lshlrev_b32 v76, 16, v102
    v_and_b32 v77, 0xffff0000, v102
    v_lshlrev_b32 v78, 16, v103
    v_and_b32 v79, 0xffff0000, v103
    v_add_f32 v20, v64, v65
    v_mul_f32 v21, v64, v64
    v_fmac_f32 v21, v65, v65
    v_add_f32 v20, v20, v66
    v_fmac_f32 v21, v66, v66
    v_add_f32 v20, v20, v67
    v_fmac_f32 v21, v67, v67
    v_add_f32 v20, v20, v68
    v_fmac_f32 v21, v68, v68
    v_add_f32 v20, v20, v69
    v_fmac_f32 v21, v69, v69
    v_add_f32 v20, v20, v70
    v_fmac_f32 v21, v70, v70
    v_add_f32 v20, v20, v71
    v_fmac_f32 v21, v71, v71
    v_add_f32 v20, v20, v72
    v_fmac_f32 v21, v72, v72
    v_add_f32 v20, v20, v73
    v_fmac_f32 v21, v73, v73
    v_add_f32 v20, v20, v74
    v_fmac_f32 v21, v74, v74
    v_add_f32 v20, v20, v75
    v_fmac_f32 v21, v75, v75
    v_add_f32 v20, v20, v76
    v_fmac_f32 v21, v76, v76
    v_add_f32 v20, v20, v77
    v_fmac_f32 v21, v77, v77
    v_add_f32 v20, v20, v78
    v_fmac_f32 v21, v78, v78
    v_add_f32 v20, v20, v79
    v_fmac_f32 v21, v79, v79
    v_lshlrev_b32 v14, 3, v1
    s_lshl_b32 s46, s3, 9
    v_add_u32 v15, s46, v14
    ds_write_b64 v15, v[20:21] offset:61440
    s_waitcnt lgkmcnt(0)
    s_barrier
    ds_read_b64 v[22:23], v14 offset:61440
    ds_read_b64 v[24:25], v14 offset:62464
    ds_read_b64 v[26:27], v14 offset:62976
    s_cmp_lg_u32 s3, 1
    s_cbranch_scc1 L_xs_194
    v_lshlrev_b32 v14, 4, v2
    s_waitcnt lgkmcnt(2)
    v_add_f32 v20, v20, v22
    v_add_f32 v21, v21, v23
    s_waitcnt lgkmcnt(1)
    v_add_f32 v20, v20, v24
    v_add_f32 v21, v21, v25
    s_waitcnt lgkmcnt(0)
    v_add_f32 v20, v20, v26
    v_add_f32 v21, v21, v27
    v_mov_b32 v22, v20
    v_mov_b32 v23, v21
    s_nop 1
    v_permlane32_swap_b32 v20, v22
    v_permlane32_swap_b32 v21, v23
    s_nop 1
    v_add_f32 v20, v20, v22
    v_add_f32 v21, v21, v23
    v_bfi_b32 v20, 1, s6, v20
    s_mov_b64 exec, s[66:67]
    s_cmp_eq_u32 s7, 0
    s_cbranch_scc1 L_stsl_195
    buffer_store_dwordx2 v[20:21], v14, s[36:39], s62 offen
L_stdn_196:
    s_mov_b64 exec, -1
L_xs_194:
    buffer_load_dword v109, v108, s[28:31], s57 offen sc1
    buffer_load_dwordx4 v[128:131], v4, s[28:31], s78 offen offset:0 sc1
    buffer_load_dwordx4 v[132:135], v4, s[28:31], s78 offen offset:1024 sc1
    buffer_load_dwordx4 v[136:139], v4, s[28:31], s78 offen offset:2048 sc1
    buffer_load_dwordx4 v[140:143], v4, s[28:31], s78 offen offset:3072 sc1
    buffer_load_dwordx4 v[144:147], v4, s[28:31], s79 offen offset:0 sc1
    buffer_load_dwordx4 v[148:151], v4, s[28:31], s79 offen offset:1024 sc1
    buffer_load_dwordx4 v[152:155], v4, s[28:31], s79 offen offset:2048 sc1
    buffer_load_dwordx4 v[156:159], v4, s[28:31], s79 offen offset:3072 sc1
    v_mov_b32 v96, v104
    v_mov_b32 v100, v105
    s_lshl_b32 s46, s3, 11
    v_add_u32 v14, s46, v4
    ds_write_b128 v14, v[96:99] offset:49664
    ds_write_b128 v14, v[100:103] offset:50688
    s_add_u32 s6, s6, 1
    s_xor_b32 s59, s59, 4096
    s_xor_b32 s74, s74, 0x10000
    s_xor_b32 s75, s75, 0x10000
    s_lshl_b32 s93, s6, 15
    s_and_b32 s93, s93, 65536
    s_xor_b32 s70, s70, 1792
L_xpb_202:
    v_mov_b32 v60, 0
    v_lshlrev_b32 v15, 3, v2
    v_add_u32 v15, s70, v15
    ds_read_b64_tr_b16 v[24:25], v7 offset:0
    ds_read_b64_tr_b16 v[26:27], v8 offset:0
    ds_read_b64_tr_b16 v[28:29], v9 offset:0
    ds_read_b64_tr_b16 v[30:31], v10 offset:0
    ds_read_b64_tr_b16 v[32:33], v7 offset:1024
    ds_read_b64_tr_b16 v[34:35], v8 offset:1024
    ds_read_b64_tr_b16 v[36:37], v9 offset:1024
    ds_read_b64_tr_b16 v[38:39], v10 offset:1024
    ds_read_b64_tr_b16 v[40:41], v7 offset:2048
    ds_read_b64_tr_b16 v[42:43], v8 offset:2048
    ds_read_b64_tr_b16 v[44:45], v9 offset:2048
    ds_read_b64_tr_b16 v[46:47], v10 offset:2048
    s_waitcnt vmcnt(8)
    v_xor_b32 v61, s75, v109
    v_and_b32 v61, 0x10000, v61
    v_cmp_ne_u32 vcc, 0, v61
    s_and_b64 vcc, vcc, s[44:45]
    s_cbranch_vccnz L_xpf_201
    s_waitcnt vmcnt(7) lgkmcnt(8)
    v_mfma_f32_32x32x16_bf16 v[64:79], v[24:27], v[128:131], 0
    ds_read_b64_tr_b16 v[48:49], v7 offset:3072
    ds_read_b64_tr_b16 v[50:51], v8 offset:3072
    buffer_load_dwordx4 v[160:163], v4, s[28:31], s80 offen offset:0 sc1
    v_bitop3_b32 v60, v60, v128, s75 bitop3:0xf6
    v_mfma_f32_32x32x16_bf16 v[80:95], v[128:131], v[28:31], 0
    ds_read_b64_tr_b16 v[52:53], v9 offset:3072
    ds_read_b64_tr_b16 v[54:55], v10 offset:3072
    s_waitcnt vmcnt(7) lgkmcnt(8)
    v_mfma_f32_32x32x16_bf16 v[64:79], v[32:35], v[132:135], v[64:79]
    ds_read_b64_tr_b16 v[24:25], v7 offset:4096
    ds_read_b64_tr_b16 v[26:27], v8 offset:4096
    buffer_load_dwordx4 v[164:167], v4, s[28:31], s80 offen offset:1024 sc1
    v_bitop3_b32 v60, v60, v132, s75 bitop3:0xf6
    v_mfma_f32_32x32x16_bf16 v[80:95], v[132:135], v[36:39], v[80:95]
    ds_read_b64_tr_b16 v[28:29], v9 offset:4096
    ds_read_b64_tr_b16 v[30:31], v10 offset:4096
    s_waitcnt vmcnt(7) lgkmcnt(8)
    v_mfma_f32_32x32x16_bf16 v[64:79], v[40:43], v[136:139], v[64:79]
    ds_read_b64_tr_b16 v[32:33], v7 offset:5120
    ds_read_b64_tr_b16 v[34:35], v8 offset:5120
    buffer_load_dwordx4 v[168:171], v4, s[28:31], s80 offen offset:2048 sc1
    v_bitop3_b32 v60, v60, v136, s75 bitop3:0xf6
    v_mfma_f32_32x32x16_bf16 v[80:95], v[136:139], v[44:47], v[80:95]
    ds_read_b64_tr_b16 v[36:37], v9 offset:5120
    ds_read_b64_tr_b16 v[38:39], v10 offset:5120
    s_waitcnt vmcnt(7) lgkmcnt(8)
    v_mfma_f32_32x32x16_bf16 v[64:79], v[48:51], v[140:143], v[64:79]
    ds_read_b64_tr_b16 v[40:41], v7 offset:6144
    ds_read_b64_tr_b16 v[42:43], v8 offset:6144
    buffer_load_dwordx4 v[172:175], v4, s[28:31], s80 offen offset:3072 sc1
    v_bitop3_b32 v60, v60, v140, s75 bitop3:0xf6
    v_mfma_f32_32x32x16_bf16 v[80:95], v[140:143], v[52:55], v[80:95]
    ds_read_b64_tr_b16 v[44:45], v9 offset:6144
    ds_read_b64_tr_b16 v[46:47], v10 offset:6144
    s_waitcnt vmcnt(7) lgkmcnt(8)
    v_mfma_f32_32x32x16_bf16 v[64:79], v[24:27], v[144:147], v[64:79]
    ds_read_b64_tr_b16 v[48:49], v7 offset:7168
    ds_read_b64_tr_b16 v[50:51], v8 offset:7168
    buffer_load_dwordx4 v[176:179], v4, s[28:31], s81 offen offset:0 sc1
    v_bitop3_b32 v60, v60, v144, s75 bitop3:0xf6
    v_mfma_f32_32x32x16_bf16 v[80:95], v[144:147], v[28:31], v[80:95]
    ds_read_b64_tr_b16 v[52:53], v9 offset:7168
    ds_read_b64_tr_b16 v[54:55], v10 offset:7168
    s_waitcnt vmcnt(7) lgkmcnt(8)
    v_mfma_f32_32x32x16_bf16 v[64:79], v[32:35], v[148:151], v[64:79]
    ds_read_b64_tr_b16 v[24:25], v7 offset:8192
    ds_read_b64_tr_b16 v[26:27], v8 offset:8192
    buffer_load_dwordx4 v[180:183], v4, s[28:31], s81 offen offset:1024 sc1
    v_bitop3_b32 v60, v60, v148, s75 bitop3:0xf6
    v_mfma_f32_32x32x16_bf16 v[80:95], v[148:151], v[36:39], v[80:95]
    ds_read_b64_tr_b16 v[28:29], v9 offset:8192
    ds_read_b64_tr_b16 v[30:31], v10 offset:8192
    s_waitcnt vmcnt(7) lgkmcnt(8)
    v_mfma_f32_32x32x16_bf16 v[64:79], v[40:43], v[152:155], v[64:79]
    ds_read_b64_tr_b16 v[32:33], v7 offset:9216
    ds_read_b64_tr_b16 v[34:35], v8 offset:9216
    buffer_load_dwordx4 v[184:187], v4, s[28:31], s81 offen offset:2048 sc1
    v_bitop3_b32 v60, v60, v152, s75 bitop3:0xf6
    v_mfma_f32_32x32x16_bf16 v[80:95], v[152:155], v[44:47], v[80:95]
    ds_read_b64_tr_b16 v[36:37], v9 offset:9216
    ds_read_b64_tr_b16 v[38:39], v10 offset:9216
    s_waitcnt vmcnt(7) lgkmcnt(8)
    v_mfma_f32_32x32x16_bf16 v[64:79], v[48:51], v[156:159], v[64:79]
    ds_read_b64_tr_b16 v[40:41], v7 offset:10240
    ds_read_b64_tr_b16 v[42:43], v8 offset:10240
    buffer_load_dwordx4 v[188:191], v4, s[28:31], s81 offen offset:3072 sc1
    v_bitop3_b32 v60, v60, v156, s75 bitop3:0xf6
    v_mfma_f32_32x32x16_bf16 v[80:95], v[156:159], v[52:55], v[80:95]
    ds_read_b64_tr_b16 v[44:45], v9 offset:10240
    ds_read_b64_tr_b16 v[46:47], v10 offset:10240
    s_waitcnt vmcnt(7) lgkmcnt(8)
    v_mfma_f32_32x32x16_bf16 v[64:79], v[24:27], v[160:163], v[64:79]
    ds_read_b64_tr_b16 v[48:49], v7 offset:11264
    ds_read_b64_tr_b16 v[50:51], v8 offset:11264
    buffer_load_dwordx4 v[192:195], v4, s[28:31], s82 offen offset:0 sc1
    v_bitop3_b32 v60, v60, v160, s75 bitop3:0xf6
    v_mfma_f32_32x32x16_bf16 v[80:95], v[160:163], v[28:31], v[80:95]
    ds_read_b64_tr_b16 v[52:53], v9 offset:11264
    ds_read_b64_tr_b16 v[54:55], v10 offset:11264
    v_and_b32 v61, 0x10000, v60
    v_cmp_ne_u32 vcc, 0, v61
    s_and_b64 vcc, vcc, s[44:45]
    s_cbranch_vccnz L_xrs_203
    s_waitcnt vmcnt(7) lgkmcnt(8)
    v_mfma_f32_32x32x16_bf16 v[64:79], v[32:35], v[164:167], v[64:79]
    ds_read_b64_tr_b16 v[24:25], v7 offset:12288
    ds_read_b64_tr_b16 v[26:27], v8 offset:12288
    buffer_load_dwordx4 v[196:199], v4, s[28:31], s82 offen offset:1024 sc1
    v_bitop3_b32 v60, v60, v164, s75 bitop3:0xf6
    v_mfma_f32_32x32x16_bf16 v[80:95], v[164:167], v[36:39], v[80:95]
    ds_read_b64_tr_b16 v[28:29], v9 offset:12288
    ds_read_b64_tr_b16 v[30:31], v10 offset:12288
    s_lshr_b32 s47, s3, 1
    s_waitcnt vmcnt(7) lgkmcnt(8)
    v_mfma_f32_32x32x16_bf16 v[64:79], v[40:43], v[168:171], v[64:79]
    ds_read_b64_tr_b16 v[32:33], v7 offset:13312
    ds_read_b64_tr_b16 v[34:35], v8 offset:13312
    buffer_load_dwordx4 v[200:203], v4, s[28:31], s82 offen offset:2048 sc1
    v_bitop3_b32 v60, v60, v168, s75 bitop3:0xf6
    v_mfma_f32_32x32x16_bf16 v[80:95], v[168:171], v[44:47], v[80:95]
    ds_read_b64_tr_b16 v[36:37], v9 offset:13312
    ds_read_b64_tr_b16 v[38:39], v10 offset:13312
    s_mul_i32 s51, s47, 1040
    s_waitcnt vmcnt(7) lgkmcnt(8)
    v_mfma_f32_32x32x16_bf16 v[64:79], v[48:51], v[172:175], v[64:79]
    ds_read_b64_tr_b16 v[40:41], v7 offset:14336
    ds_read_b64_tr_b16 v[42:43], v8 offset:14336
    buffer_load_dwordx4 v[204:207], v4, s[28:31], s82 offen offset:3072 sc1
    v_bitop3_b32 v60, v60, v172, s75 bitop3:0xf6
    v_mfma_f32_32x32x16_bf16 v[80:95], v[172:175], v[52:55], v[80:95]
    ds_read_b64_tr_b16 v[44:45], v9 offset:14336
    ds_read_b64_tr_b16 v[46:47], v10 offset:14336
    s_lshl_b32 s47, s47, 10
    s_waitcnt vmcnt(7) lgkmcnt(8)
    v_mfma_f32_32x32x16_bf16 v[64:79], v[24:27], v[176:179], v[64:79]
    ds_read_b64_tr_b16 v[48:49], v7 offset:15360
    ds_read_b64_tr_b16 v[50:51], v8 offset:15360
    buffer_load_dwordx4 v[208:211], v4, s[28:31], s83 offen offset:0 sc1
    v_bitop3_b32 v60, v60, v176, s75 bitop3:0xf6
    v_mfma_f32_32x32x16_bf16 v[80:95], v[176:179], v[28:31], v[80:95]
    ds_read_b64_tr_b16 v[52:53], v9 offset:15360
    ds_read_b64_tr_b16 v[54:55], v10 offset:15360
    s_add_u32 s76, s59, s47
    s_waitcnt vmcnt(7) lgkmcnt(8)
    v_mfma_f32_32x32x16_bf16 v[64:79], v[32:35], v[180:183], v[64:79]
    ds_read_b64_tr_b16 v[24:25], v7 offset:16384
    ds_read_b64_tr_b16 v[26:27], v8 offset:16384
    buffer_load_dwordx4 v[212:215], v4, s[28:31], s83 offen offset:1024 sc1
    v_bitop3_b32 v60, v60, v180, s75 bitop3:0xf6
    v_mfma_f32_32x32x16_bf16 v[80:95], v[180:183], v[36:39], v[80:95]
    ds_read_b64_tr_b16 v[28:29], v9 offset:16384
    ds_read_b64_tr_b16 v[30:31], v10 offset:16384
    s_mul_i32 s47, s3, 15360
    s_waitcnt vmcnt(7) lgkmcnt(8)
    v_mfma_f32_32x32x16_bf16 v[64:79], v[40:43], v[184:187], v[64:79]
    ds_read_b64_tr_b16 v[32:33], v7 offset:17408
    ds_read_b64_tr_b16 v[34:35], v8 offset:17408
    buffer_load_dwordx4 v[216:219], v4, s[28:31], s83 offen offset:2048 sc1
    v_bitop3_b32 v60, v60, v184, s75 bitop3:0xf6
    v_mfma_f32_32x32x16_bf16 v[80:95], v[184:187], v[44:47], v[80:95]
    ds_read_b64_tr_b16 v[36:37], v9 offset:17408
    ds_read_b64_tr_b16 v[38:39], v10 offset:17408
    s_sub_u32 s76, s76, s47
    s_waitcnt vmcnt(7) lgkmcnt(8)
    v_mfma_f32_32x32x16_bf16 v[64:79], v[48:51], v[188:191], v[64:79]
    ds_read_b64_tr_b16 v[40:41], v7 offset:18432
    ds_read_b64_tr_b16 v[42:43], v8 offset:18432
    buffer_load_dwordx4 v[220:223], v4, s[28:31], s83 offen offset:3072 sc1
    v_bitop3_b32 v60, v60, v188, s75 bitop3:0xf6
    v_mfma_f32_32x32x16_bf16 v[80:95], v[188:191], v[52:55], v[80:95]
    ds_read_b64_tr_b16 v[44:45], v9 offset:18432
    ds_read_b64_tr_b16 v[46:47], v10 offset:18432
    s_sub_u32 s76, s76, 16384
    s_waitcnt vmcnt(7) lgkmcnt(8)
    v_mfma_f32_32x32x16_bf16 v[64:79], v[24:27], v[192:195], v[64:79]
    ds_read_b64_tr_b16 v[48:49], v7 offset:19456
    ds_read_b64_tr_b16 v[50:51], v8 offset:19456
    buffer_load_dwordx4 v[224:227], v4, s[28:31], s64 offen offset:0 sc1
    v_bitop3_b32 v60, v60, v192, s75 bitop3:0xf6
    v_mfma_f32_32x32x16_bf16 v[80:95], v[192:195], v[28:31], v[80:95]
    ds_read_b64_tr_b16 v[52:53], v9 offset:19456
    ds_read_b64_tr_b16 v[54:55], v10 offset:19456
    s_lshl_b32 s47, s3, 10
    s_waitcnt vmcnt(7) lgkmcnt(8)
    v_mfma_f32_32x32x16_bf16 v[64:79], v[32:35], v[196:199], v[64:79]
    ds_read_b64_tr_b16 v[24:25], v7 offset:20480
    ds_read_b64_tr_b16 v[26:27], v8 offset:20480
    buffer_load_dwordx4 v[228:231], v4, s[28:31], s64 offen offset:1024 sc1
    v_bitop3_b32 v60, v60, v196, s75 bitop3:0xf6
    v_mfma_f32_32x32x16_bf16 v[80:95], v[196:199], v[36:39], v[80:95]
    ds_read_b64_tr_b16 v[28:29], v9 offset:20480
    ds_read_b64_tr_b16 v[30:31], v10 offset:20480
    buffer_load_dwordx4 v[112:115], v4, s[36:39], s60 offen sc1
    s_add_u32 s51, s51, s47
    s_waitcnt vmcnt(8) lgkmcnt(8)
    v_mfma_f32_32x32x16_bf16 v[64:79], v[40:43], v[200:203], v[64:79]
    ds_read_b64_tr_b16 v[32:33], v7 offset:21504
    ds_read_b64_tr_b16 v[34:35], v8 offset:21504
    buffer_load_dwordx4 v[232:235], v4, s[28:31], s64 offen offset:2048 sc1
    v_bitop3_b32 v60, v60, v200, s75 bitop3:0xf6
    v_mfma_f32_32x32x16_bf16 v[80:95], v[200:203], v[44:47], v[80:95]
    ds_read_b64_tr_b16 v[36:37], v9 offset:21504
    ds_read_b64_tr_b16 v[38:39], v10 offset:21504
    s_add_u32 s77, s51, 28896
    s_waitcnt vmcnt(8) lgkmcnt(8)
    v_mfma_f32_32x32x16_bf16 v[64:79], v[48:51], v[204:207], v[64:79]
    ds_read_b64_tr_b16 v[40:41], v7 offset:22528
    ds_read_b64_tr_b16 v[42:43], v8 offset:22528
    buffer_load_dwordx4 v[236:239], v4, s[28:31], s64 offen offset:3072 sc1
    v_bitop3_b32 v60, v60, v204, s75 bitop3:0xf6
    v_mfma_f32_32x32x16_bf16 v[80:95], v[204:207], v[52:55], v[80:95]
    ds_read_b64_tr_b16 v[44:45], v9 offset:22528
    ds_read_b64_tr_b16 v[46:47], v10 offset:22528
    s_cmp_eq_u32 s4, 0
    s_waitcnt vmcnt(8) lgkmcnt(8)
    v_mfma_f32_32x32x16_bf16 v[64:79], v[24:27], v[208:211], v[64:79]
    ds_read_b64_tr_b16 v[48:49], v7 offset:23552
    ds_read_b64_tr_b16 v[50:51], v8 offset:23552
    buffer_load_dwordx4 v[240:243], v4, s[28:31], s65 offen offset:0 sc1
    v_bitop3_b32 v60, v60, v208, s75 bitop3:0xf6
    v_mfma_f32_32x32x16_bf16 v[80:95], v[208:211], v[28:31], v[80:95]
    ds_read_b64_tr_b16 v[52:53], v9 offset:23552
    ds_read_b64_tr_b16 v[54:55], v10 offset:23552
    s_cselect_b32 s76, 0x7f000000, s76
    s_waitcnt vmcnt(8) lgkmcnt(8)
    v_mfma_f32_32x32x16_bf16 v[64:79], v[32:35], v[212:215], v[64:79]
    ds_read_b64_tr_b16 v[24:25], v7 offset:24576
    ds_read_b64_tr_b16 v[26:27], v8 offset:24576
    buffer_load_dwordx4 v[244:247], v4, s[28:31], s65 offen offset:1024 sc1
    v_bitop3_b32 v60, v60, v212, s75 bitop3:0xf6
    v_mfma_f32_32x32x16_bf16 v[80:95], v[212:215], v[36:39], v[80:95]
    ds_read_b64_tr_b16 v[28:29], v9 offset:24576
    ds_read_b64_tr_b16 v[30:31], v10 offset:24576
    s_cselect_b32 s27, 0, s93
    s_waitcnt vmcnt(8) lgkmcnt(8)
    v_mfma_f32_32x32x16_bf16 v[64:79], v[40:43], v[216:219], v[64:79]
    ds_read_b64_tr_b16 v[32:33], v7 offset:25600
    ds_read_b64_tr_b16 v[34:35], v8 offset:25600
    buffer_load_dwordx4 v[248:251], v4, s[28:31], s65 offen offset:2048 sc1
    v_bitop3_b32 v60, v60, v216, s75 bitop3:0xf6
    v_mfma_f32_32x32x16_bf16 v[80:95], v[216:219], v[44:47], v[80:95]
    ds_read_b64_tr_b16 v[36:37], v9 offset:25600
    ds_read_b64_tr_b16 v[38:39], v10 offset:25600
    s_waitcnt vmcnt(8) lgkmcnt(8)
    v_mfma_f32_32x32x16_bf16 v[64:79], v[48:51], v[220:223], v[64:79]
    ds_read_b64_tr_b16 v[40:41], v7 offset:26624
    ds_read_b64_tr_b16 v[42:43], v8 offset:26624
    buffer_load_dwordx4 v[252:255], v4, s[28:31], s65 offen offset:3072 sc1
    v_bitop3_b32 v60, v60, v220, s75 bitop3:0xf6
    v_mfma_f32_32x32x16_bf16 v[80:95], v[220:223], v[52:55], v[80:95]
    ds_read_b64_tr_b16 v[44:45], v9 offset:26624
    ds_read_b64_tr_b16 v[46:47], v10 offset:26624
    s_waitcnt vmcnt(8) lgkmcnt(8)
    v_mfma_f32_32x32x16_bf16 v[64:79], v[24:27], v[224:227], v[64:79]
    ds_read_b64_tr_b16 v[48:49], v7 offset:27648
    ds_read_b64_tr_b16 v[50:51], v8 offset:27648
    v_bitop3_b32 v60, v60, v224, s75 bitop3:0xf6
    v_mfma_f32_32x32x16_bf16 v[80:95], v[224:227], v[28:31], v[80:95]
    ds_read_b64_tr_b16 v[52:53], v9 offset:27648
    ds_read_b64_tr_b16 v[54:55], v10 offset:27648
    s_waitcnt vmcnt(6)
    v_lshlrev_b32 v61, 16, v112
    v_bitop3_b32 v60, v60, v61, s75 bitop3:0xf6
    v_lshlrev_b32 v61, 16, v114
    v_bitop3_b32 v60, v60, v61, s75 bitop3:0xf6
    s_waitcnt lgkmcnt(8)
    v_mfma_f32_32x32x16_bf16 v[64:79], v[32:35], v[228:231], v[64:79]
    ds_read_b64_tr_b16 v[24:25], v7 offset:28672
    ds_read_b64_tr_b16 v[26:27], v8 offset:28672
    v_add_f32 v112, v112, v114
    v_add_f32 v113, v113, v115
    v_mov_b32 v114, v112
    v_bitop3_b32 v60, v60, v228, s75 bitop3:0xf6
    v_mfma_f32_32x32x16_bf16 v[80:95], v[228:231], v[36:39], v[80:95]
    ds_read_b64_tr_b16 v[28:29], v9 offset:28672
    ds_read_b64_tr_b16 v[30:31], v10 offset:28672
    v_mov_b32 v115, v113
    v_mov_b32 v18, 0
    v_mov_b32 v19, 0
    s_waitcnt vmcnt(5) lgkmcnt(8)
    v_mfma_f32_32x32x16_bf16 v[64:79], v[40:43], v[232:235], v[64:79]
    ds_read_b64_tr_b16 v[32:33], v7 offset:29696
    ds_read_b64_tr_b16 v[34:35], v8 offset:29696
    v_permlane32_swap_b32 v112, v114
    v_permlane32_swap_b32 v113, v115
    s_lshl_b32 s46, s3, 7
    v_bitop3_b32 v60, v60, v232, s75 bitop3:0xf6
    v_mfma_f32_32x32x16_bf16 v[80:95], v[232:235], v[44:47], v[80:95]
    ds_read_b64_tr_b16 v[36:37], v9 offset:29696
    ds_read_b64_tr_b16 v[38:39], v10 offset:29696
    v_lshlrev_b32 v14, 2, v2
    v_add_f32 v112, v112, v114
    v_add_f32 v113, v113, v115
    s_waitcnt vmcnt(4) lgkmcnt(8)
    v_mfma_f32_32x32x16_bf16 v[64:79], v[48:51], v[236:239], v[64:79]
    ds_read_b64_tr_b16 v[40:41], v7 offset:30720
    ds_read_b64_tr_b16 v[42:43], v8 offset:30720
    v_mul_f32 v112, 0x3b000000, v112
    v_mul_f32 v113, 0x3b000000, v113
    v_fma_f32 v113, -v112, v112, v113
    v_bitop3_b32 v60, v60, v236, s75 bitop3:0xf6
    v_mfma_f32_32x32x16_bf16 v[80:95], v[236:239], v[52:55], v[80:95]
    ds_read_b64_tr_b16 v[44:45], v9 offset:30720
    ds_read_b64_tr_b16 v[46:47], v10 offset:30720
    v_max_f32 v113, 0, v113
    v_cvt_pk_bf16_f32 v114, v112, v113
    v_and_b32 v115, 0xffff0000, v114
    s_waitcnt vmcnt(3) lgkmcnt(8)
    v_mfma_f32_32x32x16_bf16 v[64:79], v[24:27], v[240:243], v[64:79]
    ds_read_b64_tr_b16 v[48:49], v7 offset:31744
    ds_read_b64_tr_b16 v[50:51], v8 offset:31744
    v_add_f32 v115, 0x3727c5ac, v115
    v_cvt_pk_bf16_f32 v115, v115, v115
    v_and_b32 v115, 0xffff0000, v115
    v_bitop3_b32 v60, v60, v240, s75 bitop3:0xf6
    v_mfma_f32_32x32x16_bf16 v[80:95], v[240:243], v[28:31], v[80:95]
    ds_read_b64_tr_b16 v[52:53], v9 offset:31744
    ds_read_b64_tr_b16 v[54:55], v10 offset:31744
    v_sqrt_f32 v115, v115
    v_and_b32 v114, 0xffff, v114
    v_xor_b32 v114, 0x8000, v114
    s_waitcnt vmcnt(2) lgkmcnt(8)
    v_mfma_f32_32x32x16_bf16 v[64:79], v[32:35], v[244:247], v[64:79]
    ds_read_b64 v[24:25], v15 offset:256
    ds_read_b64 v[28:29], v15 offset:512
    v_cvt_pk_bf16_f32 v115, v115, v115
    v_and_b32 v115, 0xffff0000, v115
    v_rcp_f32 v12, v115
    v_bitop3_b32 v60, v60, v244, s75 bitop3:0xf6
    v_mfma_f32_32x32x16_bf16 v[80:95], v[244:247], v[36:39], v[80:95]
    v_cndmask_b32_e64 v17, 0, v114, s[66:67]
    v_lshl_or_b32 v16, v17, 16, v17
    v_add_u32 v14, s46, v14
    s_waitcnt vmcnt(1) lgkmcnt(6)
    v_mfma_f32_32x32x16_bf16 v[64:79], v[40:43], v[248:251], v[64:79]
    ds_read_b64 v[32:33], v15 offset:0
    ds_read_b64_tr_b16 v[36:37], v5 offset:31744
    v_mul_f32 v13, 0x3eb8aa3b, v12
    v_lshlrev_b32 v21, 4, v3
    v_add_u32 v21, s46, v21
    ds_write_b32 v14, v12 offset:59392
    ds_read_b128 v[112:115], v21 offset:59392
    ds_read_b128 v[116:119], v21 offset:59424
    ds_read_b128 v[120:123], v21 offset:59456
    ds_read_b128 v[124:127], v21 offset:59488
    v_bitop3_b32 v60, v60, v248, s75 bitop3:0xf6
    v_mfma_f32_32x32x16_bf16 v[80:95], v[248:251], v[44:47], v[80:95]
    ds_read_b64_tr_b16 v[38:39], v6 offset:31744
    s_waitcnt vmcnt(0) lgkmcnt(10)
    v_mfma_f32_32x32x16_bf16 v[64:79], v[48:51], v[252:255], v[64:79]
    ds_read_b64_tr_b16 v[40:41], v5 offset:30720
    ds_read_b64_tr_b16 v[42:43], v6 offset:30720
    v_bitop3_b32 v60, v60, v252, s75 bitop3:0xf6
    v_mfma_f32_32x32x16_bf16 v[80:95], v[252:255], v[52:55], v[80:95]
    ds_read_b64_tr_b16 v[44:45], v5 offset:29696
    ds_read_b64_tr_b16 v[46:47], v6 offset:29696
    v_and_b32 v61, 0x10000, v60
    v_cmp_ne_u32 vcc, 0, v61
    s_and_b64 vcc, vcc, s[44:45]
    s_cbranch_vccnz L_g_redo_199
L_g_join_198:
    s_waitcnt lgkmcnt(12)
    v_mfma_f32_32x32x16_bf16 v[64:79], v[24:27], v[16:19], v[64:79]
    v_mfma_f32_32x32x16_bf16 v[80:95], v[16:19], v[28:31], v[80:95]
    ds_read_b64_tr_b16 v[24:25], v5 offset:28672
    ds_read_b64_tr_b16 v[26:27], v6 offset:28672
    s_nop 3
    s_waitcnt lgkmcnt(13)
    v_mfma_f32_32x32x16_bf16 v[96:111], v[32:35], v[16:19], 0
    ds_read_b64_tr_b16 v[28:29], v5 offset:27648
    ds_read_b64_tr_b16 v[30:31], v6 offset:27648
    s_mov_b32 s81, s77
    v_mul_f32 v64, v12, v64
    v_mul_f32 v65, v12, v65
    v_mul_f32 v66, v12, v66
    v_mul_f32 v67, v12, v67
    v_mul_f32 v68, v12, v68
    v_mul_f32 v69, v12, v69
    v_mul_f32 v70, v12, v70
    s_waitcnt lgkmcnt(8)
    v_mfma_f32_32x32x16_bf16 v[96:111], v[36:39], v[252:255], v[96:111]
    ds_read_b64_tr_b16 v[32:33], v5 offset:26624
    ds_read_b64_tr_b16 v[34:35], v6 offset:26624
    v_mul_f32 v71, v12, v71
    v_and_b32 v65, 0xfffe0000, v65
    v_cvt_pk_bf16_f32 v64, v64, v65
    v_cvt_pk_bf16_f32 v65, v66, v67
    v_cvt_pk_bf16_f32 v66, v68, v69
    v_cvt_pk_bf16_f32 v67, v70, v71
    v_or_b32 v64, 0x10000, v64
    s_waitcnt lgkmcnt(6)
    v_mfma_f32_32x32x16_bf16 v[96:111], v[40:43], v[248:251], v[96:111]
    ds_read_b64_tr_b16 v[36:37], v5 offset:25600
    ds_read_b64_tr_b16 v[38:39], v6 offset:25600
    v_mul_f32 v72, v12, v72
    v_mul_f32 v73, v12, v73
    v_mul_f32 v74, v12, v74
    v_mul_f32 v75, v12, v75
    v_mul_f32 v76, v12, v76
    v_mul_f32 v77, v12, v77
    v_mul_f32 v78, v12, v78
    v_mul_f32 v79, v12, v79
    v_mfma_f32_32x32x16_bf16 v[96:111], v[44:47], v[244:247], v[96:111]
    ds_read_b64_tr_b16 v[40:41], v5 offset:24576
    ds_read_b64_tr_b16 v[42:43], v6 offset:24576
    v_and_b32 v73, 0xfffe0000, v73
    v_cvt_pk_bf16_f32 v68, v72, v73
    v_cvt_pk_bf16_f32 v69, v74, v75
    v_cvt_pk_bf16_f32 v70, v76, v77
    v_cvt_pk_bf16_f32 v71, v78, v79
    v_or_b32 v68, 0x10000, v68
    s_cmp_lg_u32 s3, 3
    s_cbranch_scc1 L_kvsk_207
    buffer_store_dwordx4 v[64:67], v4, s[36:39], s59 offen offset:0 sc1
    buffer_store_dwordx4 v[68:71], v4, s[36:39], s59 offen offset:1024 sc1
L_kvsk_207:
    s_waitcnt lgkmcnt(6)
    v_mfma_f32_32x32x16_bf16 v[96:111], v[24:27], v[240:243], v[96:111]
    ds_read_b64_tr_b16 v[44:45], v5 offset:23552
    ds_read_b64_tr_b16 v[46:47], v6 offset:23552
    s_waitcnt lgkmcnt(15)
    v_mul_f32 v88, v120, v88
    v_mul_f32 v89, v121, v89
    v_mul_f32 v90, v122, v90
    v_mul_f32 v91, v123, v91
    v_mul_f32 v92, v124, v92
    v_mul_f32 v93, v125, v93
    v_mul_f32 v94, v126, v94
    v_mfma_f32_32x32x16_bf16 v[96:111], v[28:31], v[236:239], v[96:111]
    ds_read_b64_tr_b16 v[24:25], v5 offset:22528
    ds_read_b64_tr_b16 v[26:27], v6 offset:22528
    v_mul_f32 v95, v127, v95
    v_and_b32 v89, 0xfffe0000, v89
    v_cvt_pk_bf16_f32 v88, v88, v89
    v_cvt_pk_bf16_f32 v89, v90, v91
    v_cvt_pk_bf16_f32 v90, v92, v93
    v_cvt_pk_bf16_f32 v91, v94, v95
    v_or_b32 v88, 0x10000, v88
    s_waitcnt lgkmcnt(6)
    v_mfma_f32_32x32x16_bf16 v[96:111], v[32:35], v[232:235], v[96:111]
    ds_read_b64_tr_b16 v[28:29], v5 offset:21504
    ds_read_b64_tr_b16 v[30:31], v6 offset:21504
    s_cmp_lg_u32 s3, 3
    s_cbranch_scc1 L_kvsk_208
    buffer_store_dwordx4 v[88:91], v4, s[36:39], s59 offen offset:3072 sc1
L_kvsk_208:
    v_mul_f32 v80, v112, v80
    v_mul_f32 v81, v113, v81
    v_mul_f32 v82, v114, v82
    v_mul_f32 v83, v115, v83
    v_mul_f32 v84, v116, v84
    v_mul_f32 v85, v117, v85
    v_mfma_f32_32x32x16_bf16 v[96:111], v[36:39], v[228:231], v[96:111]
    ds_read_b64_tr_b16 v[32:33], v5 offset:20480
    ds_read_b64_tr_b16 v[34:35], v6 offset:20480
    v_mul_f32 v86, v118, v86
    v_mul_f32 v87, v119, v87
    s_waitcnt lgkmcnt(6)
    v_mfma_f32_32x32x16_bf16 v[96:111], v[40:43], v[224:227], v[96:111]
    ds_read_b64_tr_b16 v[36:37], v5 offset:19456
    ds_read_b64_tr_b16 v[38:39], v6 offset:19456
    v_cvt_pk_bf16_f32 v80, v80, v81
    v_cvt_pk_bf16_f32 v81, v82, v83
    v_cvt_pk_bf16_f32 v82, v84, v85
    v_mfma_f32_32x32x16_bf16 v[96:111], v[44:47], v[220:223], v[96:111]
    ds_read_b64_tr_b16 v[40:41], v5 offset:18432
    ds_read_b64_tr_b16 v[42:43], v6 offset:18432
    v_cvt_pk_bf16_f32 v83, v86, v87
    s_mul_i32 s46, s3, 4128
    s_waitcnt lgkmcnt(6)
    v_mfma_f32_32x32x16_bf16 v[96:111], v[24:27], v[216:219], v[96:111]
    ds_read_b64_tr_b16 v[44:45], v5 offset:17408
    ds_read_b64_tr_b16 v[46:47], v6 offset:17408
    v_add_u32 v248, s46, v4
    ds_write_b128 v248, v[64:67] offset:33024
    v_mfma_f32_32x32x16_bf16 v[96:111], v[28:31], v[212:215], v[96:111]
    ds_read_b64_tr_b16 v[24:25], v5 offset:16384
    ds_read_b64_tr_b16 v[26:27], v6 offset:16384
    ds_write_b128 v248, v[68:71] offset:34048
    s_waitcnt lgkmcnt(8)
    v_mfma_f32_32x32x16_bf16 v[96:111], v[32:35], v[208:211], v[96:111]
    ds_read_b64_tr_b16 v[28:29], v5 offset:15360
    ds_read_b64_tr_b16 v[30:31], v6 offset:15360
    ds_write_b128 v248, v[80:83] offset:35072
    v_mfma_f32_32x32x16_bf16 v[96:111], v[36:39], v[204:207], v[96:111]
    ds_read_b64_tr_b16 v[32:33], v5 offset:14336
    ds_read_b64_tr_b16 v[34:35], v6 offset:14336
    ds_write_b128 v248, v[88:91] offset:36112
    s_waitcnt lgkmcnt(10)
    v_mfma_f32_32x32x16_bf16 v[96:111], v[40:43], v[200:203], v[96:111]
    ds_read_b64_tr_b16 v[36:37], v5 offset:13312
    ds_read_b64_tr_b16 v[38:39], v6 offset:13312
    s_add_u32 s46, s46, 1024
    v_mov_b32 v14, s46
    v_add_u32 v251, 0x400, v248
    v_mfma_f32_32x32x16_bf16 v[96:111], v[44:47], v[196:199], v[96:111]
    ds_read_b64_tr_b16 v[40:41], v5 offset:12288
    ds_read_b64_tr_b16 v[42:43], v6 offset:12288
    v_add_u32 v250, 0x100, v248
    v_cndmask_b32_e64 v249, v14, v248, s[72:73]
    s_waitcnt lgkmcnt(8)
    v_mfma_f32_32x32x16_bf16 v[96:111], v[24:27], v[192:195], v[96:111]
    ds_read_b64_tr_b16 v[44:45], v5 offset:11264
    ds_read_b64_tr_b16 v[46:47], v6 offset:11264
    v_cndmask_b32_e64 v250, v14, v250, s[72:73]
    v_lshlrev_b32 v14, 2, v3
    v_sub_u32 v14, v14, v2
    v_mfma_f32_32x32x16_bf16 v[96:111], v[28:31], v[188:191], v[96:111]
    ds_read_b64_tr_b16 v[24:25], v5 offset:10240
    ds_read_b64_tr_b16 v[26:27], v6 offset:10240
    v_lshlrev_b32 v14, 2, v14
    v_add_u32 v14, 60544, v14
    s_waitcnt lgkmcnt(6)
    v_mfma_f32_32x32x16_bf16 v[96:111], v[32:35], v[184:187], v[96:111]
    ds_read_b64_tr_b16 v[28:29], v5 offset:9216
    ds_read_b64_tr_b16 v[30:31], v6 offset:9216
    ds_read2_b32 v[232:233], v14 offset0:0 offset1:1
    ds_read2_b32 v[234:235], v14 offset0:2 offset1:3
    ds_read2_b32 v[236:237], v14 offset0:8 offset1:9
    v_mfma_f32_32x32x16_bf16 v[96:111], v[36:39], v[180:183], v[96:111]
    ds_read_b64_tr_b16 v[32:33], v5 offset:8192
    ds_read_b64_tr_b16 v[34:35], v6 offset:8192
    ds_read2_b32 v[238:239], v14 offset0:10 offset1:11
    ds_read2_b32 v[240:241], v14 offset0:16 offset1:17
    s_waitcnt lgkmcnt(11)
    v_mfma_f32_32x32x16_bf16 v[96:111], v[40:43], v[176:179], v[96:111]
    ds_read_b64_tr_b16 v[36:37], v5 offset:7168
    ds_read_b64_tr_b16 v[38:39], v6 offset:7168
    ds_read2_b32 v[242:243], v14 offset0:18 offset1:19
    ds_read2_b32 v[244:245], v14 offset0:24 offset1:25
    ds_read2_b32 v[246:247], v14 offset0:26 offset1:27
    v_mfma_f32_32x32x16_bf16 v[96:111], v[44:47], v[172:175], v[96:111]
    ds_read_b64_tr_b16 v[40:41], v5 offset:6144
    ds_read_b64_tr_b16 v[42:43], v6 offset:6144
    ds_read2_b32 v[56:57], v14 offset0:80 offset1:81
    ds_read2_b32 v[58:59], v14 offset0:82 offset1:83
    s_waitcnt lgkmcnt(15)
    v_mfma_f32_32x32x16_bf16 v[96:111], v[24:27], v[168:171], v[96:111]
    ds_read_b64_tr_b16 v[44:45], v5 offset:5120
    ds_read_b64_tr_b16 v[46:47], v6 offset:5120
    ds_read2_b32 v[60:61], v14 offset0:88 offset1:89
    ds_read2_b32 v[62:63], v14 offset0:90 offset1:91
    v_mfma_f32_32x32x16_bf16 v[96:111], v[28:31], v[164:167], v[96:111]
    ds_read_b64_tr_b16 v[24:25], v5 offset:4096
    ds_read_b64_tr_b16 v[26:27], v6 offset:4096
    s_waitcnt lgkmcnt(13)
    v_mfma_f32_32x32x16_bf16 v[96:111], v[32:35], v[160:163], v[96:111]
    ds_read_b64_tr_b16 v[28:29], v5 offset:3072
    ds_read_b64_tr_b16 v[30:31], v6 offset:3072
    v_mfma_f32_32x32x16_bf16 v[96:111], v[36:39], v[156:159], v[96:111]
    ds_read_b64_tr_b16 v[32:33], v5 offset:2048
    ds_read_b64_tr_b16 v[34:35], v6 offset:2048
    s_waitcnt lgkmcnt(8)
    v_mfma_f32_32x32x16_bf16 v[96:111], v[40:43], v[152:155], v[96:111]
    ds_read_b64_tr_b16 v[36:37], v5 offset:1024
    ds_read_b64_tr_b16 v[38:39], v6 offset:1024
    s_cmp_eq_u32 s3, 3
    s_cbranch_scc1 L_nbb_209
    s_add_u32 m0, s81, 0
    s_nop 0
    buffer_load_dwordx4 v4, s[36:39], s76 offen offset:0 sc1 lds
L_nbb_209:
    v_mfma_f32_32x32x16_bf16 v[96:111], v[44:47], v[148:151], v[96:111]
    ds_read_b64_tr_b16 v[40:41], v5 offset:0
    ds_read_b64_tr_b16 v[42:43], v6 offset:0
    s_waitcnt lgkmcnt(6)
    v_mfma_f32_32x32x16_bf16 v[96:111], v[24:27], v[144:147], v[96:111]
    ds_read_b128 v[160:163], v248 offset:33024
    ds_read_b128 v[164:167], v249 offset:35072
    v_mfma_f32_32x32x16_bf16 v[96:111], v[28:31], v[140:143], v[96:111]
    ds_read_b128 v[168:171], v249 offset:36112
    ds_read_b128 v[172:175], v251 offset:33024
    s_waitcnt lgkmcnt(6)
    v_mfma_f32_32x32x16_bf16 v[96:111], v[32:35], v[136:139], v[96:111]
    ds_read_b128 v[176:179], v250 offset:35072
    ds_read_b128 v[180:183], v250 offset:36112
    v_mfma_f32_32x32x16_bf16 v[96:111], v[36:39], v[132:135], v[96:111]
    s_waitcnt lgkmcnt(6)
    v_mfma_f32_32x32x16_bf16 v[96:111], v[40:43], v[128:131], v[96:111]
    s_nop 7
    s_nop 3
    v_mul_f32 v96, v13, v96
    v_mul_f32 v97, v13, v97
    v_mul_f32 v98, v13, v98
    v_mul_f32 v99, v13, v99
    v_mul_f32 v100, v13, v100
    v_mul_f32 v101, v13, v101
    v_mul_f32 v102, v13, v102
    v_mul_f32 v103, v13, v103
    v_cvt_pk_bf16_f32 v16, v96, v97
    v_cvt_pk_bf16_f32 v17, v98, v99
    v_cvt_pk_bf16_f32 v18, v100, v101
    v_cvt_pk_bf16_f32 v19, v102, v103
    s_waitcnt lgkmcnt(0)
    s_nop 0
    v_mfma_f32_32x32x16_bf16 v[128:143], v[160:163], v[16:19], v[232:247]
    v_mul_f32 v104, v13, v104
    v_mul_f32 v105, v13, v105
    v_mul_f32 v106, v13, v106
    v_mul_f32 v107, v13, v107
    v_mul_f32 v108, v13, v108
    v_mul_f32 v109, v13, v109
    v_mul_f32 v110, v13, v110
    v_mul_f32 v111, v13, v111
    v_cvt_pk_bf16_f32 v20, v104, v105
    v_cvt_pk_bf16_f32 v21, v106, v107
    v_cvt_pk_bf16_f32 v22, v108, v109
    v_cvt_pk_bf16_f32 v23, v110, v111
    s_nop 1
    v_mfma_f32_32x32x16_bf16 v[144:159], v[172:175], v[20:23], v[232:247]
    v_exp_f32 v128, v128
    v_exp_f32 v129, v129
    v_exp_f32 v130, v130
    v_exp_f32 v131, v131
    v_exp_f32 v132, v132
    v_exp_f32 v133, v133
    v_exp_f32 v134, v134
    v_exp_f32 v135, v135
    v_exp_f32 v136, v136
    v_exp_f32 v137, v137
    v_exp_f32 v138, v138
    v_exp_f32 v139, v139
    v_exp_f32 v140, v140
    v_exp_f32 v141, v141
    v_exp_f32 v142, v142
    v_exp_f32 v143, v143
    v_cvt_pk_bf16_f32 v128, v128, v129
    v_cvt_pk_bf16_f32 v129, v130, v131
    v_cvt_pk_bf16_f32 v130, v132, v133
    v_cvt_pk_bf16_f32 v131, v134, v135
    v_cvt_pk_bf16_f32 v132, v136, v137
    v_cvt_pk_bf16_f32 v133, v138, v139
    v_cvt_pk_bf16_f32 v134, v140, v141
    v_cvt_pk_bf16_f32 v135, v142, v143
    s_cmp_eq_u32 s3, 3
    s_cbranch_scc1 L_nbw_210
    v_add_u32 v27, s81, v4
    s_waitcnt vmcnt(0)
    ds_read_b32 v40, v27 offset:0
L_nbw_210:
    v_exp_f32 v144, v144
    v_mfma_f32_32x32x16_bf16 v[96:111], v[164:167], v[128:131], 0
    v_exp_f32 v145, v145
    v_exp_f32 v146, v146
    v_exp_f32 v147, v147
    s_cmp_eq_u32 s3, 3
    s_cbranch_scc1 L_nbw_211
    s_waitcnt lgkmcnt(0)
    v_xor_b32 v14, s27, v40
    v_and_b32 v14, 0x10000, v14
    v_cmp_ne_u32 vcc, 0, v14
    s_and_b64 vcc, vcc, s[44:45]
    s_cbranch_vccnz L_slow_212
L_back_213:
L_nbw_211:
    s_barrier
    ds_read_b128 v[184:187], v248 offset:28896
    ds_read_b128 v[192:195], v249 offset:31984
    ds_read_b128 v[196:199], v251 offset:28896
    ds_read_b128 v[204:207], v250 offset:31984
    v_exp_f32 v148, v148
    v_exp_f32 v149, v149
    v_exp_f32 v150, v150
    v_exp_f32 v151, v151
    v_mfma_f32_32x32x16_bf16 v[96:111], v[168:171], v[132:135], v[96:111]
    v_exp_f32 v152, v152
    v_exp_f32 v153, v153
    v_exp_f32 v154, v154
    v_exp_f32 v155, v155
    v_exp_f32 v156, v156
    v_exp_f32 v157, v157
    s_waitcnt lgkmcnt(3)
    v_mfma_f32_32x32x16_bf16 v[64:79], v[184:187], v[16:19], v[48:63]
    v_exp_f32 v158, v158
    v_exp_f32 v159, v159
    v_cvt_pk_bf16_f32 v144, v144, v145
    v_cvt_pk_bf16_f32 v145, v146, v147
    v_cvt_pk_bf16_f32 v146, v148, v149
    v_cvt_pk_bf16_f32 v147, v150, v151
    s_waitcnt lgkmcnt(1)
    v_mfma_f32_32x32x16_bf16 v[80:95], v[196:199], v[20:23], v[48:63]
    v_cvt_pk_bf16_f32 v148, v152, v153
    v_cvt_pk_bf16_f32 v149, v154, v155
    v_cvt_pk_bf16_f32 v150, v156, v157
    v_cvt_pk_bf16_f32 v151, v158, v159
    v_exp_f32 v72, v72
    v_exp_f32 v73, v73
    v_mfma_f32_32x32x16_bf16 v[112:127], v[176:179], v[144:147], 0
    v_exp_f32 v74, v74
    v_exp_f32 v75, v75
    v_exp_f32 v76, v76
    v_exp_f32 v77, v77
    v_exp_f32 v78, v78
    v_exp_f32 v79, v79
    v_mfma_f32_32x32x16_bf16 v[112:127], v[180:183], v[148:151], v[112:127]
    v_cvt_pk_bf16_f32 v68, v72, v73
    v_cvt_pk_bf16_f32 v69, v74, v75
    v_cvt_pk_bf16_f32 v70, v76, v77
    v_cvt_pk_bf16_f32 v71, v78, v79
    v_exp_f32 v88, v88
    v_exp_f32 v89, v89
    v_exp_f32 v90, v90
    v_exp_f32 v91, v91
    v_exp_f32 v92, v92
    v_exp_f32 v93, v93
    v_exp_f32 v94, v94
    v_exp_f32 v95, v95
    v_mfma_f32_32x32x16_bf16 v[96:111], v[192:195], v[68:71], v[96:111]
    v_cvt_pk_bf16_f32 v84, v88, v89
    v_cvt_pk_bf16_f32 v85, v90, v91
    v_cvt_pk_bf16_f32 v86, v92, v93
    v_cvt_pk_bf16_f32 v87, v94, v95
    s_nop 1
    s_waitcnt lgkmcnt(0)
    v_mfma_f32_32x32x16_bf16 v[112:127], v[204:207], v[84:87], v[112:127]
    s_nop 3
    v_rcp_f32 v28, v104
    v_mov_b32 v29, 0x10000
    v_mul_f32 v96, v28, v96
    v_mul_f32 v97, v28, v97
    v_mul_f32 v98, v28, v98
    v_mul_f32 v99, v28, v99
    v_mul_f32 v100, v28, v100
    v_mul_f32 v101, v28, v101
    v_mul_f32 v102, v28, v102
    v_mul_f32 v103, v28, v103
    v_add_u32 v97, s75, v97
    v_and_b32 v97, 0xfffe0000, v97
    v_cvt_pk_bf16_f32 v64, v96, v97
    v_cvt_pk_bf16_f32 v65, v98, v99
    v_cvt_pk_bf16_f32 v66, v100, v101
    v_cvt_pk_bf16_f32 v67, v102, v103
    v_bfi_b32 v64, v29, s74, v64
    v_max_f32 v25, v104, v120
    v_min_f32 v26, v104, v120
    v_add_f32 v27, v104, v120
    v_cmp_nle_f32 vcc, v25, s100
    v_cmp_nge_f32 s[68:69], v26, s101
    s_or_b64 vcc, vcc, s[68:69]
    v_cmp_u_f32 s[68:69], v27, v27
    s_or_b64 vcc, vcc, s[68:69]
    s_cbranch_vccnz L_fb_215
L_fbk_216:
    s_cmp_eq_u32 s7, 0
    s_cbranch_scc1 L_stsl_224
    buffer_store_dwordx4 v[64:67], v4, s[36:39], s58 offen
L_stdn_225:
    v_rcp_f32 v28, v120
    v_mov_b32 v29, 0x10000
    v_mul_f32 v112, v28, v112
    v_mul_f32 v113, v28, v113
    v_mul_f32 v114, v28, v114
    v_mul_f32 v115, v28, v115
    v_mul_f32 v116, v28, v116
    v_mul_f32 v117, v28, v117
    v_mul_f32 v118, v28, v118
    v_mul_f32 v119, v28, v119
    v_add_u32 v113, s75, v113
    v_and_b32 v113, 0xfffe0000, v113
    v_cvt_pk_bf16_f32 v68, v112, v113
    v_cvt_pk_bf16_f32 v69, v114, v115
    v_cvt_pk_bf16_f32 v70, v116, v117
    v_cvt_pk_bf16_f32 v71, v118, v119
    v_bfi_b32 v68, v29, s74, v68
    s_cmp_eq_u32 s7, 0
    s_cbranch_scc1 L_stsl_226
    buffer_store_dwordx4 v[68:71], v4, s[36:39], s58 offen offset:1024
L_stdn_227:
    s_mul_i32 s81, s3, 8256
    s_mov_b32 s76, s63
    s_add_u32 s77, s63, 4096
    s_barrier
    s_lshl_b32 s46, s3, 11
    v_add_u32 v14, s46, v4
    ds_read_b128 v[96:99], v14 offset:49664
    ds_read_b128 v[100:103], v14 offset:50688
    s_mul_i32 s46, s3, 8256
    v_add_u32 v104, s46, v4
    s_add_u32 s46, s3, 1
    s_and_b32 s46, s46, 3
    s_mul_i32 s46, s46, 8256
    v_add_u32 v105, s46, v4
    s_add_u32 s46, s3, 2
    s_and_b32 s46, s46, 3
    s_mul_i32 s46, s46, 8256
    v_add_u32 v106, s46, v4
    s_add_u32 s46, s3, 3
    s_and_b32 s46, s46, 3
    s_mul_i32 s46, s46, 8256
    v_add_u32 v107, s46, v4
    s_waitcnt lgkmcnt(0)
    v_lshlrev_b32 v64, 16, v96
    v_and_b32 v65, 0xffff0000, v96
    v_lshlrev_b32 v66, 16, v97
    v_and_b32 v67, 0xffff0000, v97
    v_lshlrev_b32 v68, 16, v98
    v_and_b32 v69, 0xffff0000, v98
    v_lshlrev_b32 v70, 16, v99
    v_and_b32 v71, 0xffff0000, v99
    v_lshlrev_b32 v72, 16, v100
    v_and_b32 v73, 0xffff0000, v100
    v_lshlrev_b32 v74, 16, v101
    v_and_b32 v75, 0xffff0000, v101
    v_lshlrev_b32 v76, 16, v102
    v_and_b32 v77, 0xffff0000, v102
    v_lshlrev_b32 v78, 16, v103
    s_add_u32 m0, s81, 0
    v_and_b32 v79, 0xffff0000, v103
    buffer_load_dwordx4 v4, s[36:39], s76 offen offset:0 sc1 lds
    buffer_load_dwordx4 v4, s[36:39], s76 offen offset:1024 sc1 lds
    buffer_load_dwordx4 v4, s[36:39], s76 offen offset:2048 sc1 lds
    s_add_u32 m0, s81, 16
    s_nop 0
    buffer_load_dwordx4 v4, s[36:39], s76 offen offset:3072 sc1 lds
    s_add_u32 m0, s81, 4128
    s_nop 0
    buffer_load_dwordx4 v4, s[36:39], s77 offen offset:0 sc1 lds
    buffer_load_dwordx4 v4, s[36:39], s77 offen offset:1024 sc1 lds
    buffer_load_dwordx4 v4, s[36:39], s77 offen offset:2048 sc1 lds
    s_add_u32 m0, s81, 4144
    s_nop 0
    buffer_load_dwordx4 v4, s[36:39], s77 offen offset:3072 sc1 lds
L_trr_229:
L_swr_233:
    s_mov_b32 s52, 0
L_opv_238:
L_ort_239:
    s_waitcnt vmcnt(7)
    ds_read_b128 v[128:131], v104 offset:0
    s_waitcnt vmcnt(6)
    ds_read_b128 v[132:135], v104 offset:1024
    s_waitcnt vmcnt(5)
    ds_read_b128 v[136:139], v104 offset:2048
    s_waitcnt lgkmcnt(2)
    v_mfma_f32_32x32x16_bf16 v[64:79], a[0:3], v[128:131], v[64:79]
    v_xor_b32 v14, s74, v128
    s_waitcnt vmcnt(4)
    ds_read_b128 v[140:143], v104 offset:3088
    s_waitcnt lgkmcnt(2)
    v_mfma_f32_32x32x16_bf16 v[64:79], a[4:7], v[132:135], v[64:79]
    v_bitop3_b32 v14, v14, v132, s74 bitop3:0xf6
    s_waitcnt vmcnt(3)
    ds_read_b128 v[144:147], v104 offset:4128
    s_waitcnt lgkmcnt(2)
    v_mfma_f32_32x32x16_bf16 v[64:79], a[8:11], v[136:139], v[64:79]
    v_bitop3_b32 v14, v14, v136, s74 bitop3:0xf6
    s_waitcnt vmcnt(2)
    ds_read_b128 v[148:151], v104 offset:5152
    s_waitcnt lgkmcnt(2)
    v_mfma_f32_32x32x16_bf16 v[64:79], a[12:15], v[140:143], v[64:79]
    v_bitop3_b32 v14, v14, v140, s74 bitop3:0xf6
    s_waitcnt vmcnt(1)
    ds_read_b128 v[152:155], v104 offset:6176
    s_waitcnt lgkmcnt(2)
    v_mfma_f32_32x32x16_bf16 v[64:79], a[16:19], v[144:147], v[64:79]
    v_bitop3_b32 v14, v14, v144, s74 bitop3:0xf6
    s_waitcnt vmcnt(0)
    ds_read_b128 v[156:159], v104 offset:7216
    s_waitcnt lgkmcnt(2)
    v_bitop3_b32 v14, v14, v148, s74 bitop3:0xf6
    s_waitcnt lgkmcnt(1)
    v_bitop3_b32 v14, v14, v152, s74 bitop3:0xf6
    s_waitcnt lgkmcnt(0)
    v_bitop3_b32 v14, v14, v156, s74 bitop3:0xf6
    v_and_b32 v14, 0x10000, v14
    v_cmp_ne_u32 vcc, 0, v14
    s_and_b64 vcc, vcc, s[44:45]
    s_cbranch_vccnz L_osl_240
    s_barrier
    ds_read_b128 v[160:163], v105 offset:0
    ds_read_b128 v[164:167], v105 offset:1024
    ds_read_b128 v[168:171], v105 offset:2048
    ds_read_b128 v[172:175], v105 offset:3088
    v_mfma_f32_32x32x16_bf16 v[64:79], a[20:23], v[148:151], v[64:79]
    ds_read_b128 v[176:179], v105 offset:4128
    ds_read_b128 v[180:183], v105 offset:5152
    v_mfma_f32_32x32x16_bf16 v[64:79], a[24:27], v[152:155], v[64:79]
    ds_read_b128 v[184:187], v105 offset:6176
    ds_read_b128 v[188:191], v105 offset:7216
    v_mfma_f32_32x32x16_bf16 v[64:79], a[28:31], v[156:159], v[64:79]
    ds_read_b128 v[192:195], v106 offset:0
    ds_read_b128 v[196:199], v106 offset:1024
    s_lshl_b32 s48, s3, 11
    s_waitcnt lgkmcnt(9)
    v_mfma_f32_32x32x16_bf16 v[64:79], a[32:35], v[160:163], v[64:79]
    ds_read_b128 v[200:203], v106 offset:2048
    ds_read_b128 v[204:207], v106 offset:3088
    v_bfe_u32 v24, v2, 1, 2
    s_waitcnt lgkmcnt(10)
    v_mfma_f32_32x32x16_bf16 v[64:79], a[36:39], v[164:167], v[64:79]
    ds_read_b128 v[208:211], v106 offset:4128
    ds_read_b128 v[212:215], v106 offset:5152
    v_lshlrev_b32 v24, 4, v24
    s_waitcnt lgkmcnt(11)
    v_mfma_f32_32x32x16_bf16 v[64:79], a[40:43], v[168:171], v[64:79]
    ds_read_b128 v[216:219], v106 offset:6176
    ds_read_b128 v[220:223], v106 offset:7216
    v_lshl_add_u32 v24, v2, 6, v24
    s_waitcnt lgkmcnt(12)
    v_mfma_f32_32x32x16_bf16 v[64:79], a[44:47], v[172:175], v[64:79]
    ds_read_b128 v[224:227], v107 offset:0
    v_lshl_add_u32 v24, v3, 3, v24
    s_waitcnt lgkmcnt(12)
    v_mfma_f32_32x32x16_bf16 v[64:79], a[48:51], v[176:179], v[64:79]
    ds_read_b128 v[228:231], v107 offset:1024
    v_add_u32 v24, s48, v24
    s_waitcnt lgkmcnt(12)
    v_mfma_f32_32x32x16_bf16 v[64:79], a[52:55], v[180:183], v[64:79]
    ds_read_b128 v[232:235], v107 offset:2048
    v_xor_b32 v25, 16, v24
    s_waitcnt lgkmcnt(12)
    v_mfma_f32_32x32x16_bf16 v[64:79], a[56:59], v[184:187], v[64:79]
    ds_read_b128 v[236:239], v107 offset:3088
    v_xor_b32 v26, 32, v24
    s_waitcnt lgkmcnt(12)
    v_mfma_f32_32x32x16_bf16 v[64:79], a[60:63], v[188:191], v[64:79]
    ds_read_b128 v[240:243], v107 offset:4128
    v_xor_b32 v27, 48, v24
    s_waitcnt lgkmcnt(12)
    v_mfma_f32_32x32x16_bf16 v[64:79], a[64:67], v[192:195], v[64:79]
    ds_read_b128 v[244:247], v107 offset:5152
    v_bfe_u32 v28, v1, 3, 2
    s_waitcnt lgkmcnt(12)
    v_mfma_f32_32x32x16_bf16 v[64:79], a[68:71], v[196:199], v[64:79]
    ds_read_b128 v[248:251], v107 offset:6176
    v_lshlrev_b32 v28, 4, v28
    s_waitcnt lgkmcnt(12)
    v_mfma_f32_32x32x16_bf16 v[64:79], a[72:75], v[200:203], v[64:79]
    ds_read_b128 v[252:255], v107 offset:7216
    v_xor_b32 v28, v28, v4
    s_waitcnt lgkmcnt(12)
    v_mfma_f32_32x32x16_bf16 v[64:79], a[76:79], v[204:207], v[64:79]
    v_add_u32 v28, s48, v28
    s_waitcnt lgkmcnt(11)
    v_mfma_f32_32x32x16_bf16 v[64:79], a[80:83], v[208:211], v[64:79]
    v_lshrrev_b32 v29, 2, v1
    s_waitcnt lgkmcnt(10)
    v_mfma_f32_32x32x16_bf16 v[64:79], a[84:87], v[212:215], v[64:79]
    v_lshlrev_b32 v29, 10, v29
    s_waitcnt lgkmcnt(9)
    v_mfma_f32_32x32x16_bf16 v[64:79], a[88:91], v[216:219], v[64:79]
    v_and_b32 v30, 48, v4
    s_waitcnt lgkmcnt(8)
    v_mfma_f32_32x32x16_bf16 v[64:79], a[92:95], v[220:223], v[64:79]
    v_add_u32 v29, v29, v30
    s_waitcnt lgkmcnt(7)
    v_mfma_f32_32x32x16_bf16 v[64:79], a[96:99], v[224:227], v[64:79]
    s_lshl_b32 s46, s55, 15
    s_waitcnt lgkmcnt(6)
    v_mfma_f32_32x32x16_bf16 v[64:79], a[100:103], v[228:231], v[64:79]
    s_lshl_b32 s47, s56, 6
    s_waitcnt lgkmcnt(5)
    v_mfma_f32_32x32x16_bf16 v[64:79], a[104:107], v[232:235], v[64:79]
    s_add_u32 s46, s46, s47
    s_waitcnt lgkmcnt(4)
    v_mfma_f32_32x32x16_bf16 v[64:79], a[108:111], v[236:239], v[64:79]
    s_add_u32 s47, s46, 16384
    s_waitcnt lgkmcnt(3)
    v_mfma_f32_32x32x16_bf16 v[64:79], a[112:115], v[240:243], v[64:79]
    s_waitcnt lgkmcnt(2)
    v_mfma_f32_32x32x16_bf16 v[64:79], a[116:119], v[244:247], v[64:79]
    s_waitcnt lgkmcnt(1)
    v_mfma_f32_32x32x16_bf16 v[64:79], a[120:123], v[248:251], v[64:79]
    s_waitcnt lgkmcnt(0)
    v_mfma_f32_32x32x16_bf16 v[64:79], a[124:127], v[252:255], v[64:79]
L_opD_234:
    s_nop 1
L_last_241:
    s_nop 7
    s_nop 1
    v_cvt_pk_bf16_f32 v96, v64, v65
    v_cvt_pk_bf16_f32 v97, v66, v67
    ds_write_b64 v24, v[96:97] offset:49664
    v_cvt_pk_bf16_f32 v98, v68, v69
    v_cvt_pk_bf16_f32 v99, v70, v71
    ds_write_b64 v25, v[98:99] offset:49664
    v_cvt_pk_bf16_f32 v100, v72, v73
    v_cvt_pk_bf16_f32 v101, v74, v75
    ds_write_b64 v26, v[100:101] offset:49664
    v_cvt_pk_bf16_f32 v102, v76, v77
    v_cvt_pk_bf16_f32 v103, v78, v79
    ds_write_b64 v27, v[102:103] offset:49664
    ds_read_b128 v[104:107], v28 offset:49664
    ds_read_b128 v[108:111], v28 offset:50688
    s_waitcnt lgkmcnt(1)
    buffer_store_dwordx4 v[104:107], v29, s[28:31], s46 offen
    s_waitcnt lgkmcnt(0)
    buffer_store_dwordx4 v[108:111], v29, s[28:31], s47 offen
L_end:
    s_endpgm
L_fsl_5:
    s_mov_b32 s52, 0
    v_lshlrev_b32 v123, 2, v1
    s_cmp_eq_u32 s5, 0
    s_cbranch_scc1 L_fsl_5x
    v_mov_b32 v123, 0
L_fsl_5m:
    buffer_load_dword v21, v123, s[36:39], s99 offen sc1
    s_waitcnt vmcnt(0)
    v_cmp_ne_u32 vcc, -1, v21
    s_cbranch_vccnz L_fbk_6m
    s_sleep 2
    s_add_u32 s52, s52, 1
    s_cmp_lt_u32 s52, 160000
    s_cbranch_scc1 L_fsl_5m
    v_mov_b32 v21, 26112
    s_branch L_fbk_6m
L_fsl_5x:
    s_sleep 4
    buffer_load_dword v20, v123, s[32:35], 0 offen sc1
    s_waitcnt vmcnt(0)
    v_and_b32 v21, 0x80808080, v20
    v_cmp_ne_u32 vcc, 0x80808080, v21
    s_cbranch_vccz L_fbk_6
    s_add_u32 s52, s52, 1
    s_cmp_lt_u32 s52, 40000
    s_cbranch_scc1 L_fsl_5x
    s_mov_b32 s71, 100
    s_branch L_fbk_6
L_stsl_7:
    buffer_store_dwordx4 v[20:23], v4, s[28:31], s61 offen sc1
    buffer_store_dwordx4 v[20:23], v4, s[28:31], s61 offen offset:1024 sc1
    s_branch L_stdn_8
L_stsl_9:
    buffer_store_dwordx4 v[20:23], v4, s[36:39], s58 offen sc1
    buffer_store_dwordx4 v[20:23], v4, s[36:39], s58 offen offset:1024 sc1
    s_branch L_stdn_10
L_stsl_11:
    buffer_store_dwordx2 v[20:21], v15, s[36:39], s62 offen sc1
    s_branch L_stdn_12
L_kw_13:
    s_mov_b32 s52, 0
L_kw_13l:
    buffer_load_dwordx2 v[48:49], v50, s[36:39], s80 offen offset:16 sc1
    s_waitcnt vmcnt(0)
    v_or_b32 v48, v48, v49
    v_cmp_ne_u32 vcc, 0, v48
    s_cbranch_vccz L_kb_14
    s_add_u32 s52, s52, 1
    s_cmp_lt_u32 s52, 40000
    s_cbranch_scc1 L_kw_13l
    s_mov_b64 s[44:45], 0
    s_mov_b32 s71, 11
    s_branch L_kb_14
L_slow_20:
    s_mov_b32 s52, 0
L_sloop_22:
    s_add_u32 m0, s81, 0
    s_nop 0
    buffer_load_dwordx4 v4, s[36:39], s76 offen offset:0 sc1 lds
    buffer_load_dwordx4 v4, s[36:39], s76 offen offset:1024 sc1 lds
    buffer_load_dwordx4 v4, s[36:39], s76 offen offset:2048 sc1 lds
    s_add_u32 m0, s81, 16
    s_nop 0
    buffer_load_dwordx4 v4, s[36:39], s76 offen offset:3072 sc1 lds
    s_add_u32 m0, s81, 4128
    s_nop 0
    buffer_load_dwordx4 v4, s[36:39], s77 offen offset:0 sc1 lds
    buffer_load_dwordx4 v4, s[36:39], s77 offen offset:1024 sc1 lds
    buffer_load_dwordx4 v4, s[36:39], s77 offen offset:2048 sc1 lds
    s_add_u32 m0, s81, 4144
    s_nop 0
    buffer_load_dwordx4 v4, s[36:39], s77 offen offset:3072 sc1 lds
    s_waitcnt vmcnt(0)
    ds_read_b32 v40, v27 offset:0
    ds_read_b32 v41, v27 offset:1024
    ds_read_b32 v42, v27 offset:2048
    ds_read_b32 v43, v27 offset:3088
    ds_read_b32 v44, v27 offset:4128
    ds_read_b32 v45, v27 offset:5152
    ds_read_b32 v46, v27 offset:6176
    ds_read_b32 v47, v27 offset:7216
    s_waitcnt lgkmcnt(0)
    s_waitcnt vmcnt(0)
    v_xor_b32 v14, s27, v40
    v_bitop3_b32 v14, v14, v41, s27 bitop3:0xf6
    v_bitop3_b32 v14, v14, v42, s27 bitop3:0xf6
    v_bitop3_b32 v14, v14, v43, s27 bitop3:0xf6
    v_bitop3_b32 v14, v14, v44, s27 bitop3:0xf6
    v_bitop3_b32 v14, v14, v45, s27 bitop3:0xf6
    v_bitop3_b32 v14, v14, v46, s27 bitop3:0xf6
    v_bitop3_b32 v14, v14, v47, s27 bitop3:0xf6
    v_and_b32 v14, 0x10000, v14
    v_cmp_ne_u32 vcc, 0, v14
    s_cbranch_vccz L_back_21
    s_add_u32 s52, s52, 1
    s_cmp_lt_u32 s52, 40000
    s_cbranch_scc1 L_sloop_22
    s_mov_b64 s[44:45], 0
    s_mov_b32 s71, 10
    s_branch L_back_21
L_stsl_33:
    buffer_store_dwordx4 v[68:71], v4, s[36:39], s83 offen sc1
    s_branch L_stdn_34
L_stsl_35:
    buffer_store_dwordx4 v[64:67], v4, s[36:39], s82 offen sc1
    s_branch L_stdn_36
L_ocl_39:
    s_mov_b32 s52, 0
L_ocl_39l:
    buffer_load_dword v36, v37, s[36:39], s80 offen offset:12 sc1
    s_add_u32 s52, s52, 1
    s_cmp_lt_u32 s52, 40000
    s_cselect_b64 s[44:45], s[44:45], 0
    s_cselect_b32 s71, s71, 31
    s_waitcnt vmcnt(0)
    v_cmp_eq_u32 vcc, -1, v36
    s_and_b64 vcc, vcc, s[44:45]
    s_cbranch_vccnz L_ocl_39l
    s_branch L_ock_40
L_osl_49:
    s_add_u32 m0, s81, 0
    s_nop 0
    buffer_load_dwordx4 v4, s[36:39], s76 offen offset:0 sc1 lds
    buffer_load_dwordx4 v4, s[36:39], s76 offen offset:1024 sc1 lds
    buffer_load_dwordx4 v4, s[36:39], s76 offen offset:2048 sc1 lds
    s_add_u32 m0, s81, 16
    s_nop 0
    buffer_load_dwordx4 v4, s[36:39], s76 offen offset:3072 sc1 lds
    s_add_u32 m0, s81, 4128
    s_nop 0
    buffer_load_dwordx4 v4, s[36:39], s77 offen offset:0 sc1 lds
    buffer_load_dwordx4 v4, s[36:39], s77 offen offset:1024 sc1 lds
    buffer_load_dwordx4 v4, s[36:39], s77 offen offset:2048 sc1 lds
    s_add_u32 m0, s81, 4144
    s_nop 0
    buffer_load_dwordx4 v4, s[36:39], s77 offen offset:3072 sc1 lds
    s_add_u32 s52, s52, 1
    s_cmp_lt_u32 s52, 40000
    s_cselect_b64 s[44:45], s[44:45], 0
    s_cselect_b32 s71, s71, 30
    v_lshlrev_b32 v64, 16, v96
    v_and_b32 v65, 0xffff0000, v96
    v_lshlrev_b32 v66, 16, v97
    v_and_b32 v67, 0xffff0000, v97
    v_lshlrev_b32 v68, 16, v98
    v_and_b32 v69, 0xffff0000, v98
    v_lshlrev_b32 v70, 16, v99
    v_and_b32 v71, 0xffff0000, v99
    v_lshlrev_b32 v72, 16, v100
    v_and_b32 v73, 0xffff0000, v100
    v_lshlrev_b32 v74, 16, v101
    v_and_b32 v75, 0xffff0000, v101
    v_lshlrev_b32 v76, 16, v102
    v_and_b32 v77, 0xffff0000, v102
    v_lshlrev_b32 v78, 16, v103
    v_and_b32 v79, 0xffff0000, v103
    s_branch L_ort_48
L_stsl_51:
    buffer_store_dwordx4 v[96:99], v4, s[28:31], s61 offen sc1
    buffer_store_dwordx4 v[100:103], v4, s[28:31], s61 offen offset:1024 sc1
    s_branch L_stdn_52
L_stsl_54:
    buffer_store_dwordx2 v[20:21], v14, s[36:39], s62 offen sc1
    s_branch L_stdn_55
L_xrs_62:
    s_waitcnt vmcnt(0) lgkmcnt(0)
    s_add_u32 s89, s89, 1
    s_cmp_lt_u32 s89, 40000
    s_cselect_b64 s[44:45], s[44:45], 0
L_xpf_60:
    s_mov_b32 s52, 0
    buffer_load_dword v20, v108, s[28:31], s57 offen sc1
    s_waitcnt vmcnt(1)
    v_xor_b32 v14, s75, v128
    v_bitop3_b32 v14, v14, v132, s75 bitop3:0xf6
    v_bitop3_b32 v14, v14, v136, s75 bitop3:0xf6
    v_bitop3_b32 v14, v14, v140, s75 bitop3:0xf6
    v_bitop3_b32 v14, v14, v144, s75 bitop3:0xf6
    v_bitop3_b32 v14, v14, v148, s75 bitop3:0xf6
    v_bitop3_b32 v14, v14, v152, s75 bitop3:0xf6
    v_bitop3_b32 v14, v14, v156, s75 bitop3:0xf6
    v_and_b32 v14, 0x10000, v14
    v_cmp_ne_u32 vcc, 0, v14
    s_mov_b64 s[68:69], vcc
    s_sleep 1
    buffer_load_dword v21, v108, s[28:31], s57 offen sc1
L_pl_63:
    s_waitcnt vmcnt(1)
    v_xor_b32 v14, s75, v20
    v_and_b32 v14, 0x10000, v14
    v_cmp_ne_u32 vcc, 0, v14
    s_and_b64 vcc, vcc, s[44:45]
    s_cbranch_vccz L_pd_64
    buffer_load_dword v20, v108, s[28:31], s57 offen sc1
    s_waitcnt vmcnt(1)
    v_xor_b32 v14, s75, v21
    v_and_b32 v14, 0x10000, v14
    v_cmp_ne_u32 vcc, 0, v14
    s_and_b64 vcc, vcc, s[44:45]
    s_cbranch_vccz L_pd_64
    buffer_load_dword v21, v108, s[28:31], s57 offen sc1
    s_add_u32 s52, s52, 1
    s_cmp_lt_u32 s52, 40000
    s_cbranch_scc1 L_pl_63
    s_mov_b64 s[44:45], 0
    s_mov_b32 s71, 1
L_pd_64:
    v_mov_b32 v109, s75
    s_cmp_eq_u64 s[68:69], 0
    s_cbranch_scc1 L_xpb_61
    buffer_load_dwordx4 v[128:131], v4, s[28:31], s78 offen offset:0 sc1
    buffer_load_dwordx4 v[132:135], v4, s[28:31], s78 offen offset:1024 sc1
    buffer_load_dwordx4 v[136:139], v4, s[28:31], s78 offen offset:2048 sc1
    buffer_load_dwordx4 v[140:143], v4, s[28:31], s78 offen offset:3072 sc1
    buffer_load_dwordx4 v[144:147], v4, s[28:31], s79 offen offset:0 sc1
    buffer_load_dwordx4 v[148:151], v4, s[28:31], s79 offen offset:1024 sc1
    buffer_load_dwordx4 v[152:155], v4, s[28:31], s79 offen offset:2048 sc1
    buffer_load_dwordx4 v[156:159], v4, s[28:31], s79 offen offset:3072 sc1
    v_mov_b32 v109, s75
    s_branch L_xpb_61
L_slow_103:
    s_mov_b32 s52, 0
L_sloop_105:
    s_add_u32 m0, s81, 0
    s_nop 0
    buffer_load_dwordx4 v4, s[36:39], s76 offen offset:0 sc1 lds
    s_waitcnt vmcnt(0)
    ds_read_b32 v40, v27 offset:0
    s_waitcnt lgkmcnt(0)
    s_waitcnt vmcnt(0)
    v_xor_b32 v14, s27, v40
    v_and_b32 v14, 0x10000, v14
    v_cmp_ne_u32 vcc, 0, v14
    s_cbranch_vccz L_back_104
    s_add_u32 s52, s52, 1
    s_cmp_lt_u32 s52, 40000
    s_cbranch_scc1 L_sloop_105
    s_mov_b64 s[44:45], 0
    s_mov_b32 s71, 10
    s_branch L_back_104
L_stsl_116:
    buffer_store_dwordx4 v[64:67], v4, s[36:39], s58 offen sc1
    s_branch L_stdn_117
L_stsl_118:
    buffer_store_dwordx4 v[68:71], v4, s[36:39], s58 offen offset:1024 sc1
    s_branch L_stdn_119
L_osl_132:
    s_add_u32 m0, s81, 0
    s_nop 0
    buffer_load_dwordx4 v4, s[36:39], s76 offen offset:0 sc1 lds
    buffer_load_dwordx4 v4, s[36:39], s76 offen offset:1024 sc1 lds
    buffer_load_dwordx4 v4, s[36:39], s76 offen offset:2048 sc1 lds
    s_add_u32 m0, s81, 16
    s_nop 0
    buffer_load_dwordx4 v4, s[36:39], s76 offen offset:3072 sc1 lds
    s_add_u32 m0, s81, 4128
    s_nop 0
    buffer_load_dwordx4 v4, s[36:39], s77 offen offset:0 sc1 lds
    buffer_load_dwordx4 v4, s[36:39], s77 offen offset:1024 sc1 lds
    buffer_load_dwordx4 v4, s[36:39], s77 offen offset:2048 sc1 lds
    s_add_u32 m0, s81, 4144
    s_nop 0
    buffer_load_dwordx4 v4, s[36:39], s77 offen offset:3072 sc1 lds
    s_add_u32 s52, s52, 1
    s_cmp_lt_u32 s52, 40000
    s_cselect_b64 s[44:45], s[44:45], 0
    s_cselect_b32 s71, s71, 30
    v_lshlrev_b32 v64, 16, v96
    v_and_b32 v65, 0xffff0000, v96
    v_lshlrev_b32 v66, 16, v97
    v_and_b32 v67, 0xffff0000, v97
    v_lshlrev_b32 v68, 16, v98
    v_and_b32 v69, 0xffff0000, v98
    v_lshlrev_b32 v70, 16, v99
    v_and_b32 v71, 0xffff0000, v99
    v_lshlrev_b32 v72, 16, v100
    v_and_b32 v73, 0xffff0000, v100
    v_lshlrev_b32 v74, 16, v101
    v_and_b32 v75, 0xffff0000, v101
    v_lshlrev_b32 v76, 16, v102
    v_and_b32 v77, 0xffff0000, v102
    v_lshlrev_b32 v78, 16, v103
    v_and_b32 v79, 0xffff0000, v103
    s_branch L_ort_131
L_stsl_134:
    buffer_store_dwordx4 v[96:99], v4, s[28:31], s61 offen sc1
    buffer_store_dwordx4 v[100:103], v4, s[28:31], s61 offen offset:1024 sc1
    s_branch L_stdn_135
L_stsl_137:
    buffer_store_dwordx2 v[20:21], v14, s[36:39], s62 offen sc1
    s_branch L_stdn_138
L_xrs_147:
    s_waitcnt vmcnt(0) lgkmcnt(0)
    s_add_u32 s89, s89, 1
    s_cmp_lt_u32 s89, 40000
    s_cselect_b64 s[44:45], s[44:45], 0
L_xpf_145:
    s_mov_b32 s52, 0
    buffer_load_dword v20, v108, s[28:31], s57 offen sc1
    s_waitcnt vmcnt(1)
    v_xor_b32 v14, s75, v128
    v_bitop3_b32 v14, v14, v132, s75 bitop3:0xf6
    v_bitop3_b32 v14, v14, v136, s75 bitop3:0xf6
    v_bitop3_b32 v14, v14, v140, s75 bitop3:0xf6
    v_bitop3_b32 v14, v14, v144, s75 bitop3:0xf6
    v_bitop3_b32 v14, v14, v148, s75 bitop3:0xf6
    v_bitop3_b32 v14, v14, v152, s75 bitop3:0xf6
    v_bitop3_b32 v14, v14, v156, s75 bitop3:0xf6
    v_and_b32 v14, 0x10000, v14
    v_cmp_ne_u32 vcc, 0, v14
    s_mov_b64 s[68:69], vcc
    s_sleep 1
    buffer_load_dword v21, v108, s[28:31], s57 offen sc1
L_pl_148:
    s_waitcnt vmcnt(1)
    v_xor_b32 v14, s75, v20
    v_and_b32 v14, 0x10000, v14
    v_cmp_ne_u32 vcc, 0, v14
    s_and_b64 vcc, vcc, s[44:45]
    s_cbranch_vccz L_pd_149
    buffer_load_dword v20, v108, s[28:31], s57 offen sc1
    s_waitcnt vmcnt(1)
    v_xor_b32 v14, s75, v21
    v_and_b32 v14, 0x10000, v14
    v_cmp_ne_u32 vcc, 0, v14
    s_and_b64 vcc, vcc, s[44:45]
    s_cbranch_vccz L_pd_149
    buffer_load_dword v21, v108, s[28:31], s57 offen sc1
    s_add_u32 s52, s52, 1
    s_cmp_lt_u32 s52, 40000
    s_cbranch_scc1 L_pl_148
    s_mov_b64 s[44:45], 0
    s_mov_b32 s71, 1
L_pd_149:
    v_mov_b32 v109, s75
    s_cmp_eq_u64 s[68:69], 0
    s_cbranch_scc1 L_xpb_146
    buffer_load_dwordx4 v[128:131], v4, s[28:31], s78 offen offset:0 sc1
    buffer_load_dwordx4 v[132:135], v4, s[28:31], s78 offen offset:1024 sc1
    buffer_load_dwordx4 v[136:139], v4, s[28:31], s78 offen offset:2048 sc1
    buffer_load_dwordx4 v[140:143], v4, s[28:31], s78 offen offset:3072 sc1
    buffer_load_dwordx4 v[144:147], v4, s[28:31], s79 offen offset:0 sc1
    buffer_load_dwordx4 v[148:151], v4, s[28:31], s79 offen offset:1024 sc1
    buffer_load_dwordx4 v[152:155], v4, s[28:31], s79 offen offset:2048 sc1
    buffer_load_dwordx4 v[156:159], v4, s[28:31], s79 offen offset:3072 sc1
    v_mov_b32 v109, s75
    s_branch L_xpb_146
L_fsl_152:
    s_mov_b32 s52, 0
L_flp_153:
    v_and_b32 v14, 1, v1
    v_lshlrev_b32 v14, 2, v14
    buffer_load_dword v20, v14, s[36:39], s99 offen offset:4 sc1
    s_waitcnt vmcnt(0)
    v_cmp_eq_u32 vcc, -1, v20
    s_nop 3
    s_and_b32 s69, s68, vcc_lo
    s_cbranch_scc0 L_fsk_151
    s_sleep 2
    s_add_u32 s52, s52, 1
    s_cmp_lt_u32 s52, 40000
    s_cbranch_scc1 L_flp_153
    s_mov_b64 s[44:45], 0
    s_mov_b32 s71, 101
    s_branch L_fsk_151
L_slow_162:
    s_mov_b32 s52, 0
L_sloop_164:
    s_add_u32 m0, s81, 0
    s_nop 0
    buffer_load_dwordx4 v4, s[36:39], s76 offen offset:0 sc1 lds
    buffer_load_dwordx4 v4, s[36:39], s76 offen offset:1024 sc1 lds
    buffer_load_dwordx4 v4, s[36:39], s76 offen offset:2048 sc1 lds
    s_add_u32 m0, s81, 16
    s_nop 0
    buffer_load_dwordx4 v4, s[36:39], s76 offen offset:3072 sc1 lds
    s_add_u32 m0, s81, 4128
    s_nop 0
    buffer_load_dwordx4 v4, s[36:39], s77 offen offset:0 sc1 lds
    buffer_load_dwordx4 v4, s[36:39], s77 offen offset:1024 sc1 lds
    buffer_load_dwordx4 v4, s[36:39], s77 offen offset:2048 sc1 lds
    s_add_u32 m0, s81, 4144
    s_nop 0
    buffer_load_dwordx4 v4, s[36:39], s77 offen offset:3072 sc1 lds
    s_waitcnt vmcnt(0)
    ds_read_b32 v40, v27 offset:0
    ds_read_b32 v41, v27 offset:1024
    ds_read_b32 v42, v27 offset:2048
    ds_read_b32 v43, v27 offset:3088
    ds_read_b32 v44, v27 offset:4128
    ds_read_b32 v45, v27 offset:5152
    ds_read_b32 v46, v27 offset:6176
    ds_read_b32 v47, v27 offset:7216
    s_waitcnt lgkmcnt(0)
    s_waitcnt vmcnt(0)
    v_xor_b32 v14, s27, v40
    v_bitop3_b32 v14, v14, v41, s27 bitop3:0xf6
    v_bitop3_b32 v14, v14, v42, s27 bitop3:0xf6
    v_bitop3_b32 v14, v14, v43, s27 bitop3:0xf6
    v_bitop3_b32 v14, v14, v44, s27 bitop3:0xf6
    v_bitop3_b32 v14, v14, v45, s27 bitop3:0xf6
    v_bitop3_b32 v14, v14, v46, s27 bitop3:0xf6
    v_bitop3_b32 v14, v14, v47, s27 bitop3:0xf6
    v_and_b32 v14, 0x10000, v14
    v_cmp_ne_u32 vcc, 0, v14
    s_cbranch_vccz L_back_163
    s_add_u32 s52, s52, 1
    s_cmp_lt_u32 s52, 40000
    s_cbranch_scc1 L_sloop_164
    s_mov_b64 s[44:45], 0
    s_mov_b32 s71, 10
    s_branch L_back_163
L_stsl_174:
    buffer_store_dwordx4 v[68:71], v4, s[36:39], s83 offen sc1
    s_branch L_stdn_175
L_stsl_176:
    buffer_store_dwordx4 v[64:67], v4, s[36:39], s82 offen sc1
    s_branch L_stdn_177
L_osl_190:
    s_add_u32 m0, s81, 0
    s_nop 0
    buffer_load_dwordx4 v4, s[36:39], s76 offen offset:0 sc1 lds
    buffer_load_dwordx4 v4, s[36:39], s76 offen offset:1024 sc1 lds
    buffer_load_dwordx4 v4, s[36:39], s76 offen offset:2048 sc1 lds
    s_add_u32 m0, s81, 16
    s_nop 0
    buffer_load_dwordx4 v4, s[36:39], s76 offen offset:3072 sc1 lds
    s_add_u32 m0, s81, 4128
    s_nop 0
    buffer_load_dwordx4 v4, s[36:39], s77 offen offset:0 sc1 lds
    buffer_load_dwordx4 v4, s[36:39], s77 offen offset:1024 sc1 lds
    buffer_load_dwordx4 v4, s[36:39], s77 offen offset:2048 sc1 lds
    s_add_u32 m0, s81, 4144
    s_nop 0
    buffer_load_dwordx4 v4, s[36:39], s77 offen offset:3072 sc1 lds
    s_add_u32 s52, s52, 1
    s_cmp_lt_u32 s52, 40000
    s_cselect_b64 s[44:45], s[44:45], 0
    s_cselect_b32 s71, s71, 30
    v_lshlrev_b32 v64, 16, v96
    v_and_b32 v65, 0xffff0000, v96
    v_lshlrev_b32 v66, 16, v97
    v_and_b32 v67, 0xffff0000, v97
    v_lshlrev_b32 v68, 16, v98
    v_and_b32 v69, 0xffff0000, v98
    v_lshlrev_b32 v70, 16, v99
    v_and_b32 v71, 0xffff0000, v99
    v_lshlrev_b32 v72, 16, v100
    v_and_b32 v73, 0xffff0000, v100
    v_lshlrev_b32 v74, 16, v101
    v_and_b32 v75, 0xffff0000, v101
    v_lshlrev_b32 v76, 16, v102
    v_and_b32 v77, 0xffff0000, v102
    v_lshlrev_b32 v78, 16, v103
    v_and_b32 v79, 0xffff0000, v103
    s_branch L_ort_189
L_stsl_192:
    buffer_store_dwordx4 v[96:99], v4, s[28:31], s61 offen sc1
    buffer_store_dwordx4 v[100:103], v4, s[28:31], s61 offen offset:1024 sc1
    s_branch L_stdn_193
L_stsl_195:
    buffer_store_dwordx2 v[20:21], v14, s[36:39], s62 offen sc1
    s_branch L_stdn_196
L_xrs_203:
    s_waitcnt vmcnt(0) lgkmcnt(0)
    s_add_u32 s89, s89, 1
    s_cmp_lt_u32 s89, 40000
    s_cselect_b64 s[44:45], s[44:45], 0
L_xpf_201:
    s_mov_b32 s52, 0
    buffer_load_dword v20, v108, s[28:31], s57 offen sc1
    s_waitcnt vmcnt(1)
    v_xor_b32 v14, s75, v128
    v_bitop3_b32 v14, v14, v132, s75 bitop3:0xf6
    v_bitop3_b32 v14, v14, v136, s75 bitop3:0xf6
    v_bitop3_b32 v14, v14, v140, s75 bitop3:0xf6
    v_bitop3_b32 v14, v14, v144, s75 bitop3:0xf6
    v_bitop3_b32 v14, v14, v148, s75 bitop3:0xf6
    v_bitop3_b32 v14, v14, v152, s75 bitop3:0xf6
    v_bitop3_b32 v14, v14, v156, s75 bitop3:0xf6
    v_and_b32 v14, 0x10000, v14
    v_cmp_ne_u32 vcc, 0, v14
    s_mov_b64 s[68:69], vcc
    s_sleep 1
    buffer_load_dword v21, v108, s[28:31], s57 offen sc1
L_pl_204:
    s_waitcnt vmcnt(1)
    v_xor_b32 v14, s75, v20
    v_and_b32 v14, 0x10000, v14
    v_cmp_ne_u32 vcc, 0, v14
    s_and_b64 vcc, vcc, s[44:45]
    s_cbranch_vccz L_pd_205
    buffer_load_dword v20, v108, s[28:31], s57 offen sc1
    s_waitcnt vmcnt(1)
    v_xor_b32 v14, s75, v21
    v_and_b32 v14, 0x10000, v14
    v_cmp_ne_u32 vcc, 0, v14
    s_and_b64 vcc, vcc, s[44:45]
    s_cbranch_vccz L_pd_205
    buffer_load_dword v21, v108, s[28:31], s57 offen sc1
    s_add_u32 s52, s52, 1
    s_cmp_lt_u32 s52, 40000
    s_cbranch_scc1 L_pl_204
    s_mov_b64 s[44:45], 0
    s_mov_b32 s71, 1
L_pd_205:
    v_mov_b32 v109, s75
    s_cmp_eq_u64 s[68:69], 0
    s_cbranch_scc1 L_xpb_202
    buffer_load_dwordx4 v[128:131], v4, s[28:31], s78 offen offset:0 sc1
    buffer_load_dwordx4 v[132:135], v4, s[28:31], s78 offen offset:1024 sc1
    buffer_load_dwordx4 v[136:139], v4, s[28:31], s78 offen offset:2048 sc1
    buffer_load_dwordx4 v[140:143], v4, s[28:31], s78 offen offset:3072 sc1
    buffer_load_dwordx4 v[144:147], v4, s[28:31], s79 offen offset:0 sc1
    buffer_load_dwordx4 v[148:151], v4, s[28:31], s79 offen offset:1024 sc1
    buffer_load_dwordx4 v[152:155], v4, s[28:31], s79 offen offset:2048 sc1
    buffer_load_dwordx4 v[156:159], v4, s[28:31], s79 offen offset:3072 sc1
    v_mov_b32 v109, s75
    s_branch L_xpb_202
L_slow_212:
    s_mov_b32 s52, 0
L_sloop_214:
    s_add_u32 m0, s81, 0
    s_nop 0
    buffer_load_dwordx4 v4, s[36:39], s76 offen offset:0 sc1 lds
    s_waitcnt vmcnt(0)
    ds_read_b32 v40, v27 offset:0
    s_waitcnt lgkmcnt(0)
    s_waitcnt vmcnt(0)
    v_xor_b32 v14, s27, v40
    v_and_b32 v14, 0x10000, v14
    v_cmp_ne_u32 vcc, 0, v14
    s_cbranch_vccz L_back_213
    s_add_u32 s52, s52, 1
    s_cmp_lt_u32 s52, 40000
    s_cbranch_scc1 L_sloop_214
    s_mov_b64 s[44:45], 0
    s_mov_b32 s71, 10
    s_branch L_back_213
L_stsl_224:
    buffer_store_dwordx4 v[64:67], v4, s[36:39], s58 offen sc1
    s_branch L_stdn_225
L_stsl_226:
    buffer_store_dwordx4 v[68:71], v4, s[36:39], s58 offen offset:1024 sc1
    s_branch L_stdn_227
L_osl_240:
    s_add_u32 m0, s81, 0
    s_nop 0
    buffer_load_dwordx4 v4, s[36:39], s76 offen offset:0 sc1 lds
    buffer_load_dwordx4 v4, s[36:39], s76 offen offset:1024 sc1 lds
    buffer_load_dwordx4 v4, s[36:39], s76 offen offset:2048 sc1 lds
    s_add_u32 m0, s81, 16
    s_nop 0
    buffer_load_dwordx4 v4, s[36:39], s76 offen offset:3072 sc1 lds
    s_add_u32 m0, s81, 4128
    s_nop 0
    buffer_load_dwordx4 v4, s[36:39], s77 offen offset:0 sc1 lds
    buffer_load_dwordx4 v4, s[36:39], s77 offen offset:1024 sc1 lds
    buffer_load_dwordx4 v4, s[36:39], s77 offen offset:2048 sc1 lds
    s_add_u32 m0, s81, 4144
    s_nop 0
    buffer_load_dwordx4 v4, s[36:39], s77 offen offset:3072 sc1 lds
    s_add_u32 s52, s52, 1
    s_cmp_lt_u32 s52, 40000
    s_cselect_b64 s[44:45], s[44:45], 0
    s_cselect_b32 s71, s71, 30
    v_lshlrev_b32 v64, 16, v96
    v_and_b32 v65, 0xffff0000, v96
    v_lshlrev_b32 v66, 16, v97
    v_and_b32 v67, 0xffff0000, v97
    v_lshlrev_b32 v68, 16, v98
    v_and_b32 v69, 0xffff0000, v98
    v_lshlrev_b32 v70, 16, v99
    v_and_b32 v71, 0xffff0000, v99
    v_lshlrev_b32 v72, 16, v100
    v_and_b32 v73, 0xffff0000, v100
    v_lshlrev_b32 v74, 16, v101
    v_and_b32 v75, 0xffff0000, v101
    v_lshlrev_b32 v76, 16, v102
    v_and_b32 v77, 0xffff0000, v102
    v_lshlrev_b32 v78, 16, v103
    v_and_b32 v79, 0xffff0000, v103
    s_branch L_ort_239
L_codeend:
L_fb_24:
    s_ashr_i32 s51, s92, 15
    s_add_u32 s51, s51, s54
    v_mov_b32 v25, 0xff800000
    s_mov_b32 s50, 0
L_fbA_27:
    s_cmp_eq_u32 s50, 0
    s_cselect_b32 s48, 0, 4
    s_cmp_eq_u32 s50, 8
    s_cselect_b32 s48, 1, s48
    s_cmp_gt_u32 s50, s51
    s_cselect_b32 s48, 5, s48
    s_lshl_b32 s48, s48, 8
    v_lshlrev_b32 v14, 2, v3
    v_sub_u32 v14, v14, v2
    v_lshlrev_b32 v14, 2, v14
    v_add_u32 v14, 60032, v14
    v_add_u32 v14, s48, v14
    ds_read2_b32 v[232:233], v14 offset0:0 offset1:1
    ds_read2_b32 v[234:235], v14 offset0:2 offset1:3
    ds_read2_b32 v[236:237], v14 offset0:8 offset1:9
    ds_read2_b32 v[238:239], v14 offset0:10 offset1:11
    ds_read2_b32 v[240:241], v14 offset0:16 offset1:17
    ds_read2_b32 v[242:243], v14 offset0:18 offset1:19
    ds_read2_b32 v[244:245], v14 offset0:24 offset1:25
    ds_read2_b32 v[246:247], v14 offset0:26 offset1:27
    s_mul_i32 s49, s50, 4128
    s_sub_u32 s49, 33024, s49
    v_add_u32 v26, s49, v248
    v_add_u32 v28, s49, v249
    ds_read_b128 v[160:163], v26 offset:0
    s_waitcnt lgkmcnt(0)
    v_mfma_f32_32x32x16_bf16 v[64:79], v[160:163], v[16:19], v[232:247]
    s_nop 7
    s_nop 7
    v_max3_f32 v25, v25, v64, v65
    v_max3_f32 v25, v25, v66, v67
    v_max3_f32 v25, v25, v68, v69
    v_max3_f32 v25, v25, v70, v71
    v_max3_f32 v25, v25, v72, v73
    v_max3_f32 v25, v25, v74, v75
    v_max3_f32 v25, v25, v76, v77
    v_max3_f32 v25, v25, v78, v79
    s_add_u32 s50, s50, 1
    s_cmp_le_u32 s50, 8
    s_cbranch_scc1 L_fbA_27
    v_mov_b32 v27, v25
    s_nop 1
    v_permlane32_swap_b32 v25, v27
    s_nop 1
    v_max_f32 v25, v25, v27
    v_mov_b32 v96, 0
    v_mov_b32 v97, 0
    v_mov_b32 v98, 0
    v_mov_b32 v99, 0
    v_mov_b32 v100, 0
    v_mov_b32 v101, 0
    v_mov_b32 v102, 0
    v_mov_b32 v103, 0
    v_mov_b32 v104, 0
    v_mov_b32 v105, 0
    v_mov_b32 v106, 0
    v_mov_b32 v107, 0
    v_mov_b32 v108, 0
    v_mov_b32 v109, 0
    v_mov_b32 v110, 0
    v_mov_b32 v111, 0
    s_mov_b32 s50, 0
L_fbB_28:
    s_cmp_eq_u32 s50, 0
    s_cselect_b32 s48, 0, 4
    s_cmp_eq_u32 s50, 8
    s_cselect_b32 s48, 1, s48
    s_cmp_gt_u32 s50, s51
    s_cselect_b32 s48, 5, s48
    s_lshl_b32 s48, s48, 8
    v_lshlrev_b32 v14, 2, v3
    v_sub_u32 v14, v14, v2
    v_lshlrev_b32 v14, 2, v14
    v_add_u32 v14, 60032, v14
    v_add_u32 v14, s48, v14
    ds_read2_b32 v[232:233], v14 offset0:0 offset1:1
    ds_read2_b32 v[234:235], v14 offset0:2 offset1:3
    ds_read2_b32 v[236:237], v14 offset0:8 offset1:9
    ds_read2_b32 v[238:239], v14 offset0:10 offset1:11
    ds_read2_b32 v[240:241], v14 offset0:16 offset1:17
    ds_read2_b32 v[242:243], v14 offset0:18 offset1:19
    ds_read2_b32 v[244:245], v14 offset0:24 offset1:25
    ds_read2_b32 v[246:247], v14 offset0:26 offset1:27
    s_mul_i32 s49, s50, 4128
    s_sub_u32 s49, 33024, s49
    v_add_u32 v26, s49, v248
    v_add_u32 v28, s49, v249
    ds_read_b128 v[160:163], v26 offset:0
    ds_read_b128 v[164:167], v28 offset:2048
    ds_read_b128 v[168:171], v28 offset:3088
    s_waitcnt lgkmcnt(0)
    v_mfma_f32_32x32x16_bf16 v[64:79], v[160:163], v[16:19], v[232:247]
    s_nop 7
    s_nop 7
    v_sub_f32 v64, v64, v25
    v_sub_f32 v65, v65, v25
    v_sub_f32 v66, v66, v25
    v_sub_f32 v67, v67, v25
    v_sub_f32 v68, v68, v25
    v_sub_f32 v69, v69, v25
    v_sub_f32 v70, v70, v25
    v_sub_f32 v71, v71, v25
    v_sub_f32 v72, v72, v25
    v_sub_f32 v73, v73, v25
    v_sub_f32 v74, v74, v25
    v_sub_f32 v75, v75, v25
    v_sub_f32 v76, v76, v25
    v_sub_f32 v77, v77, v25
    v_sub_f32 v78, v78, v25
    v_sub_f32 v79, v79, v25
    v_exp_f32 v64, v64
    v_exp_f32 v65, v65
    v_exp_f32 v66, v66
    v_exp_f32 v67, v67
    v_exp_f32 v68, v68
    v_exp_f32 v69, v69
    v_exp_f32 v70, v70
    v_exp_f32 v71, v71
    v_exp_f32 v72, v72
    v_exp_f32 v73, v73
    v_exp_f32 v74, v74
    v_exp_f32 v75, v75
    v_exp_f32 v76, v76
    v_exp_f32 v77, v77
    v_exp_f32 v78, v78
    v_exp_f32 v79, v79
    s_nop 0
    v_cvt_pk_bf16_f32 v64, v64, v65
    v_cvt_pk_bf16_f32 v65, v66, v67
    v_cvt_pk_bf16_f32 v66, v68, v69
    v_cvt_pk_bf16_f32 v67, v70, v71
    v_cvt_pk_bf16_f32 v68, v72, v73
    v_cvt_pk_bf16_f32 v69, v74, v75
    v_cvt_pk_bf16_f32 v70, v76, v77
    v_cvt_pk_bf16_f32 v71, v78, v79
    s_nop 1
    v_mfma_f32_32x32x16_bf16 v[96:111], v[164:167], v[64:67], v[96:111]
L_fbv_29:
    v_mfma_f32_32x32x16_bf16 v[96:111], v[168:171], v[68:71], v[96:111]
    s_nop 7
    s_nop 7
    s_add_u32 s50, s50, 1
    s_cmp_le_u32 s50, 8
    s_cbranch_scc1 L_fbB_28
    s_ashr_i32 s51, s94, 15
    s_add_u32 s51, s51, s54
    v_mov_b32 v25, 0xff800000
    s_mov_b32 s50, 0
L_fbA_30:
    s_cmp_eq_u32 s50, 0
    s_cselect_b32 s48, 0, 4
    s_cmp_eq_u32 s50, 8
    s_cselect_b32 s48, 1, s48
    s_cmp_gt_u32 s50, s51
    s_cselect_b32 s48, 5, s48
    s_lshl_b32 s48, s48, 8
    v_lshlrev_b32 v14, 2, v3
    v_sub_u32 v14, v14, v2
    v_lshlrev_b32 v14, 2, v14
    v_add_u32 v14, 60032, v14
    v_add_u32 v14, s48, v14
    ds_read2_b32 v[232:233], v14 offset0:0 offset1:1
    ds_read2_b32 v[234:235], v14 offset0:2 offset1:3
    ds_read2_b32 v[236:237], v14 offset0:8 offset1:9
    ds_read2_b32 v[238:239], v14 offset0:10 offset1:11
    ds_read2_b32 v[240:241], v14 offset0:16 offset1:17
    ds_read2_b32 v[242:243], v14 offset0:18 offset1:19
    ds_read2_b32 v[244:245], v14 offset0:24 offset1:25
    ds_read2_b32 v[246:247], v14 offset0:26 offset1:27
    s_mul_i32 s49, s50, 4128
    s_sub_u32 s49, 33024, s49
    v_add_u32 v26, s49, v251
    v_add_u32 v28, s49, v250
    ds_read_b128 v[160:163], v26 offset:0
    s_waitcnt lgkmcnt(0)
    v_mfma_f32_32x32x16_bf16 v[64:79], v[160:163], v[20:23], v[232:247]
    s_nop 7
    s_nop 7
    v_max3_f32 v25, v25, v64, v65
    v_max3_f32 v25, v25, v66, v67
    v_max3_f32 v25, v25, v68, v69
    v_max3_f32 v25, v25, v70, v71
    v_max3_f32 v25, v25, v72, v73
    v_max3_f32 v25, v25, v74, v75
    v_max3_f32 v25, v25, v76, v77
    v_max3_f32 v25, v25, v78, v79
    s_add_u32 s50, s50, 1
    s_cmp_le_u32 s50, 8
    s_cbranch_scc1 L_fbA_30
    v_mov_b32 v27, v25
    s_nop 1
    v_permlane32_swap_b32 v25, v27
    s_nop 1
    v_max_f32 v25, v25, v27
    v_mov_b32 v112, 0
    v_mov_b32 v113, 0
    v_mov_b32 v114, 0
    v_mov_b32 v115, 0
    v_mov_b32 v116, 0
    v_mov_b32 v117, 0
    v_mov_b32 v118, 0
    v_mov_b32 v119, 0
    v_mov_b32 v120, 0
    v_mov_b32 v121, 0
    v_mov_b32 v122, 0
    v_mov_b32 v123, 0
    v_mov_b32 v124, 0
    v_mov_b32 v125, 0
    v_mov_b32 v126, 0
    v_mov_b32 v127, 0
    s_mov_b32 s50, 0
L_fbB_31:
    s_cmp_eq_u32 s50, 0
    s_cselect_b32 s48, 0, 4
    s_cmp_eq_u32 s50, 8
    s_cselect_b32 s48, 1, s48
    s_cmp_gt_u32 s50, s51
    s_cselect_b32 s48, 5, s48
    s_lshl_b32 s48, s48, 8
    v_lshlrev_b32 v14, 2, v3
    v_sub_u32 v14, v14, v2
    v_lshlrev_b32 v14, 2, v14
    v_add_u32 v14, 60032, v14
    v_add_u32 v14, s48, v14
    ds_read2_b32 v[232:233], v14 offset0:0 offset1:1
    ds_read2_b32 v[234:235], v14 offset0:2 offset1:3
    ds_read2_b32 v[236:237], v14 offset0:8 offset1:9
    ds_read2_b32 v[238:239], v14 offset0:10 offset1:11
    ds_read2_b32 v[240:241], v14 offset0:16 offset1:17
    ds_read2_b32 v[242:243], v14 offset0:18 offset1:19
    ds_read2_b32 v[244:245], v14 offset0:24 offset1:25
    ds_read2_b32 v[246:247], v14 offset0:26 offset1:27
    s_mul_i32 s49, s50, 4128
    s_sub_u32 s49, 33024, s49
    v_add_u32 v26, s49, v251
    v_add_u32 v28, s49, v250
    ds_read_b128 v[160:163], v26 offset:0
    ds_read_b128 v[164:167], v28 offset:2048
    ds_read_b128 v[168:171], v28 offset:3088
    s_waitcnt lgkmcnt(0)
    v_mfma_f32_32x32x16_bf16 v[64:79], v[160:163], v[20:23], v[232:247]
    s_nop 7
    s_nop 7
    v_sub_f32 v64, v64, v25
    v_sub_f32 v65, v65, v25
    v_sub_f32 v66, v66, v25
    v_sub_f32 v67, v67, v25
    v_sub_f32 v68, v68, v25
    v_sub_f32 v69, v69, v25
    v_sub_f32 v70, v70, v25
    v_sub_f32 v71, v71, v25
    v_sub_f32 v72, v72, v25
    v_sub_f32 v73, v73, v25
    v_sub_f32 v74, v74, v25
    v_sub_f32 v75, v75, v25
    v_sub_f32 v76, v76, v25
    v_sub_f32 v77, v77, v25
    v_sub_f32 v78, v78, v25
    v_sub_f32 v79, v79, v25
    v_exp_f32 v64, v64
    v_exp_f32 v65, v65
    v_exp_f32 v66, v66
    v_exp_f32 v67, v67
    v_exp_f32 v68, v68
    v_exp_f32 v69, v69
    v_exp_f32 v70, v70
    v_exp_f32 v71, v71
    v_exp_f32 v72, v72
    v_exp_f32 v73, v73
    v_exp_f32 v74, v74
    v_exp_f32 v75, v75
    v_exp_f32 v76, v76
    v_exp_f32 v77, v77
    v_exp_f32 v78, v78
    v_exp_f32 v79, v79
    s_nop 0
    v_cvt_pk_bf16_f32 v64, v64, v65
    v_cvt_pk_bf16_f32 v65, v66, v67
    v_cvt_pk_bf16_f32 v66, v68, v69
    v_cvt_pk_bf16_f32 v67, v70, v71
    v_cvt_pk_bf16_f32 v68, v72, v73
    v_cvt_pk_bf16_f32 v69, v74, v75
    v_cvt_pk_bf16_f32 v70, v76, v77
    v_cvt_pk_bf16_f32 v71, v78, v79
    s_nop 1
    v_mfma_f32_32x32x16_bf16 v[112:127], v[164:167], v[64:67], v[112:127]
L_fbv_32:
    v_mfma_f32_32x32x16_bf16 v[112:127], v[168:171], v[68:71], v[112:127]
    s_nop 7
    s_nop 7
    s_add_u32 s50, s50, 1
    s_cmp_le_u32 s50, 8
    s_cbranch_scc1 L_fbB_31
    s_branch L_fb2_26
L_fb2_26:
    v_rcp_f32 v28, v120
    v_mov_b32 v29, 0x10000
    v_mul_f32 v112, v28, v112
    v_mul_f32 v113, v28, v113
    v_mul_f32 v114, v28, v114
    v_mul_f32 v115, v28, v115
    v_mul_f32 v116, v28, v116
    v_mul_f32 v117, v28, v117
    v_mul_f32 v118, v28, v118
    v_mul_f32 v119, v28, v119
    v_add_u32 v113, s75, v113
    v_and_b32 v113, 0xfffe0000, v113
    v_cvt_pk_bf16_f32 v68, v112, v113
    v_cvt_pk_bf16_f32 v69, v114, v115
    v_cvt_pk_bf16_f32 v70, v116, v117
    v_cvt_pk_bf16_f32 v71, v118, v119
    v_bfi_b32 v68, v29, s74, v68
    s_branch L_fbk_25
L_g_redo_58:
    s_mov_b32 s52, 0
    s_waitcnt vmcnt(0) lgkmcnt(0)
    s_nop 7
    s_nop 7
L_g_rl_59:
    buffer_load_dwordx4 v[128:131], v4, s[28:31], s78 offen offset:0 sc1
    buffer_load_dwordx4 v[132:135], v4, s[28:31], s78 offen offset:1024 sc1
    buffer_load_dwordx4 v[136:139], v4, s[28:31], s78 offen offset:2048 sc1
    buffer_load_dwordx4 v[140:143], v4, s[28:31], s78 offen offset:3072 sc1
    buffer_load_dwordx4 v[144:147], v4, s[28:31], s79 offen offset:0 sc1
    buffer_load_dwordx4 v[148:151], v4, s[28:31], s79 offen offset:1024 sc1
    buffer_load_dwordx4 v[152:155], v4, s[28:31], s79 offen offset:2048 sc1
    buffer_load_dwordx4 v[156:159], v4, s[28:31], s79 offen offset:3072 sc1
    buffer_load_dwordx4 v[160:163], v4, s[28:31], s80 offen offset:0 sc1
    buffer_load_dwordx4 v[164:167], v4, s[28:31], s80 offen offset:1024 sc1
    buffer_load_dwordx4 v[168:171], v4, s[28:31], s80 offen offset:2048 sc1
    buffer_load_dwordx4 v[172:175], v4, s[28:31], s80 offen offset:3072 sc1
    buffer_load_dwordx4 v[176:179], v4, s[28:31], s81 offen offset:0 sc1
    buffer_load_dwordx4 v[180:183], v4, s[28:31], s81 offen offset:1024 sc1
    buffer_load_dwordx4 v[184:187], v4, s[28:31], s81 offen offset:2048 sc1
    buffer_load_dwordx4 v[188:191], v4, s[28:31], s81 offen offset:3072 sc1
    buffer_load_dwordx4 v[192:195], v4, s[28:31], s82 offen offset:0 sc1
    buffer_load_dwordx4 v[196:199], v4, s[28:31], s82 offen offset:1024 sc1
    buffer_load_dwordx4 v[200:203], v4, s[28:31], s82 offen offset:2048 sc1
    buffer_load_dwordx4 v[204:207], v4, s[28:31], s82 offen offset:3072 sc1
    buffer_load_dwordx4 v[208:211], v4, s[28:31], s83 offen offset:0 sc1
    buffer_load_dwordx4 v[212:215], v4, s[28:31], s83 offen offset:1024 sc1
    buffer_load_dwordx4 v[216:219], v4, s[28:31], s83 offen offset:2048 sc1
    buffer_load_dwordx4 v[220:223], v4, s[28:31], s83 offen offset:3072 sc1
    buffer_load_dwordx4 v[224:227], v4, s[28:31], s64 offen offset:0 sc1
    buffer_load_dwordx4 v[228:231], v4, s[28:31], s64 offen offset:1024 sc1
    buffer_load_dwordx4 v[232:235], v4, s[28:31], s64 offen offset:2048 sc1
    buffer_load_dwordx4 v[236:239], v4, s[28:31], s64 offen offset:3072 sc1
    buffer_load_dwordx4 v[240:243], v4, s[28:31], s65 offen offset:0 sc1
    buffer_load_dwordx4 v[244:247], v4, s[28:31], s65 offen offset:1024 sc1
    buffer_load_dwordx4 v[248:251], v4, s[28:31], s65 offen offset:2048 sc1
    buffer_load_dwordx4 v[252:255], v4, s[28:31], s65 offen offset:3072 sc1
    buffer_load_dwordx4 v[112:115], v4, s[36:39], s60 offen sc1
    s_waitcnt vmcnt(0)
    v_lshlrev_b32 v60, 16, v112
    v_lshlrev_b32 v61, 16, v114
    v_xor_b32 v14, s75, v128
    v_bitop3_b32 v14, v14, v132, s75 bitop3:0xf6
    v_bitop3_b32 v14, v14, v136, s75 bitop3:0xf6
    v_bitop3_b32 v14, v14, v140, s75 bitop3:0xf6
    v_bitop3_b32 v14, v14, v144, s75 bitop3:0xf6
    v_bitop3_b32 v14, v14, v148, s75 bitop3:0xf6
    v_bitop3_b32 v14, v14, v152, s75 bitop3:0xf6
    v_bitop3_b32 v14, v14, v156, s75 bitop3:0xf6
    v_bitop3_b32 v14, v14, v160, s75 bitop3:0xf6
    v_bitop3_b32 v14, v14, v164, s75 bitop3:0xf6
    v_bitop3_b32 v14, v14, v168, s75 bitop3:0xf6
    v_bitop3_b32 v14, v14, v172, s75 bitop3:0xf6
    v_bitop3_b32 v14, v14, v176, s75 bitop3:0xf6
    v_bitop3_b32 v14, v14, v180, s75 bitop3:0xf6
    v_bitop3_b32 v14, v14, v184, s75 bitop3:0xf6
    v_bitop3_b32 v14, v14, v188, s75 bitop3:0xf6
    v_bitop3_b32 v14, v14, v192, s75 bitop3:0xf6
    v_bitop3_b32 v14, v14, v196, s75 bitop3:0xf6
    v_bitop3_b32 v14, v14, v200, s75 bitop3:0xf6
    v_bitop3_b32 v14, v14, v204, s75 bitop3:0xf6
    v_bitop3_b32 v14, v14, v208, s75 bitop3:0xf6
    v_bitop3_b32 v14, v14, v212, s75 bitop3:0xf6
    v_bitop3_b32 v14, v14, v216, s75 bitop3:0xf6
    v_bitop3_b32 v14, v14, v220, s75 bitop3:0xf6
    v_bitop3_b32 v14, v14, v224, s75 bitop3:0xf6
    v_bitop3_b32 v14, v14, v228, s75 bitop3:0xf6
    v_bitop3_b32 v14, v14, v232, s75 bitop3:0xf6
    v_bitop3_b32 v14, v14, v236, s75 bitop3:0xf6
    v_bitop3_b32 v14, v14, v240, s75 bitop3:0xf6
    v_bitop3_b32 v14, v14, v244, s75 bitop3:0xf6
    v_bitop3_b32 v14, v14, v248, s75 bitop3:0xf6
    v_bitop3_b32 v14, v14, v252, s75 bitop3:0xf6
    v_bitop3_b32 v14, v14, v60, s75 bitop3:0xf6
    v_bitop3_b32 v14, v14, v61, s75 bitop3:0xf6
    v_and_b32 v14, 0x10000, v14
    v_cmp_ne_u32 vcc, 0, v14
    s_cbranch_vccz L_g_l0_56
    s_add_u32 s52, s52, 1
    s_cmp_lt_u32 s52, 40000
    s_cbranch_scc1 L_g_rl_59
    s_mov_b64 s[44:45], 0
    s_mov_b32 s71, 2
    s_branch L_g_l0_56
L_g_l0_56:
    v_lshlrev_b32 v15, 3, v2
    v_add_u32 v15, s70, v15
    ds_read_b64_tr_b16 v[24:25], v7 offset:0
    ds_read_b64_tr_b16 v[26:27], v8 offset:0
    ds_read_b64_tr_b16 v[28:29], v9 offset:0
    ds_read_b64_tr_b16 v[30:31], v10 offset:0
    ds_read_b64_tr_b16 v[32:33], v7 offset:1024
    ds_read_b64_tr_b16 v[34:35], v8 offset:1024
    ds_read_b64_tr_b16 v[36:37], v9 offset:1024
    ds_read_b64_tr_b16 v[38:39], v10 offset:1024
    ds_read_b64_tr_b16 v[40:41], v7 offset:2048
    ds_read_b64_tr_b16 v[42:43], v8 offset:2048
    ds_read_b64_tr_b16 v[44:45], v9 offset:2048
    ds_read_b64_tr_b16 v[46:47], v10 offset:2048
    s_waitcnt lgkmcnt(8)
    v_mfma_f32_32x32x16_bf16 v[64:79], v[24:27], v[128:131], 0
    ds_read_b64_tr_b16 v[48:49], v7 offset:3072
    ds_read_b64_tr_b16 v[50:51], v8 offset:3072
    v_mfma_f32_32x32x16_bf16 v[80:95], v[128:131], v[28:31], 0
    ds_read_b64_tr_b16 v[52:53], v9 offset:3072
    ds_read_b64_tr_b16 v[54:55], v10 offset:3072
    s_waitcnt lgkmcnt(8)
    v_mfma_f32_32x32x16_bf16 v[64:79], v[32:35], v[132:135], v[64:79]
    ds_read_b64_tr_b16 v[24:25], v7 offset:4096
    ds_read_b64_tr_b16 v[26:27], v8 offset:4096
    v_mfma_f32_32x32x16_bf16 v[80:95], v[132:135], v[36:39], v[80:95]
    ds_read_b64_tr_b16 v[28:29], v9 offset:4096
    ds_read_b64_tr_b16 v[30:31], v10 offset:4096
    s_waitcnt lgkmcnt(8)
    v_mfma_f32_32x32x16_bf16 v[64:79], v[40:43], v[136:139], v[64:79]
    ds_read_b64_tr_b16 v[32:33], v7 offset:5120
    ds_read_b64_tr_b16 v[34:35], v8 offset:5120
    v_mfma_f32_32x32x16_bf16 v[80:95], v[136:139], v[44:47], v[80:95]
    ds_read_b64_tr_b16 v[36:37], v9 offset:5120
    ds_read_b64_tr_b16 v[38:39], v10 offset:5120
    s_waitcnt lgkmcnt(8)
    v_mfma_f32_32x32x16_bf16 v[64:79], v[48:51], v[140:143], v[64:79]
    ds_read_b64_tr_b16 v[40:41], v7 offset:6144
    ds_read_b64_tr_b16 v[42:43], v8 offset:6144
    v_mfma_f32_32x32x16_bf16 v[80:95], v[140:143], v[52:55], v[80:95]
    ds_read_b64_tr_b16 v[44:45], v9 offset:6144
    ds_read_b64_tr_b16 v[46:47], v10 offset:6144
    s_waitcnt lgkmcnt(8)
    v_mfma_f32_32x32x16_bf16 v[64:79], v[24:27], v[144:147], v[64:79]
    ds_read_b64_tr_b16 v[48:49], v7 offset:7168
    ds_read_b64_tr_b16 v[50:51], v8 offset:7168
    v_mfma_f32_32x32x16_bf16 v[80:95], v[144:147], v[28:31], v[80:95]
    ds_read_b64_tr_b16 v[52:53], v9 offset:7168
    ds_read_b64_tr_b16 v[54:55], v10 offset:7168
    s_waitcnt lgkmcnt(8)
    v_mfma_f32_32x32x16_bf16 v[64:79], v[32:35], v[148:151], v[64:79]
    ds_read_b64_tr_b16 v[24:25], v7 offset:8192
    ds_read_b64_tr_b16 v[26:27], v8 offset:8192
    v_mfma_f32_32x32x16_bf16 v[80:95], v[148:151], v[36:39], v[80:95]
    ds_read_b64_tr_b16 v[28:29], v9 offset:8192
    ds_read_b64_tr_b16 v[30:31], v10 offset:8192
    s_waitcnt lgkmcnt(8)
    v_mfma_f32_32x32x16_bf16 v[64:79], v[40:43], v[152:155], v[64:79]
    ds_read_b64_tr_b16 v[32:33], v7 offset:9216
    ds_read_b64_tr_b16 v[34:35], v8 offset:9216
    v_mfma_f32_32x32x16_bf16 v[80:95], v[152:155], v[44:47], v[80:95]
    ds_read_b64_tr_b16 v[36:37], v9 offset:9216
    ds_read_b64_tr_b16 v[38:39], v10 offset:9216
    s_waitcnt lgkmcnt(8)
    v_mfma_f32_32x32x16_bf16 v[64:79], v[48:51], v[156:159], v[64:79]
    ds_read_b64_tr_b16 v[40:41], v7 offset:10240
    ds_read_b64_tr_b16 v[42:43], v8 offset:10240
    v_mfma_f32_32x32x16_bf16 v[80:95], v[156:159], v[52:55], v[80:95]
    ds_read_b64_tr_b16 v[44:45], v9 offset:10240
    ds_read_b64_tr_b16 v[46:47], v10 offset:10240
    s_waitcnt lgkmcnt(8)
    v_mfma_f32_32x32x16_bf16 v[64:79], v[24:27], v[160:163], v[64:79]
    ds_read_b64_tr_b16 v[48:49], v7 offset:11264
    ds_read_b64_tr_b16 v[50:51], v8 offset:11264
    v_mfma_f32_32x32x16_bf16 v[80:95], v[160:163], v[28:31], v[80:95]
    ds_read_b64_tr_b16 v[52:53], v9 offset:11264
    ds_read_b64_tr_b16 v[54:55], v10 offset:11264
    s_waitcnt lgkmcnt(8)
    v_mfma_f32_32x32x16_bf16 v[64:79], v[32:35], v[164:167], v[64:79]
    ds_read_b64_tr_b16 v[24:25], v7 offset:12288
    ds_read_b64_tr_b16 v[26:27], v8 offset:12288
    v_mfma_f32_32x32x16_bf16 v[80:95], v[164:167], v[36:39], v[80:95]
    ds_read_b64_tr_b16 v[28:29], v9 offset:12288
    ds_read_b64_tr_b16 v[30:31], v10 offset:12288
    s_lshr_b32 s47, s3, 1
    s_waitcnt lgkmcnt(8)
    v_mfma_f32_32x32x16_bf16 v[64:79], v[40:43], v[168:171], v[64:79]
    ds_read_b64_tr_b16 v[32:33], v7 offset:13312
    ds_read_b64_tr_b16 v[34:35], v8 offset:13312
    v_mfma_f32_32x32x16_bf16 v[80:95], v[168:171], v[44:47], v[80:95]
    ds_read_b64_tr_b16 v[36:37], v9 offset:13312
    ds_read_b64_tr_b16 v[38:39], v10 offset:13312
    s_mul_i32 s51, s47, 1040
    s_waitcnt lgkmcnt(8)
    v_mfma_f32_32x32x16_bf16 v[64:79], v[48:51], v[172:175], v[64:79]
    ds_read_b64_tr_b16 v[40:41], v7 offset:14336
    ds_read_b64_tr_b16 v[42:43], v8 offset:14336
    v_mfma_f32_32x32x16_bf16 v[80:95], v[172:175], v[52:55], v[80:95]
    ds_read_b64_tr_b16 v[44:45], v9 offset:14336
    ds_read_b64_tr_b16 v[46:47], v10 offset:14336
    s_lshl_b32 s47, s47, 10
    s_waitcnt lgkmcnt(8)
    v_mfma_f32_32x32x16_bf16 v[64:79], v[24:27], v[176:179], v[64:79]
    ds_read_b64_tr_b16 v[48:49], v7 offset:15360
    ds_read_b64_tr_b16 v[50:51], v8 offset:15360
    v_mfma_f32_32x32x16_bf16 v[80:95], v[176:179], v[28:31], v[80:95]
    ds_read_b64_tr_b16 v[52:53], v9 offset:15360
    ds_read_b64_tr_b16 v[54:55], v10 offset:15360
    s_add_u32 s76, s59, s47
    s_waitcnt lgkmcnt(8)
    v_mfma_f32_32x32x16_bf16 v[64:79], v[32:35], v[180:183], v[64:79]
    ds_read_b64_tr_b16 v[24:25], v7 offset:16384
    ds_read_b64_tr_b16 v[26:27], v8 offset:16384
    v_mfma_f32_32x32x16_bf16 v[80:95], v[180:183], v[36:39], v[80:95]
    ds_read_b64_tr_b16 v[28:29], v9 offset:16384
    ds_read_b64_tr_b16 v[30:31], v10 offset:16384
    s_mul_i32 s47, s3, 15360
    s_waitcnt lgkmcnt(8)
    v_mfma_f32_32x32x16_bf16 v[64:79], v[40:43], v[184:187], v[64:79]
    ds_read_b64_tr_b16 v[32:33], v7 offset:17408
    ds_read_b64_tr_b16 v[34:35], v8 offset:17408
    v_mfma_f32_32x32x16_bf16 v[80:95], v[184:187], v[44:47], v[80:95]
    ds_read_b64_tr_b16 v[36:37], v9 offset:17408
    ds_read_b64_tr_b16 v[38:39], v10 offset:17408
    s_sub_u32 s76, s76, s47
    s_waitcnt lgkmcnt(8)
    v_mfma_f32_32x32x16_bf16 v[64:79], v[48:51], v[188:191], v[64:79]
    ds_read_b64_tr_b16 v[40:41], v7 offset:18432
    ds_read_b64_tr_b16 v[42:43], v8 offset:18432
    v_mfma_f32_32x32x16_bf16 v[80:95], v[188:191], v[52:55], v[80:95]
    ds_read_b64_tr_b16 v[44:45], v9 offset:18432
    ds_read_b64_tr_b16 v[46:47], v10 offset:18432
    s_sub_u32 s76, s76, 16384
    s_waitcnt lgkmcnt(8)
    v_mfma_f32_32x32x16_bf16 v[64:79], v[24:27], v[192:195], v[64:79]
    ds_read_b64_tr_b16 v[48:49], v7 offset:19456
    ds_read_b64_tr_b16 v[50:51], v8 offset:19456
    v_mfma_f32_32x32x16_bf16 v[80:95], v[192:195], v[28:31], v[80:95]
    ds_read_b64_tr_b16 v[52:53], v9 offset:19456
    ds_read_b64_tr_b16 v[54:55], v10 offset:19456
    s_lshl_b32 s47, s3, 10
    s_waitcnt lgkmcnt(8)
    v_mfma_f32_32x32x16_bf16 v[64:79], v[32:35], v[196:199], v[64:79]
    ds_read_b64_tr_b16 v[24:25], v7 offset:20480
    ds_read_b64_tr_b16 v[26:27], v8 offset:20480
    v_mfma_f32_32x32x16_bf16 v[80:95], v[196:199], v[36:39], v[80:95]
    ds_read_b64_tr_b16 v[28:29], v9 offset:20480
    ds_read_b64_tr_b16 v[30:31], v10 offset:20480
    s_add_u32 s51, s51, s47
    s_waitcnt lgkmcnt(8)
    v_mfma_f32_32x32x16_bf16 v[64:79], v[40:43], v[200:203], v[64:79]
    ds_read_b64_tr_b16 v[32:33], v7 offset:21504
    ds_read_b64_tr_b16 v[34:35], v8 offset:21504
    v_mfma_f32_32x32x16_bf16 v[80:95], v[200:203], v[44:47], v[80:95]
    ds_read_b64_tr_b16 v[36:37], v9 offset:21504
    ds_read_b64_tr_b16 v[38:39], v10 offset:21504
    s_add_u32 s77, s51, 28896
    s_waitcnt lgkmcnt(8)
    v_mfma_f32_32x32x16_bf16 v[64:79], v[48:51], v[204:207], v[64:79]
    ds_read_b64_tr_b16 v[40:41], v7 offset:22528
    ds_read_b64_tr_b16 v[42:43], v8 offset:22528
    v_mfma_f32_32x32x16_bf16 v[80:95], v[204:207], v[52:55], v[80:95]
    ds_read_b64_tr_b16 v[44:45], v9 offset:22528
    ds_read_b64_tr_b16 v[46:47], v10 offset:22528
    s_cmp_eq_u32 s4, 0
    s_waitcnt lgkmcnt(8)
    v_mfma_f32_32x32x16_bf16 v[64:79], v[24:27], v[208:211], v[64:79]
    ds_read_b64_tr_b16 v[48:49], v7 offset:23552
    ds_read_b64_tr_b16 v[50:51], v8 offset:23552
    v_mfma_f32_32x32x16_bf16 v[80:95], v[208:211], v[28:31], v[80:95]
    ds_read_b64_tr_b16 v[52:53], v9 offset:23552
    ds_read_b64_tr_b16 v[54:55], v10 offset:23552
    s_cselect_b32 s76, 0x7f000000, s76
    s_waitcnt lgkmcnt(8)
    v_mfma_f32_32x32x16_bf16 v[64:79], v[32:35], v[212:215], v[64:79]
    ds_read_b64_tr_b16 v[24:25], v7 offset:24576
    ds_read_b64_tr_b16 v[26:27], v8 offset:24576
    v_mfma_f32_32x32x16_bf16 v[80:95], v[212:215], v[36:39], v[80:95]
    ds_read_b64_tr_b16 v[28:29], v9 offset:24576
    ds_read_b64_tr_b16 v[30:31], v10 offset:24576
    s_cselect_b32 s27, 0, s93
    s_waitcnt lgkmcnt(8)
    v_mfma_f32_32x32x16_bf16 v[64:79], v[40:43], v[216:219], v[64:79]
    ds_read_b64_tr_b16 v[32:33], v7 offset:25600
    ds_read_b64_tr_b16 v[34:35], v8 offset:25600
    v_mfma_f32_32x32x16_bf16 v[80:95], v[216:219], v[44:47], v[80:95]
    ds_read_b64_tr_b16 v[36:37], v9 offset:25600
    ds_read_b64_tr_b16 v[38:39], v10 offset:25600
    s_waitcnt lgkmcnt(8)
    v_mfma_f32_32x32x16_bf16 v[64:79], v[48:51], v[220:223], v[64:79]
    ds_read_b64_tr_b16 v[40:41], v7 offset:26624
    ds_read_b64_tr_b16 v[42:43], v8 offset:26624
    v_mfma_f32_32x32x16_bf16 v[80:95], v[220:223], v[52:55], v[80:95]
    ds_read_b64_tr_b16 v[44:45], v9 offset:26624
    ds_read_b64_tr_b16 v[46:47], v10 offset:26624
    s_waitcnt lgkmcnt(8)
    v_mfma_f32_32x32x16_bf16 v[64:79], v[24:27], v[224:227], v[64:79]
    ds_read_b64_tr_b16 v[48:49], v7 offset:27648
    ds_read_b64_tr_b16 v[50:51], v8 offset:27648
    v_mfma_f32_32x32x16_bf16 v[80:95], v[224:227], v[28:31], v[80:95]
    ds_read_b64_tr_b16 v[52:53], v9 offset:27648
    ds_read_b64_tr_b16 v[54:55], v10 offset:27648
    s_waitcnt lgkmcnt(8)
    v_mfma_f32_32x32x16_bf16 v[64:79], v[32:35], v[228:231], v[64:79]
    ds_read_b64_tr_b16 v[24:25], v7 offset:28672
    ds_read_b64_tr_b16 v[26:27], v8 offset:28672
    v_add_f32 v112, v112, v114
    v_add_f32 v113, v113, v115
    v_mov_b32 v114, v112
    v_mfma_f32_32x32x16_bf16 v[80:95], v[228:231], v[36:39], v[80:95]
    ds_read_b64_tr_b16 v[28:29], v9 offset:28672
    ds_read_b64_tr_b16 v[30:31], v10 offset:28672
    v_mov_b32 v115, v113
    v_mov_b32 v18, 0
    v_mov_b32 v19, 0
    s_waitcnt lgkmcnt(8)
    v_mfma_f32_32x32x16_bf16 v[64:79], v[40:43], v[232:235], v[64:79]
    ds_read_b64_tr_b16 v[32:33], v7 offset:29696
    ds_read_b64_tr_b16 v[34:35], v8 offset:29696
    v_permlane32_swap_b32 v112, v114
    v_permlane32_swap_b32 v113, v115
    s_lshl_b32 s46, s3, 7
    v_mfma_f32_32x32x16_bf16 v[80:95], v[232:235], v[44:47], v[80:95]
    ds_read_b64_tr_b16 v[36:37], v9 offset:29696
    ds_read_b64_tr_b16 v[38:39], v10 offset:29696
    v_lshlrev_b32 v14, 2, v2
    v_add_f32 v112, v112, v114
    v_add_f32 v113, v113, v115
    s_waitcnt lgkmcnt(8)
    v_mfma_f32_32x32x16_bf16 v[64:79], v[48:51], v[236:239], v[64:79]
    ds_read_b64_tr_b16 v[40:41], v7 offset:30720
    ds_read_b64_tr_b16 v[42:43], v8 offset:30720
    v_mul_f32 v112, 0x3b000000, v112
    v_mul_f32 v113, 0x3b000000, v113
    v_fma_f32 v113, -v112, v112, v113
    v_mfma_f32_32x32x16_bf16 v[80:95], v[236:239], v[52:55], v[80:95]
    ds_read_b64_tr_b16 v[44:45], v9 offset:30720
    ds_read_b64_tr_b16 v[46:47], v10 offset:30720
    v_max_f32 v113, 0, v113
    v_cvt_pk_bf16_f32 v114, v112, v113
    v_and_b32 v115, 0xffff0000, v114
    s_waitcnt lgkmcnt(8)
    v_mfma_f32_32x32x16_bf16 v[64:79], v[24:27], v[240:243], v[64:79]
    ds_read_b64_tr_b16 v[48:49], v7 offset:31744
    ds_read_b64_tr_b16 v[50:51], v8 offset:31744
    v_add_f32 v115, 0x3727c5ac, v115
    v_cvt_pk_bf16_f32 v115, v115, v115
    v_and_b32 v115, 0xffff0000, v115
    v_mfma_f32_32x32x16_bf16 v[80:95], v[240:243], v[28:31], v[80:95]
    ds_read_b64_tr_b16 v[52:53], v9 offset:31744
    ds_read_b64_tr_b16 v[54:55], v10 offset:31744
    v_sqrt_f32 v115, v115
    v_and_b32 v114, 0xffff, v114
    v_xor_b32 v114, 0x8000, v114
    s_waitcnt lgkmcnt(8)
    v_mfma_f32_32x32x16_bf16 v[64:79], v[32:35], v[244:247], v[64:79]
    ds_read_b64 v[24:25], v15 offset:256
    ds_read_b64 v[28:29], v15 offset:512
    v_cvt_pk_bf16_f32 v115, v115, v115
    v_and_b32 v115, 0xffff0000, v115
    v_rcp_f32 v12, v115
    v_mfma_f32_32x32x16_bf16 v[80:95], v[244:247], v[36:39], v[80:95]
    v_cndmask_b32_e64 v17, 0, v114, s[66:67]
    v_lshl_or_b32 v16, v17, 16, v17
    v_add_u32 v14, s46, v14
    s_waitcnt lgkmcnt(6)
    v_mfma_f32_32x32x16_bf16 v[64:79], v[40:43], v[248:251], v[64:79]
    ds_read_b64 v[32:33], v15 offset:0
    ds_read_b64_tr_b16 v[36:37], v5 offset:31744
    v_mul_f32 v13, 0x3eb8aa3b, v12
    v_lshlrev_b32 v21, 4, v3
    v_add_u32 v21, s46, v21
    ds_write_b32 v14, v12 offset:59392
    ds_read_b128 v[112:115], v21 offset:59392
    ds_read_b128 v[116:119], v21 offset:59424
    ds_read_b128 v[120:123], v21 offset:59456
    ds_read_b128 v[124:127], v21 offset:59488
    v_mfma_f32_32x32x16_bf16 v[80:95], v[248:251], v[44:47], v[80:95]
    ds_read_b64_tr_b16 v[38:39], v6 offset:31744
    s_waitcnt lgkmcnt(10)
    v_mfma_f32_32x32x16_bf16 v[64:79], v[48:51], v[252:255], v[64:79]
    ds_read_b64_tr_b16 v[40:41], v5 offset:30720
    ds_read_b64_tr_b16 v[42:43], v6 offset:30720
    v_mfma_f32_32x32x16_bf16 v[80:95], v[252:255], v[52:55], v[80:95]
    ds_read_b64_tr_b16 v[44:45], v5 offset:29696
    ds_read_b64_tr_b16 v[46:47], v6 offset:29696
    s_waitcnt vmcnt(0)
    s_branch L_g_join_57
L_fb_107:
    s_mov_b32 s51, s54
    v_mov_b32 v25, 0xff800000
    s_mov_b32 s50, 0
L_fbA_110:
    s_cmp_eq_u32 s50, 0
    s_cselect_b32 s48, 2, 4
    s_cmp_eq_u32 s50, 1
    s_cselect_b32 s48, 3, s48
    s_cmp_gt_u32 s50, s51
    s_cselect_b32 s48, 5, s48
    s_lshl_b32 s48, s48, 8
    v_lshlrev_b32 v14, 2, v3
    v_sub_u32 v14, v14, v2
    v_lshlrev_b32 v14, 2, v14
    v_add_u32 v14, 60032, v14
    v_add_u32 v14, s48, v14
    ds_read2_b32 v[232:233], v14 offset0:0 offset1:1
    ds_read2_b32 v[234:235], v14 offset0:2 offset1:3
    ds_read2_b32 v[236:237], v14 offset0:8 offset1:9
    ds_read2_b32 v[238:239], v14 offset0:10 offset1:11
    ds_read2_b32 v[240:241], v14 offset0:16 offset1:17
    ds_read2_b32 v[242:243], v14 offset0:18 offset1:19
    ds_read2_b32 v[244:245], v14 offset0:24 offset1:25
    ds_read2_b32 v[246:247], v14 offset0:26 offset1:27
    s_mul_i32 s49, s50, 4128
    s_sub_u32 s49, 33024, s49
    v_add_u32 v26, s49, v248
    v_add_u32 v28, s49, v249
    ds_read_b128 v[160:163], v26 offset:0
    s_waitcnt lgkmcnt(0)
    v_mfma_f32_32x32x16_bf16 v[64:79], v[160:163], v[16:19], v[232:247]
    s_nop 7
    s_nop 7
    v_max3_f32 v25, v25, v64, v65
    v_max3_f32 v25, v25, v66, v67
    v_max3_f32 v25, v25, v68, v69
    v_max3_f32 v25, v25, v70, v71
    v_max3_f32 v25, v25, v72, v73
    v_max3_f32 v25, v25, v74, v75
    v_max3_f32 v25, v25, v76, v77
    v_max3_f32 v25, v25, v78, v79
    s_add_u32 s50, s50, 1
    s_cmp_le_u32 s50, 1
    s_cbranch_scc1 L_fbA_110
    v_mov_b32 v27, v25
    s_nop 1
    v_permlane32_swap_b32 v25, v27
    s_nop 1
    v_max_f32 v25, v25, v27
    v_mov_b32 v96, 0
    v_mov_b32 v97, 0
    v_mov_b32 v98, 0
    v_mov_b32 v99, 0
    v_mov_b32 v100, 0
    v_mov_b32 v101, 0
    v_mov_b32 v102, 0
    v_mov_b32 v103, 0
    v_mov_b32 v104, 0
    v_mov_b32 v105, 0
    v_mov_b32 v106, 0
    v_mov_b32 v107, 0
    v_mov_b32 v108, 0
    v_mov_b32 v109, 0
    v_mov_b32 v110, 0
    v_mov_b32 v111, 0
    s_mov_b32 s50, 0
L_fbB_111:
    s_cmp_eq_u32 s50, 0
    s_cselect_b32 s48, 2, 4
    s_cmp_eq_u32 s50, 1
    s_cselect_b32 s48, 3, s48
    s_cmp_gt_u32 s50, s51
    s_cselect_b32 s48, 5, s48
    s_lshl_b32 s48, s48, 8
    v_lshlrev_b32 v14, 2, v3
    v_sub_u32 v14, v14, v2
    v_lshlrev_b32 v14, 2, v14
    v_add_u32 v14, 60032, v14
    v_add_u32 v14, s48, v14
    ds_read2_b32 v[232:233], v14 offset0:0 offset1:1
    ds_read2_b32 v[234:235], v14 offset0:2 offset1:3
    ds_read2_b32 v[236:237], v14 offset0:8 offset1:9
    ds_read2_b32 v[238:239], v14 offset0:10 offset1:11
    ds_read2_b32 v[240:241], v14 offset0:16 offset1:17
    ds_read2_b32 v[242:243], v14 offset0:18 offset1:19
    ds_read2_b32 v[244:245], v14 offset0:24 offset1:25
    ds_read2_b32 v[246:247], v14 offset0:26 offset1:27
    s_mul_i32 s49, s50, 4128
    s_sub_u32 s49, 33024, s49
    v_add_u32 v26, s49, v248
    v_add_u32 v28, s49, v249
    ds_read_b128 v[160:163], v26 offset:0
    ds_read_b128 v[164:167], v28 offset:2048
    ds_read_b128 v[168:171], v28 offset:3088
    s_waitcnt lgkmcnt(0)
    v_mfma_f32_32x32x16_bf16 v[64:79], v[160:163], v[16:19], v[232:247]
    s_nop 7
    s_nop 7
    v_sub_f32 v64, v64, v25
    v_sub_f32 v65, v65, v25
    v_sub_f32 v66, v66, v25
    v_sub_f32 v67, v67, v25
    v_sub_f32 v68, v68, v25
    v_sub_f32 v69, v69, v25
    v_sub_f32 v70, v70, v25
    v_sub_f32 v71, v71, v25
    v_sub_f32 v72, v72, v25
    v_sub_f32 v73, v73, v25
    v_sub_f32 v74, v74, v25
    v_sub_f32 v75, v75, v25
    v_sub_f32 v76, v76, v25
    v_sub_f32 v77, v77, v25
    v_sub_f32 v78, v78, v25
    v_sub_f32 v79, v79, v25
    v_exp_f32 v64, v64
    v_exp_f32 v65, v65
    v_exp_f32 v66, v66
    v_exp_f32 v67, v67
    v_exp_f32 v68, v68
    v_exp_f32 v69, v69
    v_exp_f32 v70, v70
    v_exp_f32 v71, v71
    v_exp_f32 v72, v72
    v_exp_f32 v73, v73
    v_exp_f32 v74, v74
    v_exp_f32 v75, v75
    v_exp_f32 v76, v76
    v_exp_f32 v77, v77
    v_exp_f32 v78, v78
    v_exp_f32 v79, v79
    s_nop 0
    v_cvt_pk_bf16_f32 v64, v64, v65
    v_cvt_pk_bf16_f32 v65, v66, v67
    v_cvt_pk_bf16_f32 v66, v68, v69
    v_cvt_pk_bf16_f32 v67, v70, v71
    v_cvt_pk_bf16_f32 v68, v72, v73
    v_cvt_pk_bf16_f32 v69, v74, v75
    v_cvt_pk_bf16_f32 v70, v76, v77
    v_cvt_pk_bf16_f32 v71, v78, v79
    s_nop 1
    s_cmp_eq_u32 s50, 1
    s_cbranch_scc1 L_fbv_112
    v_mfma_f32_32x32x16_bf16 v[96:111], v[164:167], v[64:67], v[96:111]
L_fbv_112:
    v_mfma_f32_32x32x16_bf16 v[96:111], v[168:171], v[68:71], v[96:111]
    s_nop 7
    s_nop 7
    s_add_u32 s50, s50, 1
    s_cmp_le_u32 s50, 1
    s_cbranch_scc1 L_fbB_111
    s_mov_b32 s51, s54
    v_mov_b32 v25, 0xff800000
    s_mov_b32 s50, 0
L_fbA_113:
    s_cmp_eq_u32 s50, 0
    s_cselect_b32 s48, 2, 4
    s_cmp_eq_u32 s50, 1
    s_cselect_b32 s48, 3, s48
    s_cmp_gt_u32 s50, s51
    s_cselect_b32 s48, 5, s48
    s_lshl_b32 s48, s48, 8
    v_lshlrev_b32 v14, 2, v3
    v_sub_u32 v14, v14, v2
    v_lshlrev_b32 v14, 2, v14
    v_add_u32 v14, 60032, v14
    v_add_u32 v14, s48, v14
    ds_read2_b32 v[232:233], v14 offset0:0 offset1:1
    ds_read2_b32 v[234:235], v14 offset0:2 offset1:3
    ds_read2_b32 v[236:237], v14 offset0:8 offset1:9
    ds_read2_b32 v[238:239], v14 offset0:10 offset1:11
    ds_read2_b32 v[240:241], v14 offset0:16 offset1:17
    ds_read2_b32 v[242:243], v14 offset0:18 offset1:19
    ds_read2_b32 v[244:245], v14 offset0:24 offset1:25
    ds_read2_b32 v[246:247], v14 offset0:26 offset1:27
    s_mul_i32 s49, s50, 4128
    s_sub_u32 s49, 33024, s49
    v_add_u32 v26, s49, v251
    v_add_u32 v28, s49, v250
    ds_read_b128 v[160:163], v26 offset:0
    s_waitcnt lgkmcnt(0)
    v_mfma_f32_32x32x16_bf16 v[64:79], v[160:163], v[20:23], v[232:247]
    s_nop 7
    s_nop 7
    v_max3_f32 v25, v25, v64, v65
    v_max3_f32 v25, v25, v66, v67
    v_max3_f32 v25, v25, v68, v69
    v_max3_f32 v25, v25, v70, v71
    v_max3_f32 v25, v25, v72, v73
    v_max3_f32 v25, v25, v74, v75
    v_max3_f32 v25, v25, v76, v77
    v_max3_f32 v25, v25, v78, v79
    s_add_u32 s50, s50, 1
    s_cmp_le_u32 s50, 1
    s_cbranch_scc1 L_fbA_113
    v_mov_b32 v27, v25
    s_nop 1
    v_permlane32_swap_b32 v25, v27
    s_nop 1
    v_max_f32 v25, v25, v27
    v_mov_b32 v112, 0
    v_mov_b32 v113, 0
    v_mov_b32 v114, 0
    v_mov_b32 v115, 0
    v_mov_b32 v116, 0
    v_mov_b32 v117, 0
    v_mov_b32 v118, 0
    v_mov_b32 v119, 0
    v_mov_b32 v120, 0
    v_mov_b32 v121, 0
    v_mov_b32 v122, 0
    v_mov_b32 v123, 0
    v_mov_b32 v124, 0
    v_mov_b32 v125, 0
    v_mov_b32 v126, 0
    v_mov_b32 v127, 0
    s_mov_b32 s50, 0
L_fbB_114:
    s_cmp_eq_u32 s50, 0
    s_cselect_b32 s48, 2, 4
    s_cmp_eq_u32 s50, 1
    s_cselect_b32 s48, 3, s48
    s_cmp_gt_u32 s50, s51
    s_cselect_b32 s48, 5, s48
    s_lshl_b32 s48, s48, 8
    v_lshlrev_b32 v14, 2, v3
    v_sub_u32 v14, v14, v2
    v_lshlrev_b32 v14, 2, v14
    v_add_u32 v14, 60032, v14
    v_add_u32 v14, s48, v14
    ds_read2_b32 v[232:233], v14 offset0:0 offset1:1
    ds_read2_b32 v[234:235], v14 offset0:2 offset1:3
    ds_read2_b32 v[236:237], v14 offset0:8 offset1:9
    ds_read2_b32 v[238:239], v14 offset0:10 offset1:11
    ds_read2_b32 v[240:241], v14 offset0:16 offset1:17
    ds_read2_b32 v[242:243], v14 offset0:18 offset1:19
    ds_read2_b32 v[244:245], v14 offset0:24 offset1:25
    ds_read2_b32 v[246:247], v14 offset0:26 offset1:27
    s_mul_i32 s49, s50, 4128
    s_sub_u32 s49, 33024, s49
    v_add_u32 v26, s49, v251
    v_add_u32 v28, s49, v250
    ds_read_b128 v[160:163], v26 offset:0
    ds_read_b128 v[164:167], v28 offset:2048
    ds_read_b128 v[168:171], v28 offset:3088
    s_waitcnt lgkmcnt(0)
    v_mfma_f32_32x32x16_bf16 v[64:79], v[160:163], v[20:23], v[232:247]
    s_nop 7
    s_nop 7
    v_sub_f32 v64, v64, v25
    v_sub_f32 v65, v65, v25
    v_sub_f32 v66, v66, v25
    v_sub_f32 v67, v67, v25
    v_sub_f32 v68, v68, v25
    v_sub_f32 v69, v69, v25
    v_sub_f32 v70, v70, v25
    v_sub_f32 v71, v71, v25
    v_sub_f32 v72, v72, v25
    v_sub_f32 v73, v73, v25
    v_sub_f32 v74, v74, v25
    v_sub_f32 v75, v75, v25
    v_sub_f32 v76, v76, v25
    v_sub_f32 v77, v77, v25
    v_sub_f32 v78, v78, v25
    v_sub_f32 v79, v79, v25
    v_exp_f32 v64, v64
    v_exp_f32 v65, v65
    v_exp_f32 v66, v66
    v_exp_f32 v67, v67
    v_exp_f32 v68, v68
    v_exp_f32 v69, v69
    v_exp_f32 v70, v70
    v_exp_f32 v71, v71
    v_exp_f32 v72, v72
    v_exp_f32 v73, v73
    v_exp_f32 v74, v74
    v_exp_f32 v75, v75
    v_exp_f32 v76, v76
    v_exp_f32 v77, v77
    v_exp_f32 v78, v78
    v_exp_f32 v79, v79
    s_nop 0
    v_cvt_pk_bf16_f32 v64, v64, v65
    v_cvt_pk_bf16_f32 v65, v66, v67
    v_cvt_pk_bf16_f32 v66, v68, v69
    v_cvt_pk_bf16_f32 v67, v70, v71
    v_cvt_pk_bf16_f32 v68, v72, v73
    v_cvt_pk_bf16_f32 v69, v74, v75
    v_cvt_pk_bf16_f32 v70, v76, v77
    v_cvt_pk_bf16_f32 v71, v78, v79
    s_nop 1
    s_cmp_eq_u32 s50, 1
    s_cbranch_scc1 L_fbv_115
    v_mfma_f32_32x32x16_bf16 v[112:127], v[164:167], v[64:67], v[112:127]
L_fbv_115:
    v_mfma_f32_32x32x16_bf16 v[112:127], v[168:171], v[68:71], v[112:127]
    s_nop 7
    s_nop 7
    s_add_u32 s50, s50, 1
    s_cmp_le_u32 s50, 1
    s_cbranch_scc1 L_fbB_114
    s_branch L_fb2_109
L_fb2_109:
    v_rcp_f32 v28, v104
    v_mov_b32 v29, 0x10000
    v_mul_f32 v96, v28, v96
    v_mul_f32 v97, v28, v97
    v_mul_f32 v98, v28, v98
    v_mul_f32 v99, v28, v99
    v_mul_f32 v100, v28, v100
    v_mul_f32 v101, v28, v101
    v_mul_f32 v102, v28, v102
    v_mul_f32 v103, v28, v103
    v_add_u32 v97, s75, v97
    v_and_b32 v97, 0xfffe0000, v97
    v_cvt_pk_bf16_f32 v64, v96, v97
    v_cvt_pk_bf16_f32 v65, v98, v99
    v_cvt_pk_bf16_f32 v66, v100, v101
    v_cvt_pk_bf16_f32 v67, v102, v103
    v_bfi_b32 v64, v29, s74, v64
    s_branch L_fbk_108
L_g_redo_141:
    s_mov_b32 s52, 0
    s_waitcnt vmcnt(0) lgkmcnt(0)
    s_nop 7
    s_nop 7
L_g_rl_142:
    buffer_load_dwordx4 v[128:131], v4, s[28:31], s78 offen offset:0 sc1
    buffer_load_dwordx4 v[132:135], v4, s[28:31], s78 offen offset:1024 sc1
    buffer_load_dwordx4 v[136:139], v4, s[28:31], s78 offen offset:2048 sc1
    buffer_load_dwordx4 v[140:143], v4, s[28:31], s78 offen offset:3072 sc1
    buffer_load_dwordx4 v[144:147], v4, s[28:31], s79 offen offset:0 sc1
    buffer_load_dwordx4 v[148:151], v4, s[28:31], s79 offen offset:1024 sc1
    buffer_load_dwordx4 v[152:155], v4, s[28:31], s79 offen offset:2048 sc1
    buffer_load_dwordx4 v[156:159], v4, s[28:31], s79 offen offset:3072 sc1
    buffer_load_dwordx4 v[160:163], v4, s[28:31], s80 offen offset:0 sc1
    buffer_load_dwordx4 v[164:167], v4, s[28:31], s80 offen offset:1024 sc1
    buffer_load_dwordx4 v[168:171], v4, s[28:31], s80 offen offset:2048 sc1
    buffer_load_dwordx4 v[172:175], v4, s[28:31], s80 offen offset:3072 sc1
    buffer_load_dwordx4 v[176:179], v4, s[28:31], s81 offen offset:0 sc1
    buffer_load_dwordx4 v[180:183], v4, s[28:31], s81 offen offset:1024 sc1
    buffer_load_dwordx4 v[184:187], v4, s[28:31], s81 offen offset:2048 sc1
    buffer_load_dwordx4 v[188:191], v4, s[28:31], s81 offen offset:3072 sc1
    buffer_load_dwordx4 v[192:195], v4, s[28:31], s82 offen offset:0 sc1
    buffer_load_dwordx4 v[196:199], v4, s[28:31], s82 offen offset:1024 sc1
    buffer_load_dwordx4 v[200:203], v4, s[28:31], s82 offen offset:2048 sc1
    buffer_load_dwordx4 v[204:207], v4, s[28:31], s82 offen offset:3072 sc1
    buffer_load_dwordx4 v[208:211], v4, s[28:31], s83 offen offset:0 sc1
    buffer_load_dwordx4 v[212:215], v4, s[28:31], s83 offen offset:1024 sc1
    buffer_load_dwordx4 v[216:219], v4, s[28:31], s83 offen offset:2048 sc1
    buffer_load_dwordx4 v[220:223], v4, s[28:31], s83 offen offset:3072 sc1
    buffer_load_dwordx4 v[224:227], v4, s[28:31], s64 offen offset:0 sc1
    buffer_load_dwordx4 v[228:231], v4, s[28:31], s64 offen offset:1024 sc1
    buffer_load_dwordx4 v[232:235], v4, s[28:31], s64 offen offset:2048 sc1
    buffer_load_dwordx4 v[236:239], v4, s[28:31], s64 offen offset:3072 sc1
    buffer_load_dwordx4 v[240:243], v4, s[28:31], s65 offen offset:0 sc1
    buffer_load_dwordx4 v[244:247], v4, s[28:31], s65 offen offset:1024 sc1
    buffer_load_dwordx4 v[248:251], v4, s[28:31], s65 offen offset:2048 sc1
    buffer_load_dwordx4 v[252:255], v4, s[28:31], s65 offen offset:3072 sc1
    buffer_load_dwordx4 v[112:115], v4, s[36:39], s60 offen sc1
    s_waitcnt vmcnt(0)
    v_lshlrev_b32 v60, 16, v112
    v_lshlrev_b32 v61, 16, v114
    v_xor_b32 v14, s75, v128
    v_bitop3_b32 v14, v14, v132, s75 bitop3:0xf6
    v_bitop3_b32 v14, v14, v136, s75 bitop3:0xf6
    v_bitop3_b32 v14, v14, v140, s75 bitop3:0xf6
    v_bitop3_b32 v14, v14, v144, s75 bitop3:0xf6
    v_bitop3_b32 v14, v14, v148, s75 bitop3:0xf6
    v_bitop3_b32 v14, v14, v152, s75 bitop3:0xf6
    v_bitop3_b32 v14, v14, v156, s75 bitop3:0xf6
    v_bitop3_b32 v14, v14, v160, s75 bitop3:0xf6
    v_bitop3_b32 v14, v14, v164, s75 bitop3:0xf6
    v_bitop3_b32 v14, v14, v168, s75 bitop3:0xf6
    v_bitop3_b32 v14, v14, v172, s75 bitop3:0xf6
    v_bitop3_b32 v14, v14, v176, s75 bitop3:0xf6
    v_bitop3_b32 v14, v14, v180, s75 bitop3:0xf6
    v_bitop3_b32 v14, v14, v184, s75 bitop3:0xf6
    v_bitop3_b32 v14, v14, v188, s75 bitop3:0xf6
    v_bitop3_b32 v14, v14, v192, s75 bitop3:0xf6
    v_bitop3_b32 v14, v14, v196, s75 bitop3:0xf6
    v_bitop3_b32 v14, v14, v200, s75 bitop3:0xf6
    v_bitop3_b32 v14, v14, v204, s75 bitop3:0xf6
    v_bitop3_b32 v14, v14, v208, s75 bitop3:0xf6
    v_bitop3_b32 v14, v14, v212, s75 bitop3:0xf6
    v_bitop3_b32 v14, v14, v216, s75 bitop3:0xf6
    v_bitop3_b32 v14, v14, v220, s75 bitop3:0xf6
    v_bitop3_b32 v14, v14, v224, s75 bitop3:0xf6
    v_bitop3_b32 v14, v14, v228, s75 bitop3:0xf6
    v_bitop3_b32 v14, v14, v232, s75 bitop3:0xf6
    v_bitop3_b32 v14, v14, v236, s75 bitop3:0xf6
    v_bitop3_b32 v14, v14, v240, s75 bitop3:0xf6
    v_bitop3_b32 v14, v14, v244, s75 bitop3:0xf6
    v_bitop3_b32 v14, v14, v248, s75 bitop3:0xf6
    v_bitop3_b32 v14, v14, v252, s75 bitop3:0xf6
    v_bitop3_b32 v14, v14, v60, s75 bitop3:0xf6
    v_bitop3_b32 v14, v14, v61, s75 bitop3:0xf6
    v_and_b32 v14, 0x10000, v14
    v_cmp_ne_u32 vcc, 0, v14
    s_cbranch_vccz L_g_l0_139
    s_add_u32 s52, s52, 1
    s_cmp_lt_u32 s52, 40000
    s_cbranch_scc1 L_g_rl_142
    s_mov_b64 s[44:45], 0
    s_mov_b32 s71, 2
    s_branch L_g_l0_139
L_g_l0_139:
    v_lshlrev_b32 v15, 3, v2
    v_add_u32 v15, s70, v15
    ds_read_b64_tr_b16 v[24:25], v7 offset:0
    ds_read_b64_tr_b16 v[26:27], v8 offset:0
    ds_read_b64_tr_b16 v[28:29], v9 offset:0
    ds_read_b64_tr_b16 v[30:31], v10 offset:0
    ds_read_b64_tr_b16 v[32:33], v7 offset:1024
    ds_read_b64_tr_b16 v[34:35], v8 offset:1024
    ds_read_b64_tr_b16 v[36:37], v9 offset:1024
    ds_read_b64_tr_b16 v[38:39], v10 offset:1024
    ds_read_b64_tr_b16 v[40:41], v7 offset:2048
    ds_read_b64_tr_b16 v[42:43], v8 offset:2048
    ds_read_b64_tr_b16 v[44:45], v9 offset:2048
    ds_read_b64_tr_b16 v[46:47], v10 offset:2048
    s_waitcnt lgkmcnt(8)
    v_mfma_f32_32x32x16_bf16 v[64:79], v[24:27], v[128:131], 0
    ds_read_b64_tr_b16 v[48:49], v7 offset:3072
    ds_read_b64_tr_b16 v[50:51], v8 offset:3072
    v_mfma_f32_32x32x16_bf16 v[80:95], v[128:131], v[28:31], 0
    ds_read_b64_tr_b16 v[52:53], v9 offset:3072
    ds_read_b64_tr_b16 v[54:55], v10 offset:3072
    s_waitcnt lgkmcnt(8)
    v_mfma_f32_32x32x16_bf16 v[64:79], v[32:35], v[132:135], v[64:79]
    ds_read_b64_tr_b16 v[24:25], v7 offset:4096
    ds_read_b64_tr_b16 v[26:27], v8 offset:4096
    v_mfma_f32_32x32x16_bf16 v[80:95], v[132:135], v[36:39], v[80:95]
    ds_read_b64_tr_b16 v[28:29], v9 offset:4096
    ds_read_b64_tr_b16 v[30:31], v10 offset:4096
    s_waitcnt lgkmcnt(8)
    v_mfma_f32_32x32x16_bf16 v[64:79], v[40:43], v[136:139], v[64:79]
    ds_read_b64_tr_b16 v[32:33], v7 offset:5120
    ds_read_b64_tr_b16 v[34:35], v8 offset:5120
    v_mfma_f32_32x32x16_bf16 v[80:95], v[136:139], v[44:47], v[80:95]
    ds_read_b64_tr_b16 v[36:37], v9 offset:5120
    ds_read_b64_tr_b16 v[38:39], v10 offset:5120
    s_waitcnt lgkmcnt(8)
    v_mfma_f32_32x32x16_bf16 v[64:79], v[48:51], v[140:143], v[64:79]
    ds_read_b64_tr_b16 v[40:41], v7 offset:6144
    ds_read_b64_tr_b16 v[42:43], v8 offset:6144
    v_mfma_f32_32x32x16_bf16 v[80:95], v[140:143], v[52:55], v[80:95]
    ds_read_b64_tr_b16 v[44:45], v9 offset:6144
    ds_read_b64_tr_b16 v[46:47], v10 offset:6144
    s_waitcnt lgkmcnt(8)
    v_mfma_f32_32x32x16_bf16 v[64:79], v[24:27], v[144:147], v[64:79]
    ds_read_b64_tr_b16 v[48:49], v7 offset:7168
    ds_read_b64_tr_b16 v[50:51], v8 offset:7168
    v_mfma_f32_32x32x16_bf16 v[80:95], v[144:147], v[28:31], v[80:95]
    ds_read_b64_tr_b16 v[52:53], v9 offset:7168
    ds_read_b64_tr_b16 v[54:55], v10 offset:7168
    s_waitcnt lgkmcnt(8)
    v_mfma_f32_32x32x16_bf16 v[64:79], v[32:35], v[148:151], v[64:79]
    ds_read_b64_tr_b16 v[24:25], v7 offset:8192
    ds_read_b64_tr_b16 v[26:27], v8 offset:8192
    v_mfma_f32_32x32x16_bf16 v[80:95], v[148:151], v[36:39], v[80:95]
    ds_read_b64_tr_b16 v[28:29], v9 offset:8192
    ds_read_b64_tr_b16 v[30:31], v10 offset:8192
    s_waitcnt lgkmcnt(8)
    v_mfma_f32_32x32x16_bf16 v[64:79], v[40:43], v[152:155], v[64:79]
    ds_read_b64_tr_b16 v[32:33], v7 offset:9216
    ds_read_b64_tr_b16 v[34:35], v8 offset:9216
    v_mfma_f32_32x32x16_bf16 v[80:95], v[152:155], v[44:47], v[80:95]
    ds_read_b64_tr_b16 v[36:37], v9 offset:9216
    ds_read_b64_tr_b16 v[38:39], v10 offset:9216
    s_waitcnt lgkmcnt(8)
    v_mfma_f32_32x32x16_bf16 v[64:79], v[48:51], v[156:159], v[64:79]
    ds_read_b64_tr_b16 v[40:41], v7 offset:10240
    ds_read_b64_tr_b16 v[42:43], v8 offset:10240
    v_mfma_f32_32x32x16_bf16 v[80:95], v[156:159], v[52:55], v[80:95]
    ds_read_b64_tr_b16 v[44:45], v9 offset:10240
    ds_read_b64_tr_b16 v[46:47], v10 offset:10240
    s_waitcnt lgkmcnt(8)
    v_mfma_f32_32x32x16_bf16 v[64:79], v[24:27], v[160:163], v[64:79]
    ds_read_b64_tr_b16 v[48:49], v7 offset:11264
    ds_read_b64_tr_b16 v[50:51], v8 offset:11264
    v_mfma_f32_32x32x16_bf16 v[80:95], v[160:163], v[28:31], v[80:95]
    ds_read_b64_tr_b16 v[52:53], v9 offset:11264
    ds_read_b64_tr_b16 v[54:55], v10 offset:11264
    s_waitcnt lgkmcnt(8)
    v_mfma_f32_32x32x16_bf16 v[64:79], v[32:35], v[164:167], v[64:79]
    ds_read_b64_tr_b16 v[24:25], v7 offset:12288
    ds_read_b64_tr_b16 v[26:27], v8 offset:12288
    v_mfma_f32_32x32x16_bf16 v[80:95], v[164:167], v[36:39], v[80:95]
    ds_read_b64_tr_b16 v[28:29], v9 offset:12288
    ds_read_b64_tr_b16 v[30:31], v10 offset:12288
    s_waitcnt lgkmcnt(8)
    v_mfma_f32_32x32x16_bf16 v[64:79], v[40:43], v[168:171], v[64:79]
    ds_read_b64_tr_b16 v[32:33], v7 offset:13312
    ds_read_b64_tr_b16 v[34:35], v8 offset:13312
    v_mfma_f32_32x32x16_bf16 v[80:95], v[168:171], v[44:47], v[80:95]
    ds_read_b64_tr_b16 v[36:37], v9 offset:13312
    ds_read_b64_tr_b16 v[38:39], v10 offset:13312
    s_waitcnt lgkmcnt(8)
    v_mfma_f32_32x32x16_bf16 v[64:79], v[48:51], v[172:175], v[64:79]
    ds_read_b64_tr_b16 v[40:41], v7 offset:14336
    ds_read_b64_tr_b16 v[42:43], v8 offset:14336
    v_mfma_f32_32x32x16_bf16 v[80:95], v[172:175], v[52:55], v[80:95]
    ds_read_b64_tr_b16 v[44:45], v9 offset:14336
    ds_read_b64_tr_b16 v[46:47], v10 offset:14336
    s_waitcnt lgkmcnt(8)
    v_mfma_f32_32x32x16_bf16 v[64:79], v[24:27], v[176:179], v[64:79]
    ds_read_b64_tr_b16 v[48:49], v7 offset:15360
    ds_read_b64_tr_b16 v[50:51], v8 offset:15360
    v_mfma_f32_32x32x16_bf16 v[80:95], v[176:179], v[28:31], v[80:95]
    ds_read_b64_tr_b16 v[52:53], v9 offset:15360
    ds_read_b64_tr_b16 v[54:55], v10 offset:15360
    s_waitcnt lgkmcnt(8)
    v_mfma_f32_32x32x16_bf16 v[64:79], v[32:35], v[180:183], v[64:79]
    ds_read_b64_tr_b16 v[24:25], v7 offset:16384
    ds_read_b64_tr_b16 v[26:27], v8 offset:16384
    v_mfma_f32_32x32x16_bf16 v[80:95], v[180:183], v[36:39], v[80:95]
    ds_read_b64_tr_b16 v[28:29], v9 offset:16384
    ds_read_b64_tr_b16 v[30:31], v10 offset:16384
    s_waitcnt lgkmcnt(8)
    v_mfma_f32_32x32x16_bf16 v[64:79], v[40:43], v[184:187], v[64:79]
    ds_read_b64_tr_b16 v[32:33], v7 offset:17408
    ds_read_b64_tr_b16 v[34:35], v8 offset:17408
    v_mfma_f32_32x32x16_bf16 v[80:95], v[184:187], v[44:47], v[80:95]
    ds_read_b64_tr_b16 v[36:37], v9 offset:17408
    ds_read_b64_tr_b16 v[38:39], v10 offset:17408
    s_waitcnt lgkmcnt(8)
    v_mfma_f32_32x32x16_bf16 v[64:79], v[48:51], v[188:191], v[64:79]
    ds_read_b64_tr_b16 v[40:41], v7 offset:18432
    ds_read_b64_tr_b16 v[42:43], v8 offset:18432
    v_mfma_f32_32x32x16_bf16 v[80:95], v[188:191], v[52:55], v[80:95]
    ds_read_b64_tr_b16 v[44:45], v9 offset:18432
    ds_read_b64_tr_b16 v[46:47], v10 offset:18432
    s_waitcnt lgkmcnt(8)
    v_mfma_f32_32x32x16_bf16 v[64:79], v[24:27], v[192:195], v[64:79]
    ds_read_b64_tr_b16 v[48:49], v7 offset:19456
    ds_read_b64_tr_b16 v[50:51], v8 offset:19456
    v_mfma_f32_32x32x16_bf16 v[80:95], v[192:195], v[28:31], v[80:95]
    ds_read_b64_tr_b16 v[52:53], v9 offset:19456
    ds_read_b64_tr_b16 v[54:55], v10 offset:19456
    s_waitcnt lgkmcnt(8)
    v_mfma_f32_32x32x16_bf16 v[64:79], v[32:35], v[196:199], v[64:79]
    ds_read_b64_tr_b16 v[24:25], v7 offset:20480
    ds_read_b64_tr_b16 v[26:27], v8 offset:20480
    v_mfma_f32_32x32x16_bf16 v[80:95], v[196:199], v[36:39], v[80:95]
    ds_read_b64_tr_b16 v[28:29], v9 offset:20480
    ds_read_b64_tr_b16 v[30:31], v10 offset:20480
    s_waitcnt lgkmcnt(8)
    v_mfma_f32_32x32x16_bf16 v[64:79], v[40:43], v[200:203], v[64:79]
    ds_read_b64_tr_b16 v[32:33], v7 offset:21504
    ds_read_b64_tr_b16 v[34:35], v8 offset:21504
    v_mfma_f32_32x32x16_bf16 v[80:95], v[200:203], v[44:47], v[80:95]
    ds_read_b64_tr_b16 v[36:37], v9 offset:21504
    ds_read_b64_tr_b16 v[38:39], v10 offset:21504
    s_waitcnt lgkmcnt(8)
    v_mfma_f32_32x32x16_bf16 v[64:79], v[48:51], v[204:207], v[64:79]
    ds_read_b64_tr_b16 v[40:41], v7 offset:22528
    ds_read_b64_tr_b16 v[42:43], v8 offset:22528
    v_mfma_f32_32x32x16_bf16 v[80:95], v[204:207], v[52:55], v[80:95]
    ds_read_b64_tr_b16 v[44:45], v9 offset:22528
    ds_read_b64_tr_b16 v[46:47], v10 offset:22528
    s_waitcnt lgkmcnt(8)
    v_mfma_f32_32x32x16_bf16 v[64:79], v[24:27], v[208:211], v[64:79]
    ds_read_b64_tr_b16 v[48:49], v7 offset:23552
    ds_read_b64_tr_b16 v[50:51], v8 offset:23552
    v_mfma_f32_32x32x16_bf16 v[80:95], v[208:211], v[28:31], v[80:95]
    ds_read_b64_tr_b16 v[52:53], v9 offset:23552
    ds_read_b64_tr_b16 v[54:55], v10 offset:23552
    s_waitcnt lgkmcnt(8)
    v_mfma_f32_32x32x16_bf16 v[64:79], v[32:35], v[212:215], v[64:79]
    ds_read_b64_tr_b16 v[24:25], v7 offset:24576
    ds_read_b64_tr_b16 v[26:27], v8 offset:24576
    v_mfma_f32_32x32x16_bf16 v[80:95], v[212:215], v[36:39], v[80:95]
    ds_read_b64_tr_b16 v[28:29], v9 offset:24576
    ds_read_b64_tr_b16 v[30:31], v10 offset:24576
    s_waitcnt lgkmcnt(8)
    v_mfma_f32_32x32x16_bf16 v[64:79], v[40:43], v[216:219], v[64:79]
    ds_read_b64_tr_b16 v[32:33], v7 offset:25600
    ds_read_b64_tr_b16 v[34:35], v8 offset:25600
    v_mfma_f32_32x32x16_bf16 v[80:95], v[216:219], v[44:47], v[80:95]
    ds_read_b64_tr_b16 v[36:37], v9 offset:25600
    ds_read_b64_tr_b16 v[38:39], v10 offset:25600
    s_waitcnt lgkmcnt(8)
    v_mfma_f32_32x32x16_bf16 v[64:79], v[48:51], v[220:223], v[64:79]
    ds_read_b64_tr_b16 v[40:41], v7 offset:26624
    ds_read_b64_tr_b16 v[42:43], v8 offset:26624
    v_mfma_f32_32x32x16_bf16 v[80:95], v[220:223], v[52:55], v[80:95]
    ds_read_b64_tr_b16 v[44:45], v9 offset:26624
    ds_read_b64_tr_b16 v[46:47], v10 offset:26624
    s_waitcnt lgkmcnt(8)
    v_mfma_f32_32x32x16_bf16 v[64:79], v[24:27], v[224:227], v[64:79]
    ds_read_b64_tr_b16 v[48:49], v7 offset:27648
    ds_read_b64_tr_b16 v[50:51], v8 offset:27648
    v_mfma_f32_32x32x16_bf16 v[80:95], v[224:227], v[28:31], v[80:95]
    ds_read_b64_tr_b16 v[52:53], v9 offset:27648
    ds_read_b64_tr_b16 v[54:55], v10 offset:27648
    s_waitcnt lgkmcnt(8)
    v_mfma_f32_32x32x16_bf16 v[64:79], v[32:35], v[228:231], v[64:79]
    ds_read_b64_tr_b16 v[24:25], v7 offset:28672
    ds_read_b64_tr_b16 v[26:27], v8 offset:28672
    v_add_f32 v112, v112, v114
    v_add_f32 v113, v113, v115
    v_mov_b32 v114, v112
    v_mfma_f32_32x32x16_bf16 v[80:95], v[228:231], v[36:39], v[80:95]
    ds_read_b64_tr_b16 v[28:29], v9 offset:28672
    ds_read_b64_tr_b16 v[30:31], v10 offset:28672
    v_mov_b32 v115, v113
    v_mov_b32 v18, 0
    v_mov_b32 v19, 0
    s_waitcnt lgkmcnt(8)
    v_mfma_f32_32x32x16_bf16 v[64:79], v[40:43], v[232:235], v[64:79]
    ds_read_b64_tr_b16 v[32:33], v7 offset:29696
    ds_read_b64_tr_b16 v[34:35], v8 offset:29696
    v_permlane32_swap_b32 v112, v114
    v_permlane32_swap_b32 v113, v115
    s_lshl_b32 s46, s3, 7
    v_mfma_f32_32x32x16_bf16 v[80:95], v[232:235], v[44:47], v[80:95]
    ds_read_b64_tr_b16 v[36:37], v9 offset:29696
    ds_read_b64_tr_b16 v[38:39], v10 offset:29696
    v_lshlrev_b32 v14, 2, v2
    v_add_f32 v112, v112, v114
    v_add_f32 v113, v113, v115
    s_waitcnt lgkmcnt(8)
    v_mfma_f32_32x32x16_bf16 v[64:79], v[48:51], v[236:239], v[64:79]
    ds_read_b64_tr_b16 v[40:41], v7 offset:30720
    ds_read_b64_tr_b16 v[42:43], v8 offset:30720
    v_mul_f32 v112, 0x3b000000, v112
    v_mul_f32 v113, 0x3b000000, v113
    v_fma_f32 v113, -v112, v112, v113
    v_mfma_f32_32x32x16_bf16 v[80:95], v[236:239], v[52:55], v[80:95]
    ds_read_b64_tr_b16 v[44:45], v9 offset:30720
    ds_read_b64_tr_b16 v[46:47], v10 offset:30720
    v_max_f32 v113, 0, v113
    v_cvt_pk_bf16_f32 v114, v112, v113
    v_and_b32 v115, 0xffff0000, v114
    s_waitcnt lgkmcnt(8)
    v_mfma_f32_32x32x16_bf16 v[64:79], v[24:27], v[240:243], v[64:79]
    ds_read_b64_tr_b16 v[48:49], v7 offset:31744
    ds_read_b64_tr_b16 v[50:51], v8 offset:31744
    v_add_f32 v115, 0x3727c5ac, v115
    v_cvt_pk_bf16_f32 v115, v115, v115
    v_and_b32 v115, 0xffff0000, v115
    v_mfma_f32_32x32x16_bf16 v[80:95], v[240:243], v[28:31], v[80:95]
    ds_read_b64_tr_b16 v[52:53], v9 offset:31744
    ds_read_b64_tr_b16 v[54:55], v10 offset:31744
    v_sqrt_f32 v115, v115
    v_and_b32 v114, 0xffff, v114
    v_xor_b32 v114, 0x8000, v114
    s_waitcnt lgkmcnt(8)
    v_mfma_f32_32x32x16_bf16 v[64:79], v[32:35], v[244:247], v[64:79]
    ds_read_b64 v[24:25], v15 offset:256
    ds_read_b64 v[28:29], v15 offset:512
    v_cvt_pk_bf16_f32 v115, v115, v115
    v_and_b32 v115, 0xffff0000, v115
    v_rcp_f32 v12, v115
    v_mfma_f32_32x32x16_bf16 v[80:95], v[244:247], v[36:39], v[80:95]
    v_cndmask_b32_e64 v17, 0, v114, s[66:67]
    v_lshl_or_b32 v16, v17, 16, v17
    v_add_u32 v14, s46, v14
    s_waitcnt lgkmcnt(6)
    v_mfma_f32_32x32x16_bf16 v[64:79], v[40:43], v[248:251], v[64:79]
    ds_read_b64 v[32:33], v15 offset:0
    ds_read_b64_tr_b16 v[36:37], v5 offset:31744
    v_mul_f32 v13, 0x3eb8aa3b, v12
    v_lshlrev_b32 v21, 4, v3
    v_add_u32 v21, s46, v21
    ds_write_b32 v14, v12 offset:59392
    ds_read_b128 v[112:115], v21 offset:59392
    ds_read_b128 v[116:119], v21 offset:59424
    ds_read_b128 v[120:123], v21 offset:59456
    ds_read_b128 v[124:127], v21 offset:59488
    v_mfma_f32_32x32x16_bf16 v[80:95], v[248:251], v[44:47], v[80:95]
    ds_read_b64_tr_b16 v[38:39], v6 offset:31744
    s_waitcnt lgkmcnt(10)
    v_mfma_f32_32x32x16_bf16 v[64:79], v[48:51], v[252:255], v[64:79]
    ds_read_b64_tr_b16 v[40:41], v5 offset:30720
    ds_read_b64_tr_b16 v[42:43], v6 offset:30720
    v_mfma_f32_32x32x16_bf16 v[80:95], v[252:255], v[52:55], v[80:95]
    ds_read_b64_tr_b16 v[44:45], v5 offset:29696
    ds_read_b64_tr_b16 v[46:47], v6 offset:29696
    s_waitcnt vmcnt(0)
    s_branch L_g_join_140
L_fb_165:
    s_ashr_i32 s51, s92, 15
    s_add_u32 s51, s51, s54
    v_mov_b32 v25, 0xff800000
    s_mov_b32 s50, 0
L_fbA_168:
    s_cmp_eq_u32 s50, 0
    s_cselect_b32 s48, 0, 4
    s_cmp_eq_u32 s50, 8
    s_cselect_b32 s48, 1, s48
    s_cmp_gt_u32 s50, s51
    s_cselect_b32 s48, 5, s48
    s_lshl_b32 s48, s48, 8
    v_lshlrev_b32 v14, 2, v3
    v_sub_u32 v14, v14, v2
    v_lshlrev_b32 v14, 2, v14
    v_add_u32 v14, 60032, v14
    v_add_u32 v14, s48, v14
    ds_read2_b32 v[232:233], v14 offset0:0 offset1:1
    ds_read2_b32 v[234:235], v14 offset0:2 offset1:3
    ds_read2_b32 v[236:237], v14 offset0:8 offset1:9
    ds_read2_b32 v[238:239], v14 offset0:10 offset1:11
    ds_read2_b32 v[240:241], v14 offset0:16 offset1:17
    ds_read2_b32 v[242:243], v14 offset0:18 offset1:19
    ds_read2_b32 v[244:245], v14 offset0:24 offset1:25
    ds_read2_b32 v[246:247], v14 offset0:26 offset1:27
    s_mul_i32 s49, s50, 4128
    s_sub_u32 s49, 33024, s49
    v_add_u32 v26, s49, v248
    v_add_u32 v28, s49, v249
    ds_read_b128 v[160:163], v26 offset:0
    s_waitcnt lgkmcnt(0)
    v_mfma_f32_32x32x16_bf16 v[64:79], v[160:163], v[16:19], v[232:247]
    s_nop 7
    s_nop 7
    v_max3_f32 v25, v25, v64, v65
    v_max3_f32 v25, v25, v66, v67
    v_max3_f32 v25, v25, v68, v69
    v_max3_f32 v25, v25, v70, v71
    v_max3_f32 v25, v25, v72, v73
    v_max3_f32 v25, v25, v74, v75
    v_max3_f32 v25, v25, v76, v77
    v_max3_f32 v25, v25, v78, v79
    s_add_u32 s50, s50, 1
    s_cmp_le_u32 s50, 8
    s_cbranch_scc1 L_fbA_168
    v_mov_b32 v27, v25
    s_nop 1
    v_permlane32_swap_b32 v25, v27
    s_nop 1
    v_max_f32 v25, v25, v27
    v_mov_b32 v96, 0
    v_mov_b32 v97, 0
    v_mov_b32 v98, 0
    v_mov_b32 v99, 0
    v_mov_b32 v100, 0
    v_mov_b32 v101, 0
    v_mov_b32 v102, 0
    v_mov_b32 v103, 0
    v_mov_b32 v104, 0
    v_mov_b32 v105, 0
    v_mov_b32 v106, 0
    v_mov_b32 v107, 0
    v_mov_b32 v108, 0
    v_mov_b32 v109, 0
    v_mov_b32 v110, 0
    v_mov_b32 v111, 0
    s_mov_b32 s50, 0
L_fbB_169:
    s_cmp_eq_u32 s50, 0
    s_cselect_b32 s48, 0, 4
    s_cmp_eq_u32 s50, 8
    s_cselect_b32 s48, 1, s48
    s_cmp_gt_u32 s50, s51
    s_cselect_b32 s48, 5, s48
    s_lshl_b32 s48, s48, 8
    v_lshlrev_b32 v14, 2, v3
    v_sub_u32 v14, v14, v2
    v_lshlrev_b32 v14, 2, v14
    v_add_u32 v14, 60032, v14
    v_add_u32 v14, s48, v14
    ds_read2_b32 v[232:233], v14 offset0:0 offset1:1
    ds_read2_b32 v[234:235], v14 offset0:2 offset1:3
    ds_read2_b32 v[236:237], v14 offset0:8 offset1:9
    ds_read2_b32 v[238:239], v14 offset0:10 offset1:11
    ds_read2_b32 v[240:241], v14 offset0:16 offset1:17
    ds_read2_b32 v[242:243], v14 offset0:18 offset1:19
    ds_read2_b32 v[244:245], v14 offset0:24 offset1:25
    ds_read2_b32 v[246:247], v14 offset0:26 offset1:27
    s_mul_i32 s49, s50, 4128
    s_sub_u32 s49, 33024, s49
    v_add_u32 v26, s49, v248
    v_add_u32 v28, s49, v249
    ds_read_b128 v[160:163], v26 offset:0
    ds_read_b128 v[164:167], v28 offset:2048
    ds_read_b128 v[168:171], v28 offset:3088
    s_waitcnt lgkmcnt(0)
    v_mfma_f32_32x32x16_bf16 v[64:79], v[160:163], v[16:19], v[232:247]
    s_nop 7
    s_nop 7
    v_sub_f32 v64, v64, v25
    v_sub_f32 v65, v65, v25
    v_sub_f32 v66, v66, v25
    v_sub_f32 v67, v67, v25
    v_sub_f32 v68, v68, v25
    v_sub_f32 v69, v69, v25
    v_sub_f32 v70, v70, v25
    v_sub_f32 v71, v71, v25
    v_sub_f32 v72, v72, v25
    v_sub_f32 v73, v73, v25
    v_sub_f32 v74, v74, v25
    v_sub_f32 v75, v75, v25
    v_sub_f32 v76, v76, v25
    v_sub_f32 v77, v77, v25
    v_sub_f32 v78, v78, v25
    v_sub_f32 v79, v79, v25
    v_exp_f32 v64, v64
    v_exp_f32 v65, v65
    v_exp_f32 v66, v66
    v_exp_f32 v67, v67
    v_exp_f32 v68, v68
    v_exp_f32 v69, v69
    v_exp_f32 v70, v70
    v_exp_f32 v71, v71
    v_exp_f32 v72, v72
    v_exp_f32 v73, v73
    v_exp_f32 v74, v74
    v_exp_f32 v75, v75
    v_exp_f32 v76, v76
    v_exp_f32 v77, v77
    v_exp_f32 v78, v78
    v_exp_f32 v79, v79
    s_nop 0
    v_cvt_pk_bf16_f32 v64, v64, v65
    v_cvt_pk_bf16_f32 v65, v66, v67
    v_cvt_pk_bf16_f32 v66, v68, v69
    v_cvt_pk_bf16_f32 v67, v70, v71
    v_cvt_pk_bf16_f32 v68, v72, v73
    v_cvt_pk_bf16_f32 v69, v74, v75
    v_cvt_pk_bf16_f32 v70, v76, v77
    v_cvt_pk_bf16_f32 v71, v78, v79
    s_nop 1
    v_mfma_f32_32x32x16_bf16 v[96:111], v[164:167], v[64:67], v[96:111]
L_fbv_170:
    v_mfma_f32_32x32x16_bf16 v[96:111], v[168:171], v[68:71], v[96:111]
    s_nop 7
    s_nop 7
    s_add_u32 s50, s50, 1
    s_cmp_le_u32 s50, 8
    s_cbranch_scc1 L_fbB_169
    s_ashr_i32 s51, s94, 15
    s_add_u32 s51, s51, s54
    v_mov_b32 v25, 0xff800000
    s_mov_b32 s50, 0
L_fbA_171:
    s_cmp_eq_u32 s50, 0
    s_cselect_b32 s48, 0, 4
    s_cmp_eq_u32 s50, 8
    s_cselect_b32 s48, 1, s48
    s_cmp_gt_u32 s50, s51
    s_cselect_b32 s48, 5, s48
    s_lshl_b32 s48, s48, 8
    v_lshlrev_b32 v14, 2, v3
    v_sub_u32 v14, v14, v2
    v_lshlrev_b32 v14, 2, v14
    v_add_u32 v14, 60032, v14
    v_add_u32 v14, s48, v14
    ds_read2_b32 v[232:233], v14 offset0:0 offset1:1
    ds_read2_b32 v[234:235], v14 offset0:2 offset1:3
    ds_read2_b32 v[236:237], v14 offset0:8 offset1:9
    ds_read2_b32 v[238:239], v14 offset0:10 offset1:11
    ds_read2_b32 v[240:241], v14 offset0:16 offset1:17
    ds_read2_b32 v[242:243], v14 offset0:18 offset1:19
    ds_read2_b32 v[244:245], v14 offset0:24 offset1:25
    ds_read2_b32 v[246:247], v14 offset0:26 offset1:27
    s_mul_i32 s49, s50, 4128
    s_sub_u32 s49, 33024, s49
    v_add_u32 v26, s49, v251
    v_add_u32 v28, s49, v250
    ds_read_b128 v[160:163], v26 offset:0
    s_waitcnt lgkmcnt(0)
    v_mfma_f32_32x32x16_bf16 v[64:79], v[160:163], v[20:23], v[232:247]
    s_nop 7
    s_nop 7
    v_max3_f32 v25, v25, v64, v65
    v_max3_f32 v25, v25, v66, v67
    v_max3_f32 v25, v25, v68, v69
    v_max3_f32 v25, v25, v70, v71
    v_max3_f32 v25, v25, v72, v73
    v_max3_f32 v25, v25, v74, v75
    v_max3_f32 v25, v25, v76, v77
    v_max3_f32 v25, v25, v78, v79
    s_add_u32 s50, s50, 1
    s_cmp_le_u32 s50, 8
    s_cbranch_scc1 L_fbA_171
    v_mov_b32 v27, v25
    s_nop 1
    v_permlane32_swap_b32 v25, v27
    s_nop 1
    v_max_f32 v25, v25, v27
    v_mov_b32 v112, 0
    v_mov_b32 v113, 0
    v_mov_b32 v114, 0
    v_mov_b32 v115, 0
    v_mov_b32 v116, 0
    v_mov_b32 v117, 0
    v_mov_b32 v118, 0
    v_mov_b32 v119, 0
    v_mov_b32 v120, 0
    v_mov_b32 v121, 0
    v_mov_b32 v122, 0
    v_mov_b32 v123, 0
    v_mov_b32 v124, 0
    v_mov_b32 v125, 0
    v_mov_b32 v126, 0
    v_mov_b32 v127, 0
    s_mov_b32 s50, 0
L_fbB_172:
    s_cmp_eq_u32 s50, 0
    s_cselect_b32 s48, 0, 4
    s_cmp_eq_u32 s50, 8
    s_cselect_b32 s48, 1, s48
    s_cmp_gt_u32 s50, s51
    s_cselect_b32 s48, 5, s48
    s_lshl_b32 s48, s48, 8
    v_lshlrev_b32 v14, 2, v3
    v_sub_u32 v14, v14, v2
    v_lshlrev_b32 v14, 2, v14
    v_add_u32 v14, 60032, v14
    v_add_u32 v14, s48, v14
    ds_read2_b32 v[232:233], v14 offset0:0 offset1:1
    ds_read2_b32 v[234:235], v14 offset0:2 offset1:3
    ds_read2_b32 v[236:237], v14 offset0:8 offset1:9
    ds_read2_b32 v[238:239], v14 offset0:10 offset1:11
    ds_read2_b32 v[240:241], v14 offset0:16 offset1:17
    ds_read2_b32 v[242:243], v14 offset0:18 offset1:19
    ds_read2_b32 v[244:245], v14 offset0:24 offset1:25
    ds_read2_b32 v[246:247], v14 offset0:26 offset1:27
    s_mul_i32 s49, s50, 4128
    s_sub_u32 s49, 33024, s49
    v_add_u32 v26, s49, v251
    v_add_u32 v28, s49, v250
    ds_read_b128 v[160:163], v26 offset:0
    ds_read_b128 v[164:167], v28 offset:2048
    ds_read_b128 v[168:171], v28 offset:3088
    s_waitcnt lgkmcnt(0)
    v_mfma_f32_32x32x16_bf16 v[64:79], v[160:163], v[20:23], v[232:247]
    s_nop 7
    s_nop 7
    v_sub_f32 v64, v64, v25
    v_sub_f32 v65, v65, v25
    v_sub_f32 v66, v66, v25
    v_sub_f32 v67, v67, v25
    v_sub_f32 v68, v68, v25
    v_sub_f32 v69, v69, v25
    v_sub_f32 v70, v70, v25
    v_sub_f32 v71, v71, v25
    v_sub_f32 v72, v72, v25
    v_sub_f32 v73, v73, v25
    v_sub_f32 v74, v74, v25
    v_sub_f32 v75, v75, v25
    v_sub_f32 v76, v76, v25
    v_sub_f32 v77, v77, v25
    v_sub_f32 v78, v78, v25
    v_sub_f32 v79, v79, v25
    v_exp_f32 v64, v64
    v_exp_f32 v65, v65
    v_exp_f32 v66, v66
    v_exp_f32 v67, v67
    v_exp_f32 v68, v68
    v_exp_f32 v69, v69
    v_exp_f32 v70, v70
    v_exp_f32 v71, v71
    v_exp_f32 v72, v72
    v_exp_f32 v73, v73
    v_exp_f32 v74, v74
    v_exp_f32 v75, v75
    v_exp_f32 v76, v76
    v_exp_f32 v77, v77
    v_exp_f32 v78, v78
    v_exp_f32 v79, v79
    s_nop 0
    v_cvt_pk_bf16_f32 v64, v64, v65
    v_cvt_pk_bf16_f32 v65, v66, v67
    v_cvt_pk_bf16_f32 v66, v68, v69
    v_cvt_pk_bf16_f32 v67, v70, v71
    v_cvt_pk_bf16_f32 v68, v72, v73
    v_cvt_pk_bf16_f32 v69, v74, v75
    v_cvt_pk_bf16_f32 v70, v76, v77
    v_cvt_pk_bf16_f32 v71, v78, v79
    s_nop 1
    v_mfma_f32_32x32x16_bf16 v[112:127], v[164:167], v[64:67], v[112:127]
L_fbv_173:
    v_mfma_f32_32x32x16_bf16 v[112:127], v[168:171], v[68:71], v[112:127]
    s_nop 7
    s_nop 7
    s_add_u32 s50, s50, 1
    s_cmp_le_u32 s50, 8
    s_cbranch_scc1 L_fbB_172
    s_branch L_fb2_167
L_fb2_167:
    v_rcp_f32 v28, v120
    v_mov_b32 v29, 0x10000
    v_mul_f32 v112, v28, v112
    v_mul_f32 v113, v28, v113
    v_mul_f32 v114, v28, v114
    v_mul_f32 v115, v28, v115
    v_mul_f32 v116, v28, v116
    v_mul_f32 v117, v28, v117
    v_mul_f32 v118, v28, v118
    v_mul_f32 v119, v28, v119
    v_add_u32 v113, s75, v113
    v_and_b32 v113, 0xfffe0000, v113
    v_cvt_pk_bf16_f32 v68, v112, v113
    v_cvt_pk_bf16_f32 v69, v114, v115
    v_cvt_pk_bf16_f32 v70, v116, v117
    v_cvt_pk_bf16_f32 v71, v118, v119
    v_bfi_b32 v68, v29, s74, v68
    s_branch L_fbk_166
L_g_redo_199:
    s_mov_b32 s52, 0
    s_waitcnt vmcnt(0) lgkmcnt(0)
    s_nop 7
    s_nop 7
L_g_rl_200:
    buffer_load_dwordx4 v[128:131], v4, s[28:31], s78 offen offset:0 sc1
    buffer_load_dwordx4 v[132:135], v4, s[28:31], s78 offen offset:1024 sc1
    buffer_load_dwordx4 v[136:139], v4, s[28:31], s78 offen offset:2048 sc1
    buffer_load_dwordx4 v[140:143], v4, s[28:31], s78 offen offset:3072 sc1
    buffer_load_dwordx4 v[144:147], v4, s[28:31], s79 offen offset:0 sc1
    buffer_load_dwordx4 v[148:151], v4, s[28:31], s79 offen offset:1024 sc1
    buffer_load_dwordx4 v[152:155], v4, s[28:31], s79 offen offset:2048 sc1
    buffer_load_dwordx4 v[156:159], v4, s[28:31], s79 offen offset:3072 sc1
    buffer_load_dwordx4 v[160:163], v4, s[28:31], s80 offen offset:0 sc1
    buffer_load_dwordx4 v[164:167], v4, s[28:31], s80 offen offset:1024 sc1
    buffer_load_dwordx4 v[168:171], v4, s[28:31], s80 offen offset:2048 sc1
    buffer_load_dwordx4 v[172:175], v4, s[28:31], s80 offen offset:3072 sc1
    buffer_load_dwordx4 v[176:179], v4, s[28:31], s81 offen offset:0 sc1
    buffer_load_dwordx4 v[180:183], v4, s[28:31], s81 offen offset:1024 sc1
    buffer_load_dwordx4 v[184:187], v4, s[28:31], s81 offen offset:2048 sc1
    buffer_load_dwordx4 v[188:191], v4, s[28:31], s81 offen offset:3072 sc1
    buffer_load_dwordx4 v[192:195], v4, s[28:31], s82 offen offset:0 sc1
    buffer_load_dwordx4 v[196:199], v4, s[28:31], s82 offen offset:1024 sc1
    buffer_load_dwordx4 v[200:203], v4, s[28:31], s82 offen offset:2048 sc1
    buffer_load_dwordx4 v[204:207], v4, s[28:31], s82 offen offset:3072 sc1
    buffer_load_dwordx4 v[208:211], v4, s[28:31], s83 offen offset:0 sc1
    buffer_load_dwordx4 v[212:215], v4, s[28:31], s83 offen offset:1024 sc1
    buffer_load_dwordx4 v[216:219], v4, s[28:31], s83 offen offset:2048 sc1
    buffer_load_dwordx4 v[220:223], v4, s[28:31], s83 offen offset:3072 sc1
    buffer_load_dwordx4 v[224:227], v4, s[28:31], s64 offen offset:0 sc1
    buffer_load_dwordx4 v[228:231], v4, s[28:31], s64 offen offset:1024 sc1
    buffer_load_dwordx4 v[232:235], v4, s[28:31], s64 offen offset:2048 sc1
    buffer_load_dwordx4 v[236:239], v4, s[28:31], s64 offen offset:3072 sc1
    buffer_load_dwordx4 v[240:243], v4, s[28:31], s65 offen offset:0 sc1
    buffer_load_dwordx4 v[244:247], v4, s[28:31], s65 offen offset:1024 sc1
    buffer_load_dwordx4 v[248:251], v4, s[28:31], s65 offen offset:2048 sc1
    buffer_load_dwordx4 v[252:255], v4, s[28:31], s65 offen offset:3072 sc1
    buffer_load_dwordx4 v[112:115], v4, s[36:39], s60 offen sc1
    s_waitcnt vmcnt(0)
    v_lshlrev_b32 v60, 16, v112
    v_lshlrev_b32 v61, 16, v114
    v_xor_b32 v14, s75, v128
    v_bitop3_b32 v14, v14, v132, s75 bitop3:0xf6
    v_bitop3_b32 v14, v14, v136, s75 bitop3:0xf6
    v_bitop3_b32 v14, v14, v140, s75 bitop3:0xf6
    v_bitop3_b32 v14, v14, v144, s75 bitop3:0xf6
    v_bitop3_b32 v14, v14, v148, s75 bitop3:0xf6
    v_bitop3_b32 v14, v14, v152, s75 bitop3:0xf6
    v_bitop3_b32 v14, v14, v156, s75 bitop3:0xf6
    v_bitop3_b32 v14, v14, v160, s75 bitop3:0xf6
    v_bitop3_b32 v14, v14, v164, s75 bitop3:0xf6
    v_bitop3_b32 v14, v14, v168, s75 bitop3:0xf6
    v_bitop3_b32 v14, v14, v172, s75 bitop3:0xf6
    v_bitop3_b32 v14, v14, v176, s75 bitop3:0xf6
    v_bitop3_b32 v14, v14, v180, s75 bitop3:0xf6
    v_bitop3_b32 v14, v14, v184, s75 bitop3:0xf6
    v_bitop3_b32 v14, v14, v188, s75 bitop3:0xf6
    v_bitop3_b32 v14, v14, v192, s75 bitop3:0xf6
    v_bitop3_b32 v14, v14, v196, s75 bitop3:0xf6
    v_bitop3_b32 v14, v14, v200, s75 bitop3:0xf6
    v_bitop3_b32 v14, v14, v204, s75 bitop3:0xf6
    v_bitop3_b32 v14, v14, v208, s75 bitop3:0xf6
    v_bitop3_b32 v14, v14, v212, s75 bitop3:0xf6
    v_bitop3_b32 v14, v14, v216, s75 bitop3:0xf6
    v_bitop3_b32 v14, v14, v220, s75 bitop3:0xf6
    v_bitop3_b32 v14, v14, v224, s75 bitop3:0xf6
    v_bitop3_b32 v14, v14, v228, s75 bitop3:0xf6
    v_bitop3_b32 v14, v14, v232, s75 bitop3:0xf6
    v_bitop3_b32 v14, v14, v236, s75 bitop3:0xf6
    v_bitop3_b32 v14, v14, v240, s75 bitop3:0xf6
    v_bitop3_b32 v14, v14, v244, s75 bitop3:0xf6
    v_bitop3_b32 v14, v14, v248, s75 bitop3:0xf6
    v_bitop3_b32 v14, v14, v252, s75 bitop3:0xf6
    v_bitop3_b32 v14, v14, v60, s75 bitop3:0xf6
    v_bitop3_b32 v14, v14, v61, s75 bitop3:0xf6
    v_and_b32 v14, 0x10000, v14
    v_cmp_ne_u32 vcc, 0, v14
    s_cbranch_vccz L_g_l0_197
    s_add_u32 s52, s52, 1
    s_cmp_lt_u32 s52, 40000
    s_cbranch_scc1 L_g_rl_200
    s_mov_b64 s[44:45], 0
    s_mov_b32 s71, 2
    s_branch L_g_l0_197
L_g_l0_197:
    v_lshlrev_b32 v15, 3, v2
    v_add_u32 v15, s70, v15
    ds_read_b64_tr_b16 v[24:25], v7 offset:0
    ds_read_b64_tr_b16 v[26:27], v8 offset:0
    ds_read_b64_tr_b16 v[28:29], v9 offset:0
    ds_read_b64_tr_b16 v[30:31], v10 offset:0
    ds_read_b64_tr_b16 v[32:33], v7 offset:1024
    ds_read_b64_tr_b16 v[34:35], v8 offset:1024
    ds_read_b64_tr_b16 v[36:37], v9 offset:1024
    ds_read_b64_tr_b16 v[38:39], v10 offset:1024
    ds_read_b64_tr_b16 v[40:41], v7 offset:2048
    ds_read_b64_tr_b16 v[42:43], v8 offset:2048
    ds_read_b64_tr_b16 v[44:45], v9 offset:2048
    ds_read_b64_tr_b16 v[46:47], v10 offset:2048
    s_waitcnt lgkmcnt(8)
    v_mfma_f32_32x32x16_bf16 v[64:79], v[24:27], v[128:131], 0
    ds_read_b64_tr_b16 v[48:49], v7 offset:3072
    ds_read_b64_tr_b16 v[50:51], v8 offset:3072
    v_mfma_f32_32x32x16_bf16 v[80:95], v[128:131], v[28:31], 0
    ds_read_b64_tr_b16 v[52:53], v9 offset:3072
    ds_read_b64_tr_b16 v[54:55], v10 offset:3072
    s_waitcnt lgkmcnt(8)
    v_mfma_f32_32x32x16_bf16 v[64:79], v[32:35], v[132:135], v[64:79]
    ds_read_b64_tr_b16 v[24:25], v7 offset:4096
    ds_read_b64_tr_b16 v[26:27], v8 offset:4096
    v_mfma_f32_32x32x16_bf16 v[80:95], v[132:135], v[36:39], v[80:95]
    ds_read_b64_tr_b16 v[28:29], v9 offset:4096
    ds_read_b64_tr_b16 v[30:31], v10 offset:4096
    s_waitcnt lgkmcnt(8)
    v_mfma_f32_32x32x16_bf16 v[64:79], v[40:43], v[136:139], v[64:79]
    ds_read_b64_tr_b16 v[32:33], v7 offset:5120
    ds_read_b64_tr_b16 v[34:35], v8 offset:5120
    v_mfma_f32_32x32x16_bf16 v[80:95], v[136:139], v[44:47], v[80:95]
    ds_read_b64_tr_b16 v[36:37], v9 offset:5120
    ds_read_b64_tr_b16 v[38:39], v10 offset:5120
    s_waitcnt lgkmcnt(8)
    v_mfma_f32_32x32x16_bf16 v[64:79], v[48:51], v[140:143], v[64:79]
    ds_read_b64_tr_b16 v[40:41], v7 offset:6144
    ds_read_b64_tr_b16 v[42:43], v8 offset:6144
    v_mfma_f32_32x32x16_bf16 v[80:95], v[140:143], v[52:55], v[80:95]
    ds_read_b64_tr_b16 v[44:45], v9 offset:6144
    ds_read_b64_tr_b16 v[46:47], v10 offset:6144
    s_waitcnt lgkmcnt(8)
    v_mfma_f32_32x32x16_bf16 v[64:79], v[24:27], v[144:147], v[64:79]
    ds_read_b64_tr_b16 v[48:49], v7 offset:7168
    ds_read_b64_tr_b16 v[50:51], v8 offset:7168
    v_mfma_f32_32x32x16_bf16 v[80:95], v[144:147], v[28:31], v[80:95]
    ds_read_b64_tr_b16 v[52:53], v9 offset:7168
    ds_read_b64_tr_b16 v[54:55], v10 offset:7168
    s_waitcnt lgkmcnt(8)
    v_mfma_f32_32x32x16_bf16 v[64:79], v[32:35], v[148:151], v[64:79]
    ds_read_b64_tr_b16 v[24:25], v7 offset:8192
    ds_read_b64_tr_b16 v[26:27], v8 offset:8192
    v_mfma_f32_32x32x16_bf16 v[80:95], v[148:151], v[36:39], v[80:95]
    ds_read_b64_tr_b16 v[28:29], v9 offset:8192
    ds_read_b64_tr_b16 v[30:31], v10 offset:8192
    s_waitcnt lgkmcnt(8)
    v_mfma_f32_32x32x16_bf16 v[64:79], v[40:43], v[152:155], v[64:79]
    ds_read_b64_tr_b16 v[32:33], v7 offset:9216
    ds_read_b64_tr_b16 v[34:35], v8 offset:9216
    v_mfma_f32_32x32x16_bf16 v[80:95], v[152:155], v[44:47], v[80:95]
    ds_read_b64_tr_b16 v[36:37], v9 offset:9216
    ds_read_b64_tr_b16 v[38:39], v10 offset:9216
    s_waitcnt lgkmcnt(8)
    v_mfma_f32_32x32x16_bf16 v[64:79], v[48:51], v[156:159], v[64:79]
    ds_read_b64_tr_b16 v[40:41], v7 offset:10240
    ds_read_b64_tr_b16 v[42:43], v8 offset:10240
    v_mfma_f32_32x32x16_bf16 v[80:95], v[156:159], v[52:55], v[80:95]
    ds_read_b64_tr_b16 v[44:45], v9 offset:10240
    ds_read_b64_tr_b16 v[46:47], v10 offset:10240
    s_waitcnt lgkmcnt(8)
    v_mfma_f32_32x32x16_bf16 v[64:79], v[24:27], v[160:163], v[64:79]
    ds_read_b64_tr_b16 v[48:49], v7 offset:11264
    ds_read_b64_tr_b16 v[50:51], v8 offset:11264
    v_mfma_f32_32x32x16_bf16 v[80:95], v[160:163], v[28:31], v[80:95]
    ds_read_b64_tr_b16 v[52:53], v9 offset:11264
    ds_read_b64_tr_b16 v[54:55], v10 offset:11264
    s_waitcnt lgkmcnt(8)
    v_mfma_f32_32x32x16_bf16 v[64:79], v[32:35], v[164:167], v[64:79]
    ds_read_b64_tr_b16 v[24:25], v7 offset:12288
    ds_read_b64_tr_b16 v[26:27], v8 offset:12288
    v_mfma_f32_32x32x16_bf16 v[80:95], v[164:167], v[36:39], v[80:95]
    ds_read_b64_tr_b16 v[28:29], v9 offset:12288
    ds_read_b64_tr_b16 v[30:31], v10 offset:12288
    s_lshr_b32 s47, s3, 1
    s_waitcnt lgkmcnt(8)
    v_mfma_f32_32x32x16_bf16 v[64:79], v[40:43], v[168:171], v[64:79]
    ds_read_b64_tr_b16 v[32:33], v7 offset:13312
    ds_read_b64_tr_b16 v[34:35], v8 offset:13312
    v_mfma_f32_32x32x16_bf16 v[80:95], v[168:171], v[44:47], v[80:95]
    ds_read_b64_tr_b16 v[36:37], v9 offset:13312
    ds_read_b64_tr_b16 v[38:39], v10 offset:13312
    s_mul_i32 s51, s47, 1040
    s_waitcnt lgkmcnt(8)
    v_mfma_f32_32x32x16_bf16 v[64:79], v[48:51], v[172:175], v[64:79]
    ds_read_b64_tr_b16 v[40:41], v7 offset:14336
    ds_read_b64_tr_b16 v[42:43], v8 offset:14336
    v_mfma_f32_32x32x16_bf16 v[80:95], v[172:175], v[52:55], v[80:95]
    ds_read_b64_tr_b16 v[44:45], v9 offset:14336
    ds_read_b64_tr_b16 v[46:47], v10 offset:14336
    s_lshl_b32 s47, s47, 10
    s_waitcnt lgkmcnt(8)
    v_mfma_f32_32x32x16_bf16 v[64:79], v[24:27], v[176:179], v[64:79]
    ds_read_b64_tr_b16 v[48:49], v7 offset:15360
    ds_read_b64_tr_b16 v[50:51], v8 offset:15360
    v_mfma_f32_32x32x16_bf16 v[80:95], v[176:179], v[28:31], v[80:95]
    ds_read_b64_tr_b16 v[52:53], v9 offset:15360
    ds_read_b64_tr_b16 v[54:55], v10 offset:15360
    s_add_u32 s76, s59, s47
    s_waitcnt lgkmcnt(8)
    v_mfma_f32_32x32x16_bf16 v[64:79], v[32:35], v[180:183], v[64:79]
    ds_read_b64_tr_b16 v[24:25], v7 offset:16384
    ds_read_b64_tr_b16 v[26:27], v8 offset:16384
    v_mfma_f32_32x32x16_bf16 v[80:95], v[180:183], v[36:39], v[80:95]
    ds_read_b64_tr_b16 v[28:29], v9 offset:16384
    ds_read_b64_tr_b16 v[30:31], v10 offset:16384
    s_mul_i32 s47, s3, 15360
    s_waitcnt lgkmcnt(8)
    v_mfma_f32_32x32x16_bf16 v[64:79], v[40:43], v[184:187], v[64:79]
    ds_read_b64_tr_b16 v[32:33], v7 offset:17408
    ds_read_b64_tr_b16 v[34:35], v8 offset:17408
    v_mfma_f32_32x32x16_bf16 v[80:95], v[184:187], v[44:47], v[80:95]
    ds_read_b64_tr_b16 v[36:37], v9 offset:17408
    ds_read_b64_tr_b16 v[38:39], v10 offset:17408
    s_sub_u32 s76, s76, s47
    s_waitcnt lgkmcnt(8)
    v_mfma_f32_32x32x16_bf16 v[64:79], v[48:51], v[188:191], v[64:79]
    ds_read_b64_tr_b16 v[40:41], v7 offset:18432
    ds_read_b64_tr_b16 v[42:43], v8 offset:18432
    v_mfma_f32_32x32x16_bf16 v[80:95], v[188:191], v[52:55], v[80:95]
    ds_read_b64_tr_b16 v[44:45], v9 offset:18432
    ds_read_b64_tr_b16 v[46:47], v10 offset:18432
    s_sub_u32 s76, s76, 16384
    s_waitcnt lgkmcnt(8)
    v_mfma_f32_32x32x16_bf16 v[64:79], v[24:27], v[192:195], v[64:79]
    ds_read_b64_tr_b16 v[48:49], v7 offset:19456
    ds_read_b64_tr_b16 v[50:51], v8 offset:19456
    v_mfma_f32_32x32x16_bf16 v[80:95], v[192:195], v[28:31], v[80:95]
    ds_read_b64_tr_b16 v[52:53], v9 offset:19456
    ds_read_b64_tr_b16 v[54:55], v10 offset:19456
    s_lshl_b32 s47, s3, 10
    s_waitcnt lgkmcnt(8)
    v_mfma_f32_32x32x16_bf16 v[64:79], v[32:35], v[196:199], v[64:79]
    ds_read_b64_tr_b16 v[24:25], v7 offset:20480
    ds_read_b64_tr_b16 v[26:27], v8 offset:20480
    v_mfma_f32_32x32x16_bf16 v[80:95], v[196:199], v[36:39], v[80:95]
    ds_read_b64_tr_b16 v[28:29], v9 offset:20480
    ds_read_b64_tr_b16 v[30:31], v10 offset:20480
    s_add_u32 s51, s51, s47
    s_waitcnt lgkmcnt(8)
    v_mfma_f32_32x32x16_bf16 v[64:79], v[40:43], v[200:203], v[64:79]
    ds_read_b64_tr_b16 v[32:33], v7 offset:21504
    ds_read_b64_tr_b16 v[34:35], v8 offset:21504
    v_mfma_f32_32x32x16_bf16 v[80:95], v[200:203], v[44:47], v[80:95]
    ds_read_b64_tr_b16 v[36:37], v9 offset:21504
    ds_read_b64_tr_b16 v[38:39], v10 offset:21504
    s_add_u32 s77, s51, 28896
    s_waitcnt lgkmcnt(8)
    v_mfma_f32_32x32x16_bf16 v[64:79], v[48:51], v[204:207], v[64:79]
    ds_read_b64_tr_b16 v[40:41], v7 offset:22528
    ds_read_b64_tr_b16 v[42:43], v8 offset:22528
    v_mfma_f32_32x32x16_bf16 v[80:95], v[204:207], v[52:55], v[80:95]
    ds_read_b64_tr_b16 v[44:45], v9 offset:22528
    ds_read_b64_tr_b16 v[46:47], v10 offset:22528
    s_cmp_eq_u32 s4, 0
    s_waitcnt lgkmcnt(8)
    v_mfma_f32_32x32x16_bf16 v[64:79], v[24:27], v[208:211], v[64:79]
    ds_read_b64_tr_b16 v[48:49], v7 offset:23552
    ds_read_b64_tr_b16 v[50:51], v8 offset:23552
    v_mfma_f32_32x32x16_bf16 v[80:95], v[208:211], v[28:31], v[80:95]
    ds_read_b64_tr_b16 v[52:53], v9 offset:23552
    ds_read_b64_tr_b16 v[54:55], v10 offset:23552
    s_cselect_b32 s76, 0x7f000000, s76
    s_waitcnt lgkmcnt(8)
    v_mfma_f32_32x32x16_bf16 v[64:79], v[32:35], v[212:215], v[64:79]
    ds_read_b64_tr_b16 v[24:25], v7 offset:24576
    ds_read_b64_tr_b16 v[26:27], v8 offset:24576
    v_mfma_f32_32x32x16_bf16 v[80:95], v[212:215], v[36:39], v[80:95]
    ds_read_b64_tr_b16 v[28:29], v9 offset:24576
    ds_read_b64_tr_b16 v[30:31], v10 offset:24576
    s_cselect_b32 s27, 0, s93
    s_waitcnt lgkmcnt(8)
    v_mfma_f32_32x32x16_bf16 v[64:79], v[40:43], v[216:219], v[64:79]
    ds_read_b64_tr_b16 v[32:33], v7 offset:25600
    ds_read_b64_tr_b16 v[34:35], v8 offset:25600
    v_mfma_f32_32x32x16_bf16 v[80:95], v[216:219], v[44:47], v[80:95]
    ds_read_b64_tr_b16 v[36:37], v9 offset:25600
    ds_read_b64_tr_b16 v[38:39], v10 offset:25600
    s_waitcnt lgkmcnt(8)
    v_mfma_f32_32x32x16_bf16 v[64:79], v[48:51], v[220:223], v[64:79]
    ds_read_b64_tr_b16 v[40:41], v7 offset:26624
    ds_read_b64_tr_b16 v[42:43], v8 offset:26624
    v_mfma_f32_32x32x16_bf16 v[80:95], v[220:223], v[52:55], v[80:95]
    ds_read_b64_tr_b16 v[44:45], v9 offset:26624
    ds_read_b64_tr_b16 v[46:47], v10 offset:26624
    s_waitcnt lgkmcnt(8)
    v_mfma_f32_32x32x16_bf16 v[64:79], v[24:27], v[224:227], v[64:79]
    ds_read_b64_tr_b16 v[48:49], v7 offset:27648
    ds_read_b64_tr_b16 v[50:51], v8 offset:27648
    v_mfma_f32_32x32x16_bf16 v[80:95], v[224:227], v[28:31], v[80:95]
    ds_read_b64_tr_b16 v[52:53], v9 offset:27648
    ds_read_b64_tr_b16 v[54:55], v10 offset:27648
    s_waitcnt lgkmcnt(8)
    v_mfma_f32_32x32x16_bf16 v[64:79], v[32:35], v[228:231], v[64:79]
    ds_read_b64_tr_b16 v[24:25], v7 offset:28672
    ds_read_b64_tr_b16 v[26:27], v8 offset:28672
    v_add_f32 v112, v112, v114
    v_add_f32 v113, v113, v115
    v_mov_b32 v114, v112
    v_mfma_f32_32x32x16_bf16 v[80:95], v[228:231], v[36:39], v[80:95]
    ds_read_b64_tr_b16 v[28:29], v9 offset:28672
    ds_read_b64_tr_b16 v[30:31], v10 offset:28672
    v_mov_b32 v115, v113
    v_mov_b32 v18, 0
    v_mov_b32 v19, 0
    s_waitcnt lgkmcnt(8)
    v_mfma_f32_32x32x16_bf16 v[64:79], v[40:43], v[232:235], v[64:79]
    ds_read_b64_tr_b16 v[32:33], v7 offset:29696
    ds_read_b64_tr_b16 v[34:35], v8 offset:29696
    v_permlane32_swap_b32 v112, v114
    v_permlane32_swap_b32 v113, v115
    s_lshl_b32 s46, s3, 7
    v_mfma_f32_32x32x16_bf16 v[80:95], v[232:235], v[44:47], v[80:95]
    ds_read_b64_tr_b16 v[36:37], v9 offset:29696
    ds_read_b64_tr_b16 v[38:39], v10 offset:29696
    v_lshlrev_b32 v14, 2, v2
    v_add_f32 v112, v112, v114
    v_add_f32 v113, v113, v115
    s_waitcnt lgkmcnt(8)
    v_mfma_f32_32x32x16_bf16 v[64:79], v[48:51], v[236:239], v[64:79]
    ds_read_b64_tr_b16 v[40:41], v7 offset:30720
    ds_read_b64_tr_b16 v[42:43], v8 offset:30720
    v_mul_f32 v112, 0x3b000000, v112
    v_mul_f32 v113, 0x3b000000, v113
    v_fma_f32 v113, -v112, v112, v113
    v_mfma_f32_32x32x16_bf16 v[80:95], v[236:239], v[52:55], v[80:95]
    ds_read_b64_tr_b16 v[44:45], v9 offset:30720
    ds_read_b64_tr_b16 v[46:47], v10 offset:30720
    v_max_f32 v113, 0, v113
    v_cvt_pk_bf16_f32 v114, v112, v113
    v_and_b32 v115, 0xffff0000, v114
    s_waitcnt lgkmcnt(8)
    v_mfma_f32_32x32x16_bf16 v[64:79], v[24:27], v[240:243], v[64:79]
    ds_read_b64_tr_b16 v[48:49], v7 offset:31744
    ds_read_b64_tr_b16 v[50:51], v8 offset:31744
    v_add_f32 v115, 0x3727c5ac, v115
    v_cvt_pk_bf16_f32 v115, v115, v115
    v_and_b32 v115, 0xffff0000, v115
    v_mfma_f32_32x32x16_bf16 v[80:95], v[240:243], v[28:31], v[80:95]
    ds_read_b64_tr_b16 v[52:53], v9 offset:31744
    ds_read_b64_tr_b16 v[54:55], v10 offset:31744
    v_sqrt_f32 v115, v115
    v_and_b32 v114, 0xffff, v114
    v_xor_b32 v114, 0x8000, v114
    s_waitcnt lgkmcnt(8)
    v_mfma_f32_32x32x16_bf16 v[64:79], v[32:35], v[244:247], v[64:79]
    ds_read_b64 v[24:25], v15 offset:256
    ds_read_b64 v[28:29], v15 offset:512
    v_cvt_pk_bf16_f32 v115, v115, v115
    v_and_b32 v115, 0xffff0000, v115
    v_rcp_f32 v12, v115
    v_mfma_f32_32x32x16_bf16 v[80:95], v[244:247], v[36:39], v[80:95]
    v_cndmask_b32_e64 v17, 0, v114, s[66:67]
    v_lshl_or_b32 v16, v17, 16, v17
    v_add_u32 v14, s46, v14
    s_waitcnt lgkmcnt(6)
    v_mfma_f32_32x32x16_bf16 v[64:79], v[40:43], v[248:251], v[64:79]
    ds_read_b64 v[32:33], v15 offset:0
    ds_read_b64_tr_b16 v[36:37], v5 offset:31744
    v_mul_f32 v13, 0x3eb8aa3b, v12
    v_lshlrev_b32 v21, 4, v3
    v_add_u32 v21, s46, v21
    ds_write_b32 v14, v12 offset:59392
    ds_read_b128 v[112:115], v21 offset:59392
    ds_read_b128 v[116:119], v21 offset:59424
    ds_read_b128 v[120:123], v21 offset:59456
    ds_read_b128 v[124:127], v21 offset:59488
    v_mfma_f32_32x32x16_bf16 v[80:95], v[248:251], v[44:47], v[80:95]
    ds_read_b64_tr_b16 v[38:39], v6 offset:31744
    s_waitcnt lgkmcnt(10)
    v_mfma_f32_32x32x16_bf16 v[64:79], v[48:51], v[252:255], v[64:79]
    ds_read_b64_tr_b16 v[40:41], v5 offset:30720
    ds_read_b64_tr_b16 v[42:43], v6 offset:30720
    v_mfma_f32_32x32x16_bf16 v[80:95], v[252:255], v[52:55], v[80:95]
    ds_read_b64_tr_b16 v[44:45], v5 offset:29696
    ds_read_b64_tr_b16 v[46:47], v6 offset:29696
    s_waitcnt vmcnt(0)
    s_branch L_g_join_198
L_fb_215:
    s_mov_b32 s51, s54
    v_mov_b32 v25, 0xff800000
    s_mov_b32 s50, 0
L_fbA_218:
    s_cmp_eq_u32 s50, 0
    s_cselect_b32 s48, 2, 4
    s_cmp_eq_u32 s50, 1
    s_cselect_b32 s48, 3, s48
    s_cmp_gt_u32 s50, s51
    s_cselect_b32 s48, 5, s48
    s_lshl_b32 s48, s48, 8
    v_lshlrev_b32 v14, 2, v3
    v_sub_u32 v14, v14, v2
    v_lshlrev_b32 v14, 2, v14
    v_add_u32 v14, 60032, v14
    v_add_u32 v14, s48, v14
    ds_read2_b32 v[232:233], v14 offset0:0 offset1:1
    ds_read2_b32 v[234:235], v14 offset0:2 offset1:3
    ds_read2_b32 v[236:237], v14 offset0:8 offset1:9
    ds_read2_b32 v[238:239], v14 offset0:10 offset1:11
    ds_read2_b32 v[240:241], v14 offset0:16 offset1:17
    ds_read2_b32 v[242:243], v14 offset0:18 offset1:19
    ds_read2_b32 v[244:245], v14 offset0:24 offset1:25
    ds_read2_b32 v[246:247], v14 offset0:26 offset1:27
    s_mul_i32 s49, s50, 4128
    s_sub_u32 s49, 33024, s49
    v_add_u32 v26, s49, v248
    v_add_u32 v28, s49, v249
    ds_read_b128 v[160:163], v26 offset:0
    s_waitcnt lgkmcnt(0)
    v_mfma_f32_32x32x16_bf16 v[64:79], v[160:163], v[16:19], v[232:247]
    s_nop 7
    s_nop 7
    v_max3_f32 v25, v25, v64, v65
    v_max3_f32 v25, v25, v66, v67
    v_max3_f32 v25, v25, v68, v69
    v_max3_f32 v25, v25, v70, v71
    v_max3_f32 v25, v25, v72, v73
    v_max3_f32 v25, v25, v74, v75
    v_max3_f32 v25, v25, v76, v77
    v_max3_f32 v25, v25, v78, v79
    s_add_u32 s50, s50, 1
    s_cmp_le_u32 s50, 1
    s_cbranch_scc1 L_fbA_218
    v_mov_b32 v27, v25
    s_nop 1
    v_permlane32_swap_b32 v25, v27
    s_nop 1
    v_max_f32 v25, v25, v27
    v_mov_b32 v96, 0
    v_mov_b32 v97, 0
    v_mov_b32 v98, 0
    v_mov_b32 v99, 0
    v_mov_b32 v100, 0
    v_mov_b32 v101, 0
    v_mov_b32 v102, 0
    v_mov_b32 v103, 0
    v_mov_b32 v104, 0
    v_mov_b32 v105, 0
    v_mov_b32 v106, 0
    v_mov_b32 v107, 0
    v_mov_b32 v108, 0
    v_mov_b32 v109, 0
    v_mov_b32 v110, 0
    v_mov_b32 v111, 0
    s_mov_b32 s50, 0
L_fbB_219:
    s_cmp_eq_u32 s50, 0
    s_cselect_b32 s48, 2, 4
    s_cmp_eq_u32 s50, 1
    s_cselect_b32 s48, 3, s48
    s_cmp_gt_u32 s50, s51
    s_cselect_b32 s48, 5, s48
    s_lshl_b32 s48, s48, 8
    v_lshlrev_b32 v14, 2, v3
    v_sub_u32 v14, v14, v2
    v_lshlrev_b32 v14, 2, v14
    v_add_u32 v14, 60032, v14
    v_add_u32 v14, s48, v14
    ds_read2_b32 v[232:233], v14 offset0:0 offset1:1
    ds_read2_b32 v[234:235], v14 offset0:2 offset1:3
    ds_read2_b32 v[236:237], v14 offset0:8 offset1:9
    ds_read2_b32 v[238:239], v14 offset0:10 offset1:11
    ds_read2_b32 v[240:241], v14 offset0:16 offset1:17
    ds_read2_b32 v[242:243], v14 offset0:18 offset1:19
    ds_read2_b32 v[244:245], v14 offset0:24 offset1:25
    ds_read2_b32 v[246:247], v14 offset0:26 offset1:27
    s_mul_i32 s49, s50, 4128
    s_sub_u32 s49, 33024, s49
    v_add_u32 v26, s49, v248
    v_add_u32 v28, s49, v249
    ds_read_b128 v[160:163], v26 offset:0
    ds_read_b128 v[164:167], v28 offset:2048
    ds_read_b128 v[168:171], v28 offset:3088
    s_waitcnt lgkmcnt(0)
    v_mfma_f32_32x32x16_bf16 v[64:79], v[160:163], v[16:19], v[232:247]
    s_nop 7
    s_nop 7
    v_sub_f32 v64, v64, v25
    v_sub_f32 v65, v65, v25
    v_sub_f32 v66, v66, v25
    v_sub_f32 v67, v67, v25
    v_sub_f32 v68, v68, v25
    v_sub_f32 v69, v69, v25
    v_sub_f32 v70, v70, v25
    v_sub_f32 v71, v71, v25
    v_sub_f32 v72, v72, v25
    v_sub_f32 v73, v73, v25
    v_sub_f32 v74, v74, v25
    v_sub_f32 v75, v75, v25
    v_sub_f32 v76, v76, v25
    v_sub_f32 v77, v77, v25
    v_sub_f32 v78, v78, v25
    v_sub_f32 v79, v79, v25
    v_exp_f32 v64, v64
    v_exp_f32 v65, v65
    v_exp_f32 v66, v66
    v_exp_f32 v67, v67
    v_exp_f32 v68, v68
    v_exp_f32 v69, v69
    v_exp_f32 v70, v70
    v_exp_f32 v71, v71
    v_exp_f32 v72, v72
    v_exp_f32 v73, v73
    v_exp_f32 v74, v74
    v_exp_f32 v75, v75
    v_exp_f32 v76, v76
    v_exp_f32 v77, v77
    v_exp_f32 v78, v78
    v_exp_f32 v79, v79
    s_nop 0
    v_cvt_pk_bf16_f32 v64, v64, v65
    v_cvt_pk_bf16_f32 v65, v66, v67
    v_cvt_pk_bf16_f32 v66, v68, v69
    v_cvt_pk_bf16_f32 v67, v70, v71
    v_cvt_pk_bf16_f32 v68, v72, v73
    v_cvt_pk_bf16_f32 v69, v74, v75
    v_cvt_pk_bf16_f32 v70, v76, v77
    v_cvt_pk_bf16_f32 v71, v78, v79
    s_nop 1
    s_cmp_eq_u32 s50, 1
    s_cbranch_scc1 L_fbv_220
    v_mfma_f32_32x32x16_bf16 v[96:111], v[164:167], v[64:67], v[96:111]
L_fbv_220:
    v_mfma_f32_32x32x16_bf16 v[96:111], v[168:171], v[68:71], v[96:111]
    s_nop 7
    s_nop 7
    s_add_u32 s50, s50, 1
    s_cmp_le_u32 s50, 1
    s_cbranch_scc1 L_fbB_219
    s_mov_b32 s51, s54
    v_mov_b32 v25, 0xff800000
    s_mov_b32 s50, 0
L_fbA_221:
    s_cmp_eq_u32 s50, 0
    s_cselect_b32 s48, 2, 4
    s_cmp_eq_u32 s50, 1
    s_cselect_b32 s48, 3, s48
    s_cmp_gt_u32 s50, s51
    s_cselect_b32 s48, 5, s48
    s_lshl_b32 s48, s48, 8
    v_lshlrev_b32 v14, 2, v3
    v_sub_u32 v14, v14, v2
    v_lshlrev_b32 v14, 2, v14
    v_add_u32 v14, 60032, v14
    v_add_u32 v14, s48, v14
    ds_read2_b32 v[232:233], v14 offset0:0 offset1:1
    ds_read2_b32 v[234:235], v14 offset0:2 offset1:3
    ds_read2_b32 v[236:237], v14 offset0:8 offset1:9
    ds_read2_b32 v[238:239], v14 offset0:10 offset1:11
    ds_read2_b32 v[240:241], v14 offset0:16 offset1:17
    ds_read2_b32 v[242:243], v14 offset0:18 offset1:19
    ds_read2_b32 v[244:245], v14 offset0:24 offset1:25
    ds_read2_b32 v[246:247], v14 offset0:26 offset1:27
    s_mul_i32 s49, s50, 4128
    s_sub_u32 s49, 33024, s49
    v_add_u32 v26, s49, v251
    v_add_u32 v28, s49, v250
    ds_read_b128 v[160:163], v26 offset:0
    s_waitcnt lgkmcnt(0)
    v_mfma_f32_32x32x16_bf16 v[64:79], v[160:163], v[20:23], v[232:247]
    s_nop 7
    s_nop 7
    v_max3_f32 v25, v25, v64, v65
    v_max3_f32 v25, v25, v66, v67
    v_max3_f32 v25, v25, v68, v69
    v_max3_f32 v25, v25, v70, v71
    v_max3_f32 v25, v25, v72, v73
    v_max3_f32 v25, v25, v74, v75
    v_max3_f32 v25, v25, v76, v77
    v_max3_f32 v25, v25, v78, v79
    s_add_u32 s50, s50, 1
    s_cmp_le_u32 s50, 1
    s_cbranch_scc1 L_fbA_221
    v_mov_b32 v27, v25
    s_nop 1
    v_permlane32_swap_b32 v25, v27
    s_nop 1
    v_max_f32 v25, v25, v27
    v_mov_b32 v112, 0
    v_mov_b32 v113, 0
    v_mov_b32 v114, 0
    v_mov_b32 v115, 0
    v_mov_b32 v116, 0
    v_mov_b32 v117, 0
    v_mov_b32 v118, 0
    v_mov_b32 v119, 0
    v_mov_b32 v120, 0
    v_mov_b32 v121, 0
    v_mov_b32 v122, 0
    v_mov_b32 v123, 0
    v_mov_b32 v124, 0
    v_mov_b32 v125, 0
    v_mov_b32 v126, 0
    v_mov_b32 v127, 0
    s_mov_b32 s50, 0
L_fbB_222:
    s_cmp_eq_u32 s50, 0
    s_cselect_b32 s48, 2, 4
    s_cmp_eq_u32 s50, 1
    s_cselect_b32 s48, 3, s48
    s_cmp_gt_u32 s50, s51
    s_cselect_b32 s48, 5, s48
    s_lshl_b32 s48, s48, 8
    v_lshlrev_b32 v14, 2, v3
    v_sub_u32 v14, v14, v2
    v_lshlrev_b32 v14, 2, v14
    v_add_u32 v14, 60032, v14
    v_add_u32 v14, s48, v14
    ds_read2_b32 v[232:233], v14 offset0:0 offset1:1
    ds_read2_b32 v[234:235], v14 offset0:2 offset1:3
    ds_read2_b32 v[236:237], v14 offset0:8 offset1:9
    ds_read2_b32 v[238:239], v14 offset0:10 offset1:11
    ds_read2_b32 v[240:241], v14 offset0:16 offset1:17
    ds_read2_b32 v[242:243], v14 offset0:18 offset1:19
    ds_read2_b32 v[244:245], v14 offset0:24 offset1:25
    ds_read2_b32 v[246:247], v14 offset0:26 offset1:27
    s_mul_i32 s49, s50, 4128
    s_sub_u32 s49, 33024, s49
    v_add_u32 v26, s49, v251
    v_add_u32 v28, s49, v250
    ds_read_b128 v[160:163], v26 offset:0
    ds_read_b128 v[164:167], v28 offset:2048
    ds_read_b128 v[168:171], v28 offset:3088
    s_waitcnt lgkmcnt(0)
    v_mfma_f32_32x32x16_bf16 v[64:79], v[160:163], v[20:23], v[232:247]
    s_nop 7
    s_nop 7
    v_sub_f32 v64, v64, v25
    v_sub_f32 v65, v65, v25
    v_sub_f32 v66, v66, v25
    v_sub_f32 v67, v67, v25
    v_sub_f32 v68, v68, v25
    v_sub_f32 v69, v69, v25
    v_sub_f32 v70, v70, v25
    v_sub_f32 v71, v71, v25
    v_sub_f32 v72, v72, v25
    v_sub_f32 v73, v73, v25
    v_sub_f32 v74, v74, v25
    v_sub_f32 v75, v75, v25
    v_sub_f32 v76, v76, v25
    v_sub_f32 v77, v77, v25
    v_sub_f32 v78, v78, v25
    v_sub_f32 v79, v79, v25
    v_exp_f32 v64, v64
    v_exp_f32 v65, v65
    v_exp_f32 v66, v66
    v_exp_f32 v67, v67
    v_exp_f32 v68, v68
    v_exp_f32 v69, v69
    v_exp_f32 v70, v70
    v_exp_f32 v71, v71
    v_exp_f32 v72, v72
    v_exp_f32 v73, v73
    v_exp_f32 v74, v74
    v_exp_f32 v75, v75
    v_exp_f32 v76, v76
    v_exp_f32 v77, v77
    v_exp_f32 v78, v78
    v_exp_f32 v79, v79
    s_nop 0
    v_cvt_pk_bf16_f32 v64, v64, v65
    v_cvt_pk_bf16_f32 v65, v66, v67
    v_cvt_pk_bf16_f32 v66, v68, v69
    v_cvt_pk_bf16_f32 v67, v70, v71
    v_cvt_pk_bf16_f32 v68, v72, v73
    v_cvt_pk_bf16_f32 v69, v74, v75
    v_cvt_pk_bf16_f32 v70, v76, v77
    v_cvt_pk_bf16_f32 v71, v78, v79
    s_nop 1
    s_cmp_eq_u32 s50, 1
    s_cbranch_scc1 L_fbv_223
    v_mfma_f32_32x32x16_bf16 v[112:127], v[164:167], v[64:67], v[112:127]
L_fbv_223:
    v_mfma_f32_32x32x16_bf16 v[112:127], v[168:171], v[68:71], v[112:127]
    s_nop 7
    s_nop 7
    s_add_u32 s50, s50, 1
    s_cmp_le_u32 s50, 1
    s_cbranch_scc1 L_fbB_222
    s_branch L_fb2_217
L_fb2_217:
    v_rcp_f32 v28, v104
    v_mov_b32 v29, 0x10000
    v_mul_f32 v96, v28, v96
    v_mul_f32 v97, v28, v97
    v_mul_f32 v98, v28, v98
    v_mul_f32 v99, v28, v99
    v_mul_f32 v100, v28, v100
    v_mul_f32 v101, v28, v101
    v_mul_f32 v102, v28, v102
    v_mul_f32 v103, v28, v103
    v_add_u32 v97, s75, v97
    v_and_b32 v97, 0xfffe0000, v97
    v_cvt_pk_bf16_f32 v64, v96, v97
    v_cvt_pk_bf16_f32 v65, v98, v99
    v_cvt_pk_bf16_f32 v66, v100, v101
    v_cvt_pk_bf16_f32 v67, v102, v103
    v_bfi_b32 v64, v29, s74, v64
    s_branch L_fbk_216
L_textend:
.if L_textend-L_pc < 49152
.error "code touch too long"
.endif

.section .rodata,"a"
.p2align 6
.amdhsa_kernel interleave_layers__sliding_block__sliding_local_dilated__prompt_kernel
  .amdhsa_next_free_vgpr 512
  .amdhsa_next_free_sgpr 102
  .amdhsa_accum_offset 256
  .amdhsa_group_segment_fixed_size 0
  .amdhsa_kernarg_size 72
  .amdhsa_user_sgpr_count 2
  .amdhsa_user_sgpr_kernarg_segment_ptr 1
  .amdhsa_system_sgpr_workgroup_id_x 1
.end_amdhsa_kernel
```
